```python
import torch

def _softmax(x, axis=-1):
    return torch.softmax(x, dim=axis)
def _gelu(x):
    return torch.nn.functional.gelu(x, approximate="tanh")
def _silu(x):
    return torch.nn.functional.silu(x)
def _sigmoid(x):
    return torch.sigmoid(x)
def _layernorm(x, axis=-1, eps=1e-5):
    m = x.mean(dim=axis, keepdim=True)
    v = x.var(dim=axis, keepdim=True, unbiased=False)
    return (x - m) / torch.sqrt(v + eps)
def _scatter_add(tgt, idx, src, axis=0):
    return tgt.clone().index_add_(axis, idx, src)
def _segment_sum(src, seg, n):
    out = torch.zeros((n,) + src.shape[1:], dtype=src.dtype)
    return out.index_add_(0, seg, src)
def _pad(x, pw):
    flat = tuple(v for pair in reversed(pw) for v in pair)
    return torch.nn.functional.pad(x, flat)

kernel_name = 'parallel_sum__linear_kernel_hedgehog__dense_activation_relu__prompt'

def setup_inputs():

    _w = (lambda a: (lambda t: t.to(torch.bfloat16) if t.is_floating_point() else t)(torch.as_tensor(a)))
    def _A_setup():
        B, S, D, H = 1, 2048, 512, 32
        Dh = D // H
        return {
            "x": _w((lambda *s: torch.randn(*s, dtype=torch.bfloat16) * 0.05)(B, S, D)),
            "wqkv": _w((lambda *s: torch.randn(*s, dtype=torch.bfloat16) * 0.4)(D, 3 * D)),
            "w_phi": _w((lambda *s: torch.randn(*s, dtype=torch.bfloat16) * 0.4)(H, Dh, Dh) * (Dh ** -0.5)),
            "wo": _w((lambda *s: torch.randn(*s, dtype=torch.bfloat16) * 0.1)(D, D)),
        }
    _A_in = _A_setup()

    def _B_setup():
        B, S, D, Dff = 1, 2048, 512, 1792
        return {
            "x": _w((lambda *s: torch.randn(*s, dtype=torch.bfloat16) * 0.05)(B, S, D)),
            "w1": _w((lambda *s: torch.randn(*s, dtype=torch.bfloat16) * 0.05)(D, Dff)),
            "w2": _w((lambda *s: torch.randn(*s, dtype=torch.bfloat16) * 0.05)(Dff, D)),
        }
    _B_in = _B_setup()

    return {
        "A_x": _A_in["x"],
        "A_wqkv": _A_in["wqkv"],
        "A_w_phi": _A_in["w_phi"],
        "A_wo": _A_in["wo"],
        "B_x": _B_in["x"],
        "B_w1": _B_in["w1"],
        "B_w2": _B_in["w2"],
    }

def reference(A_x, A_wqkv, A_w_phi, A_wo, B_x, B_w1, B_w2):
    def _A_ref(x, wqkv, w_phi, wo):
        B, S, D = x.shape
        H = 32; Dh = D // H
        qkv = (lambda x, *d: x.permute(*d))((x @ wqkv).reshape(B, S, 3, H, Dh), 2, 0, 3, 1, 4)
        q, k, v = qkv[0], qkv[1], qkv[2]
        pq = torch.einsum("bhsd,hdf->bhsf", q, w_phi)
        pk = torch.einsum("bhsd,hdf->bhsf", k, w_phi)
        phi_q = torch.concatenate([_softmax(pq, axis=-1), _softmax(-pq, axis=-1)], axis=-1)
        phi_k = torch.concatenate([_softmax(pk, axis=-1), _softmax(-pk, axis=-1)], axis=-1)
        kv = torch.einsum("bhsf,bhsd->bhfd", phi_k, v)
        z  = torch.einsum("bhsf->bhf", phi_k)
        num = torch.einsum("bhqf,bhfd->bhqd", phi_q, kv)
        den = torch.einsum("bhqf,bhf->bhq", phi_q, z)[..., None] + 1e-6
        o = num / den
        return (lambda x, *d: x.permute(*d))(o, 0, 2, 1, 3).reshape(B, S, D) @ wo

    def _B_ref(x, w1, w2):
        h = torch.einsum("bsd,df->bsf", x, w1)
        zero = torch.zeros_like(h)
        h = torch.maximum(h, zero)
        return torch.einsum("bsf,fd->bsd", h, w2)

    x = A_x
    xn = _layernorm(x, axis=-1)
    return x + _A_ref(xn, A_wqkv, A_w_phi, A_wo) + _B_ref(xn, B_w1, B_w2)
```

```asm
; @launch grid=(256,1,1) block=(512,1,1) lds=163840
.amdgcn_target "amdgcn-amd-amdhsa--gfx950"
.text
.globl parallel_sum__linear_kernel_hedgehog__dense_activation_relu__prompt_kernel
.p2align 8
.type parallel_sum__linear_kernel_hedgehog__dense_activation_relu__prompt_kernel,@function
parallel_sum__linear_kernel_hedgehog__dense_activation_relu__prompt_kernel:
    s_cmp_ge_u32 s2, 256
    s_cbranch_scc1 L_end
    s_load_dwordx4 s[44:47], s[0:1], 0
    s_load_dwordx4 s[60:63], s[0:1], 40
    s_load_dwordx2 s[58:59], s[0:1], 72
    s_load_dwordx4 s[48:51], s[0:1], 16
    s_load_dwordx2 s[56:57], s[0:1], 56
    v_lshrrev_b32 v1, 6, v0
    v_and_b32 v0, 63, v0
    v_readfirstlane_b32 s38, v1
    s_and_b32 s3, s2, 7
    s_lshr_b32 s42, s2, 3
    s_lshr_b32 s64, s3, 2
    s_and_b32 s65, s42, 7
    s_lshl_b32 s36, s64, 3
    s_add_u32 s36, s36, s65
    s_lshr_b32 s66, s42, 3
    s_lshr_b32 s101, s66, 1
    s_and_b32 s100, s3, 3
    s_lshl_b32 s100, s100, 1
    s_and_b32 s67, s66, 1
    s_add_u32 s100, s100, s67
    s_lshl_b32 s66, s66, 1
    s_add_u32 s43, s65, s66
    s_and_b32 s43, s43, 7
    s_cmp_lt_u32 s38, 4
    s_cbranch_scc1 L_mfma
    s_sub_u32 s70, s38, 4
    v_lshrrev_b32 v2, 3, v0
    v_bfe_u32 v3, v0, 4, 1
    v_lshlrev_b32 v3, 2, v3
    v_and_b32 v4, 7, v0
    v_xor_b32 v3, v3, v4
    v_lshlrev_b32 v3, 4, v3
    s_lshl_b32 s64, s70, 4
    v_add_u32 v2, s64, v2
    s_lshl_b32 s69, s70, 11
    s_mul_i32 s65, s100, 448
    s_and_b32 s66, s100, 1
    s_lshl_b32 s66, s66, 6
    s_add_u32 s65, s65, s66
    s_cmp_eq_u32 s101, 1
    s_cbranch_scc1 L_hq
    v_mul_u32_u24 v16, 3072, v2
    s_lshl_b32 s72, s100, 7
    s_add_u32 s72, s72, 1024
    v_add3_u32 v16, v16, v3, s72
    v_add_u32 v17, 23552, v16
    v_add_u32 v18, 1024, v16
    v_add_u32 v19, 1024, v17
    s_mul_i32 s74, s43, 196608
    s_waitcnt lgkmcnt(0)
    s_mov_b32 s8, s46
    s_and_b32 s9, s47, 0xffff
    s_mov_b32 s10, 1572864
    s_mov_b32 s11, 0x00020000
    s_add_u32 m0, s69, 16384
    s_nop 0
    buffer_load_dwordx4 v16, s[8:11], s74 offen offset:0 lds
    buffer_load_dwordx4 v17, s[8:11], s74 offen offset:1024 lds
    s_add_u32 m0, s69, 24576
    s_nop 0
    buffer_load_dwordx4 v18, s[8:11], s74 offen offset:0 lds
    buffer_load_dwordx4 v19, s[8:11], s74 offen offset:1024 lds
    s_add_u32 s74, s58, 19070976
    s_addc_u32 s75, s59, 0
    s_load_dword s99, s[74:75], 0
    s_mov_b32 s12, s60
    s_and_b32 s13, s61, 0xffff
    s_mov_b32 s14, 1835008
    s_mov_b32 s15, 0x00020000
    v_lshlrev_b32 v14, 4, v0
    s_mov_b32 s4, s44
    s_and_b32 s5, s45, 0xffff
    s_mov_b32 s6, 2097152
    s_mov_b32 s7, 0x00020000
    v_lshrrev_b32 v4, 3, v0
    s_lshl_b32 s71, s36, 2
    s_add_u32 s71, s71, s70
    s_lshl_b32 s71, s71, 15
    v_lshl_add_u32 v4, v4, 10, s71
    v_lshrrev_b32 v5, 4, v0
    v_and_b32 v6, 7, v0
    v_mov_b32 v7, v5
    v_xor_b32 v7, v7, v6
    v_lshl_add_u32 v8, v7, 4, v4
    v_add_u32 v7, 4, v5
    v_xor_b32 v7, v7, v6
    v_lshl_add_u32 v9, v7, 4, v4
    v_add_u32 v9, 7168, v9
    v_add_u32 v10, 14336, v8
    v_add_u32 v11, 14336, v9
    s_lshl_b32 s68, s70, 12
    s_add_u32 s74, s43, 2
    s_and_b32 s74, s74, 7
    s_lshl_b32 s75, s74, 7
    s_add_u32 m0, s68, 32768
    s_mul_i32 s74, s74, 196608
    buffer_load_dwordx4 v8, s[4:7], s75 offen offset:0 lds
    buffer_load_dwordx4 v9, s[4:7], s75 offen offset:1024 lds
    buffer_load_dwordx4 v10, s[4:7], s75 offen offset:2048 lds
    buffer_load_dwordx4 v11, s[4:7], s75 offen offset:3072 lds
    s_add_u32 m0, s69, 49152
    s_nop 0
    buffer_load_dwordx4 v16, s[8:11], s74 offen offset:0 lds
    buffer_load_dwordx4 v17, s[8:11], s74 offen offset:1024 lds
    s_add_u32 m0, s69, 57344
    s_nop 0
    buffer_load_dwordx4 v18, s[8:11], s74 offen offset:0 lds
    buffer_load_dwordx4 v19, s[8:11], s74 offen offset:1024 lds
    s_mov_b32 s16, s62
    s_and_b32 s17, s63, 0xffff
    s_mov_b32 s18, 1835008
    s_mov_b32 s19, 0x00020000
    s_lshr_b32 s72, s2, 4
    s_bfe_u32 s73, s2, 0x30001
    s_and_b32 s75, s2, 1
    v_lshrrev_b32 v4, 3, v0
    v_lshl_add_u32 v4, v4, 10, v3
    s_lshl_b32 s73, s73, 7
    v_add_u32 v24, s73, v4
    v_add_u32 v25, 7168, v24
    s_mul_i32 s60, s72, 14
    s_and_b32 s73, s72, 1
    s_cmp_eq_u32 s73, 0
    s_cselect_b32 s61, 0, -12
    s_add_u32 s61, s61, s60
    s_lshl_b32 s73, s73, 1
    s_add_u32 s60, s60, s73
    s_lshl_b32 s72, s72, 2
    s_sub_u32 s62, s72, 14
    s_mul_i32 s75, s75, 9
    s_add_u32 s63, s75, s70
    s_sub_u32 s72, s63, 8
    s_add_u32 s73, s63, 4
    s_cmp_lt_u32 s63, 8
    s_cselect_b32 s72, s73, s72
    s_add_u32 s72, s72, s60
    s_add_u32 s73, s63, s61
    s_cmp_ge_u32 s63, 12
    s_cselect_b32 s72, s73, s72
    s_lshl_b32 s72, s72, 14
    s_add_u32 m0, s69, 139264
    s_nop 0
    buffer_load_dwordx4 v24, s[16:19], s72 offen offset:0 lds
    buffer_load_dwordx4 v25, s[16:19], s72 offen offset:1024 lds
    s_add_u32 s63, s63, 4
    s_sub_u32 s72, s63, 8
    s_add_u32 s73, s63, 4
    s_cmp_lt_u32 s63, 8
    s_cselect_b32 s72, s73, s72
    s_add_u32 s72, s72, s60
    s_add_u32 s73, s63, s61
    s_cmp_ge_u32 s63, 12
    s_cselect_b32 s72, s73, s72
    s_add_u32 s73, s63, s62
    s_cmp_ge_u32 s63, 14
    s_cselect_b32 s72, s73, s72
    s_cselect_b32 s20, s50, s16
    s_cselect_b32 s21, s51, s17
    s_cselect_b32 s22, 0x80000, s18
    s_and_b32 s21, s21, 0xffff
    s_mov_b32 s23, 0x00020000
    s_lshl_b32 s72, s72, 14
    s_add_u32 m0, s69, 147456
    s_nop 0
    buffer_load_dwordx4 v24, s[20:23], s72 offen offset:0 lds
    buffer_load_dwordx4 v25, s[20:23], s72 offen offset:1024 lds
    s_add_u32 s63, s63, 4
    s_cmp_lg_u32 s70, 0
    s_cbranch_scc1 L_hnc
    s_sub_u32 s72, s63, 8
    s_add_u32 s73, s63, 4
    s_cmp_lt_u32 s63, 8
    s_cselect_b32 s72, s73, s72
    s_add_u32 s72, s72, s60
    s_add_u32 s73, s63, s61
    s_cmp_ge_u32 s63, 12
    s_cselect_b32 s72, s73, s72
    s_add_u32 s73, s63, s62
    s_cmp_ge_u32 s63, 14
    s_cselect_b32 s72, s73, s72
    s_cselect_b32 s20, s50, s16
    s_cselect_b32 s21, s51, s17
    s_cselect_b32 s22, 0x80000, s18
    s_and_b32 s21, s21, 0xffff
    s_mov_b32 s23, 0x00020000
    s_lshl_b32 s72, s72, 14
    s_add_u32 m0, s69, 155648
    s_nop 0
    buffer_load_dwordx4 v24, s[20:23], s72 offen offset:0 lds
    buffer_load_dwordx4 v25, s[20:23], s72 offen offset:1024 lds
L_hnc:
    v_mul_u32_u24 v20, 3584, v2
    v_add3_u32 v20, v20, v3, s65
    v_add_u32 v21, 27648, v20
    s_mul_i32 s75, s43, 229376
    s_add_u32 m0, s69, 131072
    s_nop 0
    buffer_load_dwordx4 v20, s[12:15], s75 offen offset:0 lds
    buffer_load_dwordx4 v21, s[12:15], s75 offen offset:1024 lds
    s_mov_b32 s24, s48
    s_and_b32 s25, s49, 0xffff
    s_mov_b32 s26, 16384
    s_mov_b32 s27, 0x00020000
    s_lshl_b32 s72, s100, 11
    s_lshl_b32 s73, s70, 9
    s_add_u32 s72, s72, s73
    s_add_u32 m0, s73, 160320
    s_mov_b32 exec_hi, 0
    buffer_load_dwordx4 v14, s[24:27], s72 offen lds
    s_mov_b32 exec_hi, -1
    s_mov_b32 s28, s58
    s_and_b32 s29, s59, 0xffff
    s_mov_b32 s30, 134217728
    s_mov_b32 s31, 0x00020000
    v_mov_b32 v4, 160256
    v_mov_b32 v28, 0
    v_mov_b32 v29, 0
    v_mov_b32 v30, 0
    v_mov_b32 v31, 0
    ds_write_b128 v4, v[28:31] offset:0
    ds_write_b128 v4, v[28:31] offset:16
    ds_write_b128 v4, v[28:31] offset:32
    ds_write_b128 v4, v[28:31] offset:48
    s_waitcnt lgkmcnt(0)
    s_waitcnt vmcnt(15)
    s_barrier
    s_add_u32 s74, s43, 4
    s_and_b32 s74, s74, 7
    s_lshl_b32 s75, s74, 7
    s_add_u32 m0, s68, 65536
    s_mul_i32 s74, s74, 196608
    s_waitcnt vmcnt(8)
    buffer_load_dwordx4 v8, s[4:7], s75 offen offset:0 lds
    s_waitcnt vmcnt(8)
    buffer_load_dwordx4 v9, s[4:7], s75 offen offset:1024 lds
    s_waitcnt vmcnt(8)
    buffer_load_dwordx4 v10, s[4:7], s75 offen offset:2048 lds
    s_waitcnt vmcnt(8)
    buffer_load_dwordx4 v11, s[4:7], s75 offen offset:3072 lds
    s_add_u32 m0, s69, 81920
    s_waitcnt vmcnt(8)
    buffer_load_dwordx4 v16, s[8:11], s74 offen offset:0 lds
    s_waitcnt vmcnt(8)
    buffer_load_dwordx4 v17, s[8:11], s74 offen offset:1024 lds
    s_add_u32 m0, s69, 90112
    s_waitcnt vmcnt(8)
    buffer_load_dwordx4 v18, s[8:11], s74 offen offset:0 lds
    s_waitcnt vmcnt(8)
    buffer_load_dwordx4 v19, s[8:11], s74 offen offset:1024 lds
    s_barrier
    s_add_u32 s74, s43, 6
    s_and_b32 s74, s74, 7
    s_lshl_b32 s75, s74, 7
    s_add_u32 m0, s68, 98304
    s_mul_i32 s74, s74, 196608
    s_waitcnt vmcnt(8)
    buffer_load_dwordx4 v8, s[4:7], s75 offen offset:0 lds
    s_waitcnt vmcnt(8)
    buffer_load_dwordx4 v9, s[4:7], s75 offen offset:1024 lds
    s_waitcnt vmcnt(8)
    buffer_load_dwordx4 v10, s[4:7], s75 offen offset:2048 lds
    s_waitcnt vmcnt(8)
    buffer_load_dwordx4 v11, s[4:7], s75 offen offset:3072 lds
    s_add_u32 m0, s69, 114688
    s_waitcnt vmcnt(8)
    buffer_load_dwordx4 v16, s[8:11], s74 offen offset:0 lds
    s_waitcnt vmcnt(8)
    buffer_load_dwordx4 v17, s[8:11], s74 offen offset:1024 lds
    s_add_u32 m0, s69, 122880
    s_waitcnt vmcnt(8)
    buffer_load_dwordx4 v18, s[8:11], s74 offen offset:0 lds
    s_waitcnt vmcnt(8)
    buffer_load_dwordx4 v19, s[8:11], s74 offen offset:1024 lds
    s_waitcnt vmcnt(8)
    s_barrier
    s_add_u32 s74, s43, 1
    s_and_b32 s74, s74, 7
    s_lshl_b32 s75, s74, 7
    s_add_u32 m0, s68, 0
    s_mul_i32 s74, s74, 196608
    buffer_load_dwordx4 v8, s[4:7], s75 offen offset:0 lds
    s_waitcnt vmcnt(8)
    buffer_load_dwordx4 v9, s[4:7], s75 offen offset:1024 lds
    s_waitcnt vmcnt(8)
    buffer_load_dwordx4 v10, s[4:7], s75 offen offset:2048 lds
    s_waitcnt vmcnt(8)
    buffer_load_dwordx4 v11, s[4:7], s75 offen offset:3072 lds
    s_add_u32 m0, s69, 16384
    s_waitcnt vmcnt(8)
    buffer_load_dwordx4 v16, s[8:11], s74 offen offset:0 lds
    s_waitcnt vmcnt(8)
    buffer_load_dwordx4 v17, s[8:11], s74 offen offset:1024 lds
    s_add_u32 m0, s69, 24576
    s_waitcnt vmcnt(8)
    buffer_load_dwordx4 v18, s[8:11], s74 offen offset:0 lds
    s_waitcnt vmcnt(8)
    buffer_load_dwordx4 v19, s[8:11], s74 offen offset:1024 lds
    s_lshl_b32 s37, s100, 1
    s_add_u32 s37, s37, s101
    s_and_b32 s40, s42, 3
    s_lshl_b32 s41, s3, 2
    s_add_u32 s40, s40, s41
    s_lshr_b32 s41, s42, 2
    s_and_b32 s72, s42, 3
    s_lshl_b32 s96, s72, 1
    s_add_u32 s96, s96, s38
    s_and_b32 s96, s96, 7
    s_and_b32 s72, s72, 1
    s_lshl_b32 s73, s72, 2
    s_add_u32 s97, s41, s73
    s_and_b32 s97, s97, 7
    s_lshl_b32 s73, s72, 1
    s_add_u32 s98, s41, s73
    s_and_b32 s98, s98, 3
    s_mov_b32 s24, s56
    s_and_b32 s25, s57, 0xffff
    s_mov_b32 s26, 2097152
    s_mov_b32 s27, 0x00020000
    v_and_b32 v26, 7, v0
    v_lshlrev_b32 v26, 2, v26
    s_lshl_b32 s61, s41, 3
    s_add_u32 s61, s61, s96
    s_lshl_b32 s61, s61, 5
    s_add_u32 s61, s61, 19136512
    s_mul_i32 s39, s99, 0x9E3779B1
    s_add_u32 s39, s39, 0x7F4A7C15
    s_and_b32 s52, s99, 3
    s_xor_b32 s53, s52, 1
    s_bfe_u32 s54, s99, 0x20002
    s_bfe_u32 s55, s99, 0x20004
    s_mul_i32 s52, s52, 0x40008000
    s_and_b32 s52, s52, 0x80008000
    s_mul_i32 s53, s53, 0x40008000
    s_and_b32 s53, s53, 0x80008000
    s_mul_i32 s54, s54, 0x40008000
    s_and_b32 s54, s54, 0x80008000
    s_mul_i32 s55, s55, 0x40008000
    s_and_b32 s55, s55, 0x80008000
    s_waitcnt vmcnt(8)
    s_barrier
    s_add_u32 s74, s43, 3
    s_and_b32 s74, s74, 7
    s_lshl_b32 s75, s74, 7
    s_add_u32 m0, s68, 32768
    s_mul_i32 s74, s74, 196608
    buffer_load_dwordx4 v8, s[4:7], s75 offen offset:0 lds
    s_waitcnt vmcnt(8)
    buffer_load_dwordx4 v9, s[4:7], s75 offen offset:1024 lds
    s_waitcnt vmcnt(8)
    buffer_load_dwordx4 v10, s[4:7], s75 offen offset:2048 lds
    s_waitcnt vmcnt(8)
    buffer_load_dwordx4 v11, s[4:7], s75 offen offset:3072 lds
    s_add_u32 m0, s69, 49152
    s_waitcnt vmcnt(8)
    buffer_load_dwordx4 v16, s[8:11], s74 offen offset:0 lds
    s_waitcnt vmcnt(8)
    buffer_load_dwordx4 v17, s[8:11], s74 offen offset:1024 lds
    s_add_u32 m0, s69, 57344
    s_waitcnt vmcnt(8)
    buffer_load_dwordx4 v18, s[8:11], s74 offen offset:0 lds
    s_waitcnt vmcnt(8)
    buffer_load_dwordx4 v19, s[8:11], s74 offen offset:1024 lds
    s_waitcnt vmcnt(8)
    s_barrier
    s_add_u32 s74, s43, 5
    s_and_b32 s74, s74, 7
    s_lshl_b32 s75, s74, 7
    s_add_u32 m0, s68, 65536
    s_mul_i32 s74, s74, 196608
    buffer_load_dwordx4 v8, s[4:7], s75 offen offset:0 lds
    s_waitcnt vmcnt(8)
    buffer_load_dwordx4 v9, s[4:7], s75 offen offset:1024 lds
    s_waitcnt vmcnt(8)
    buffer_load_dwordx4 v10, s[4:7], s75 offen offset:2048 lds
    s_waitcnt vmcnt(8)
    buffer_load_dwordx4 v11, s[4:7], s75 offen offset:3072 lds
    s_add_u32 m0, s69, 81920
    s_waitcnt vmcnt(8)
    buffer_load_dwordx4 v16, s[8:11], s74 offen offset:0 lds
    s_waitcnt vmcnt(8)
    buffer_load_dwordx4 v17, s[8:11], s74 offen offset:1024 lds
    s_add_u32 m0, s69, 90112
    s_waitcnt vmcnt(8)
    buffer_load_dwordx4 v18, s[8:11], s74 offen offset:0 lds
    s_waitcnt vmcnt(8)
    buffer_load_dwordx4 v19, s[8:11], s74 offen offset:1024 lds
    s_waitcnt vmcnt(8)
    s_barrier
    s_add_u32 s74, s43, 7
    s_and_b32 s74, s74, 7
    s_lshl_b32 s75, s74, 7
    s_add_u32 m0, s68, 98304
    s_mul_i32 s74, s74, 196608
    buffer_load_dwordx4 v8, s[4:7], s75 offen offset:0 lds
    s_waitcnt vmcnt(8)
    buffer_load_dwordx4 v9, s[4:7], s75 offen offset:1024 lds
    s_waitcnt vmcnt(8)
    buffer_load_dwordx4 v10, s[4:7], s75 offen offset:2048 lds
    s_waitcnt vmcnt(8)
    buffer_load_dwordx4 v11, s[4:7], s75 offen offset:3072 lds
    s_add_u32 m0, s69, 114688
    s_waitcnt vmcnt(8)
    buffer_load_dwordx4 v16, s[8:11], s74 offen offset:0 lds
    s_waitcnt vmcnt(8)
    buffer_load_dwordx4 v17, s[8:11], s74 offen offset:1024 lds
    s_add_u32 m0, s69, 122880
    s_waitcnt vmcnt(8)
    buffer_load_dwordx4 v18, s[8:11], s74 offen offset:0 lds
    s_waitcnt vmcnt(8)
    buffer_load_dwordx4 v19, s[8:11], s74 offen offset:1024 lds
    s_waitcnt vmcnt(8)
    s_barrier
    s_add_u32 s74, s43, 2
    s_and_b32 s74, s74, 7
    s_mul_i32 s75, s74, 229376
    s_add_u32 m0, s69, 8192
    s_nop 0
    buffer_load_dwordx4 v20, s[12:15], s75 offen offset:0 lds
    s_waitcnt vmcnt(8)
    buffer_load_dwordx4 v21, s[12:15], s75 offen offset:1024 lds
    s_add_u32 s74, s43, 4
    s_and_b32 s74, s74, 7
    s_mul_i32 s75, s74, 229376
    s_add_u32 m0, s69, 16384
    s_waitcnt vmcnt(8)
    buffer_load_dwordx4 v20, s[12:15], s75 offen offset:0 lds
    s_waitcnt vmcnt(8)
    buffer_load_dwordx4 v21, s[12:15], s75 offen offset:1024 lds
    s_add_u32 s74, s43, 6
    s_and_b32 s74, s74, 7
    s_mul_i32 s75, s74, 229376
    s_add_u32 m0, s69, 24576
    s_waitcnt vmcnt(8)
    buffer_load_dwordx4 v20, s[12:15], s75 offen offset:0 lds
    s_waitcnt vmcnt(8)
    buffer_load_dwordx4 v21, s[12:15], s75 offen offset:1024 lds
    s_waitcnt vmcnt(8)
    buffer_load_dword v27, v26, s[28:31], s61 offen sc1
    s_add_u32 s74, s43, 1
    s_and_b32 s74, s74, 7
    s_mul_i32 s75, s74, 229376
    s_add_u32 m0, s69, 32768
    s_waitcnt vmcnt(8)
    buffer_load_dwordx4 v20, s[12:15], s75 offen offset:0 lds
    s_waitcnt vmcnt(8)
    s_barrier
    buffer_load_dwordx4 v21, s[12:15], s75 offen offset:1024 lds
    s_add_u32 s74, s43, 3
    s_and_b32 s74, s74, 7
    s_mul_i32 s75, s74, 229376
    s_add_u32 m0, s69, 40960
    s_waitcnt vmcnt(8)
    buffer_load_dwordx4 v20, s[12:15], s75 offen offset:0 lds
    s_waitcnt vmcnt(8)
    buffer_load_dwordx4 v21, s[12:15], s75 offen offset:1024 lds
    s_add_u32 s74, s43, 5
    s_and_b32 s74, s74, 7
    s_mul_i32 s75, s74, 229376
    s_add_u32 m0, s69, 49152
    s_waitcnt vmcnt(8)
    buffer_load_dwordx4 v20, s[12:15], s75 offen offset:0 lds
    s_waitcnt vmcnt(8)
    buffer_load_dwordx4 v21, s[12:15], s75 offen offset:1024 lds
    s_add_u32 s74, s43, 7
    s_and_b32 s74, s74, 7
    s_mul_i32 s75, s74, 229376
    s_add_u32 m0, s69, 57344
    s_waitcnt vmcnt(8)
    buffer_load_dwordx4 v20, s[12:15], s75 offen offset:0 lds
    s_waitcnt vmcnt(8)
    buffer_load_dwordx4 v21, s[12:15], s75 offen offset:1024 lds
    s_add_u32 s8, s97, 0
    s_and_b32 s8, s8, 7
    s_lshl_b32 s8, s8, 10
    s_add_u32 s9, s97, 1
    s_and_b32 s9, s9, 7
    s_lshl_b32 s9, s9, 10
    s_add_u32 s10, s97, 2
    s_and_b32 s10, s10, 7
    s_lshl_b32 s10, s10, 10
    s_add_u32 s11, s97, 3
    s_and_b32 s11, s11, 7
    s_lshl_b32 s11, s11, 10
    s_add_u32 s12, s97, 4
    s_and_b32 s12, s12, 7
    s_lshl_b32 s12, s12, 10
    s_add_u32 s13, s97, 5
    s_and_b32 s13, s13, 7
    s_lshl_b32 s13, s13, 10
    s_add_u32 s14, s97, 6
    s_and_b32 s14, s14, 7
    s_lshl_b32 s14, s14, 10
    s_add_u32 s15, s97, 7
    s_and_b32 s15, s15, 7
    s_lshl_b32 s15, s15, 10
    s_add_u32 s16, s98, 0
    s_and_b32 s16, s16, 3
    s_lshl_b32 s16, s16, 10
    s_add_u32 s16, s16, 8192
    s_add_u32 s17, s98, 1
    s_and_b32 s17, s17, 3
    s_lshl_b32 s17, s17, 10
    s_add_u32 s17, s17, 8192
    s_add_u32 s18, s98, 2
    s_and_b32 s18, s18, 3
    s_lshl_b32 s18, s18, 10
    s_add_u32 s18, s18, 8192
    s_add_u32 s19, s98, 3
    s_and_b32 s19, s19, 3
    s_lshl_b32 s19, s19, 10
    s_add_u32 s19, s19, 8192
    s_mov_b32 s20, 12288
    s_mov_b32 s21, 13312
    s_add_u32 s22, s16, 6144
    s_add_u32 s23, s17, 6144
    s_add_u32 s32, s18, 6144
    s_add_u32 s33, s19, 6144
    s_lshl_b32 s72, s96, 3
    s_add_u32 s72, s72, s41
    s_mul_i32 s72, s72, 36864
    s_add_u32 s72, s72, 20971520
    v_add_u32 v11, s72, v14
    v_lshrrev_b32 v3, 5, v0
    v_bfe_u32 v4, v0, 2, 2
    v_and_b32 v5, 3, v0
    v_and_b32 v2, 31, v0
    v_lshl_add_u32 v6, v3, 2, v4
    v_lshlrev_b32 v6, 5, v6
    v_lshl_add_u32 v6, v5, 3, v6
    v_add_u32 v6, 160320, v6
    s_lshl_b32 s72, s70, 10
    s_add_u32 s72, s72, 98304
    v_add_u32 v15, s72, v14
    v_mov_b32 v13, 160256
    s_lshl_b32 s72, s100, 2
    s_add_u32 s72, s72, s70
    s_lshl_b32 s62, s72, 2
    s_add_u32 s62, s62, 19005440
    s_mul_i32 s63, s72, 4352
    s_add_u32 s63, s63, 17825792
    s_lshl_b32 s60, s72, 7
    s_add_u32 s60, s60, 18939904
    v_mov_b32 v111, 0
    s_waitcnt vmcnt(8)
    v_cmp_ne_u32 vcc, s39, v27
    s_nop 0
    s_cmp_eq_u64 vcc, 0
    s_cbranch_scc0 L_slow0
    buffer_load_dword v110, v111, s[28:31], s62 offen sc1
    s_lshl_b32 s34, s8, 1
    buffer_load_dwordx4 v[112:115], v11, s[28:31], s34 offen offset:0 sc1
    buffer_load_dwordx4 v[116:119], v11, s[28:31], s34 offen offset:1024 sc1
    s_lshl_b32 s34, s9, 1
    buffer_load_dwordx4 v[120:123], v11, s[28:31], s34 offen offset:0 sc1
    buffer_load_dwordx4 v[124:127], v11, s[28:31], s34 offen offset:1024 sc1
    s_lshl_b32 s34, s10, 1
    buffer_load_dwordx4 v[128:131], v11, s[28:31], s34 offen offset:0 sc1
    buffer_load_dwordx4 v[132:135], v11, s[28:31], s34 offen offset:1024 sc1
    s_waitcnt vmcnt(7)
    s_barrier
    s_setprio 3
    s_lshl_b32 s72, s70, 9
    v_add_u32 v6, s72, v6
    ds_read_b64_tr_b16 v[16:17], v6
    ds_read_b64_tr_b16 v[18:19], v6 offset:256
    ds_read_b128 v[88:91], v15 offset:0
    ds_read_b128 v[92:95], v15 offset:4096
    ds_read_b128 v[96:99], v15 offset:8192
    ds_read_b128 v[100:103], v15 offset:12288
    v_lshlrev_b32 v6, 2, v2
    v_add_u32 v6, 157696, v6
    ds_read_b32 v8, v6 offset:0
    ds_read_b32 v10, v6 offset:128
    ds_read_b32 v104, v6 offset:256
    ds_read_b32 v106, v6 offset:384
    s_mul_i32 s72, s70, 2304
    s_add_u32 s72, s72, 82944
    v_mul_u32_u24 v6, 72, v2
    v_lshl_add_u32 v6, v3, 3, v6
    v_add_u32 v12, s72, v6
    v_lshl_add_u32 v6, v3, 3, v4
    v_mul_u32_u24 v7, 72, v6
    v_lshl_add_u32 v7, v5, 3, v7
    v_bfe_u32 v1, v0, 4, 1
    v_lshl_add_u32 v7, v1, 5, v7
    v_add_u32 v7, s72, v7
    s_waitcnt lgkmcnt(7)
    v_mfma_f32_32x32x16_bf16 v[32:47], v[16:19], v[88:91], 0
    v_mul_u32_u24 v6, 136, v6
    s_lshl_b32 s72, s70, 5
    v_lshl_add_u32 v108, v5, 3, s72
    v_cmp_eq_u32 vcc, 1, v1
    v_mov_b32 v109, 128
    s_nop 0
    v_cndmask_b32 v108, v108, v109, vcc
    v_add_u32 v6, v6, v108
    v_add_u32 v6, 65536, v6
    v_bfe_u32 v1, v0, 2, 1
    v_lshlrev_b32 v1, 7, v1
    v_bfe_u32 v108, v0, 3, 2
    v_lshl_add_u32 v1, v108, 5, v1
    v_lshl_add_u32 v1, v5, 3, v1
    v_lshl_add_u32 v1, v3, 10, v1
    s_waitcnt lgkmcnt(0)
    v_mul_f32 v8, 1069066811, v8
    v_mul_f32 v10, 1069066811, v10
    v_mul_f32 v104, 1069066811, v104
    v_mul_f32 v106, 1069066811, v106
    v_max3_f32 v48, v32, v33, v34
    v_min3_f32 v50, v32, v33, v34
    v_max3_f32 v52, v35, v36, v37
    v_min3_f32 v53, v35, v36, v37
    v_max3_f32 v48, v48, v38, v39
    v_min3_f32 v50, v50, v38, v39
    v_max_f32 v48, v48, v52
    v_min_f32 v50, v50, v53
    v_sub_f32 v50, 0, v50
    s_nop 1
    v_permlane32_swap_b32 v48, v50
    v_max_f32 v48, v48, v50
    v_mul_f32 v48, v48, -v8
    v_mov_b32 v50, v48
    s_nop 1
    v_permlane32_swap_b32 v48, v50
    v_fma_f32 v54, v32, v8, v48
    v_fma_f32 v62, -v32, v8, v50
    v_fma_f32 v55, v33, v8, v48
    v_fma_f32 v63, -v33, v8, v50
    v_fma_f32 v56, v34, v8, v48
    v_fma_f32 v64, -v34, v8, v50
    v_fma_f32 v57, v35, v8, v48
    v_fma_f32 v65, -v35, v8, v50
    v_fma_f32 v58, v36, v8, v48
    v_fma_f32 v66, -v36, v8, v50
    v_fma_f32 v59, v37, v8, v48
    v_fma_f32 v67, -v37, v8, v50
    v_fma_f32 v60, v38, v8, v48
    v_fma_f32 v68, -v38, v8, v50
    v_fma_f32 v61, v39, v8, v48
    v_fma_f32 v69, -v39, v8, v50
    v_mfma_f32_32x32x16_bf16 v[32:47], v[16:19], v[92:95], 0
    v_exp_f32 v54, v54
    v_exp_f32 v55, v55
    v_exp_f32 v56, v56
    v_exp_f32 v57, v57
    v_exp_f32 v58, v58
    v_exp_f32 v59, v59
    v_exp_f32 v60, v60
    v_exp_f32 v61, v61
    v_exp_f32 v62, v62
    v_exp_f32 v63, v63
    v_exp_f32 v64, v64
    v_exp_f32 v65, v65
    v_exp_f32 v66, v66
    v_exp_f32 v67, v67
    v_exp_f32 v68, v68
    s_lshl_b32 s34, s11, 1
    buffer_load_dwordx4 v[136:139], v11, s[28:31], s34 offen offset:0 sc1
    v_exp_f32 v69, v69
    v_add_f32 v48, v54, v55
    v_add_f32 v49, v56, v57
    v_add_f32 v52, v58, v59
    v_add_f32 v50, v62, v63
    v_add_f32 v51, v64, v65
    v_add_f32 v53, v66, v67
    v_add_f32 v48, v48, v60
    v_add_f32 v49, v49, v61
    v_add_f32 v50, v50, v68
    v_add_f32 v51, v51, v69
    v_add_f32 v48, v48, v52
    v_add_f32 v50, v50, v53
    v_add_f32 v48, v48, v49
    v_add_f32 v50, v50, v51
    s_nop 1
    v_permlane32_swap_b32 v48, v50
    v_add_f32 v48, v48, v50
    v_rcp_f32 v48, v48
    s_nop 0
    v_mov_b32 v50, v48
    s_nop 1
    v_permlane32_swap_b32 v48, v50
    v_mul_f32 v54, v54, v48
    v_mul_f32 v62, v62, v50
    v_mul_f32 v55, v55, v48
    v_mul_f32 v63, v63, v50
    v_mul_f32 v56, v56, v48
    v_mul_f32 v64, v64, v50
    v_mul_f32 v57, v57, v48
    v_mul_f32 v65, v65, v50
    v_mul_f32 v58, v58, v48
    v_mul_f32 v66, v66, v50
    v_mul_f32 v59, v59, v48
    v_mul_f32 v67, v67, v50
    v_mul_f32 v60, v60, v48
    v_mul_f32 v68, v68, v50
    v_mul_f32 v61, v61, v48
    v_mul_f32 v69, v69, v50
    v_cvt_pk_bf16_f32 v24, v54, v55
    v_cvt_pk_bf16_f32 v25, v56, v57
    v_cvt_pk_bf16_f32 v26, v58, v59
    v_cvt_pk_bf16_f32 v27, v60, v61
    v_cvt_pk_bf16_f32 v28, v62, v63
    v_cvt_pk_bf16_f32 v29, v64, v65
    v_cvt_pk_bf16_f32 v30, v66, v67
    v_cvt_pk_bf16_f32 v31, v68, v69
    ds_write_b64 v12, v[24:25] offset:0
    ds_write_b64 v12, v[26:27] offset:16
    ds_write_b64 v12, v[28:29] offset:32
    ds_write_b64 v12, v[30:31] offset:48
    ds_read_b64_tr_b16 v[72:73], v7 offset:0
    ds_read_b64_tr_b16 v[74:75], v7 offset:288
    ds_read_b64_tr_b16 v[76:77], v7 offset:1152
    ds_read_b64_tr_b16 v[78:79], v7 offset:1440
    v_max3_f32 v48, v32, v33, v34
    buffer_load_dwordx4 v[140:143], v11, s[28:31], s34 offen offset:1024 sc1
    v_min3_f32 v50, v32, v33, v34
    v_max3_f32 v52, v35, v36, v37
    v_min3_f32 v53, v35, v36, v37
    v_max3_f32 v48, v48, v38, v39
    v_min3_f32 v50, v50, v38, v39
    v_max_f32 v48, v48, v52
    v_min_f32 v50, v50, v53
    v_sub_f32 v50, 0, v50
    s_nop 1
    v_permlane32_swap_b32 v48, v50
    v_max_f32 v48, v48, v50
    v_mul_f32 v48, v48, -v10
    v_mov_b32 v50, v48
    s_nop 1
    v_permlane32_swap_b32 v48, v50
    v_fma_f32 v54, v32, v10, v48
    v_fma_f32 v62, -v32, v10, v50
    v_fma_f32 v55, v33, v10, v48
    v_fma_f32 v63, -v33, v10, v50
    v_fma_f32 v56, v34, v10, v48
    v_fma_f32 v64, -v34, v10, v50
    v_fma_f32 v57, v35, v10, v48
    v_fma_f32 v65, -v35, v10, v50
    v_fma_f32 v58, v36, v10, v48
    v_fma_f32 v66, -v36, v10, v50
    v_fma_f32 v59, v37, v10, v48
    v_fma_f32 v67, -v37, v10, v50
    v_fma_f32 v60, v38, v10, v48
    v_fma_f32 v68, -v38, v10, v50
    v_fma_f32 v61, v39, v10, v48
    v_fma_f32 v69, -v39, v10, v50
    v_mfma_f32_32x32x16_bf16 v[32:47], v[16:19], v[96:99], 0
    v_exp_f32 v54, v54
    v_exp_f32 v55, v55
    v_exp_f32 v56, v56
    v_exp_f32 v57, v57
    v_exp_f32 v58, v58
    v_exp_f32 v59, v59
    v_exp_f32 v60, v60
    v_exp_f32 v61, v61
    v_exp_f32 v62, v62
    v_exp_f32 v63, v63
    v_exp_f32 v64, v64
    v_exp_f32 v65, v65
    v_exp_f32 v66, v66
    v_exp_f32 v67, v67
    v_exp_f32 v68, v68
    v_exp_f32 v69, v69
    s_lshl_b32 s34, s12, 1
    buffer_load_dwordx4 v[144:147], v11, s[28:31], s34 offen offset:0 sc1
    v_add_f32 v48, v54, v55
    v_add_f32 v49, v56, v57
    v_add_f32 v52, v58, v59
    v_add_f32 v50, v62, v63
    v_add_f32 v51, v64, v65
    v_add_f32 v53, v66, v67
    v_add_f32 v48, v48, v60
    v_add_f32 v49, v49, v61
    v_add_f32 v50, v50, v68
    v_add_f32 v51, v51, v69
    v_add_f32 v48, v48, v52
    v_add_f32 v50, v50, v53
    v_add_f32 v48, v48, v49
    v_add_f32 v50, v50, v51
    s_nop 1
    v_permlane32_swap_b32 v48, v50
    v_add_f32 v48, v48, v50
    v_rcp_f32 v48, v48
    s_nop 0
    v_mov_b32 v50, v48
    s_nop 1
    v_permlane32_swap_b32 v48, v50
    v_mul_f32 v54, v54, v48
    v_mul_f32 v62, v62, v50
    v_mul_f32 v55, v55, v48
    v_mul_f32 v63, v63, v50
    v_mul_f32 v56, v56, v48
    v_mul_f32 v64, v64, v50
    v_mul_f32 v57, v57, v48
    v_mul_f32 v65, v65, v50
    v_mul_f32 v58, v58, v48
    v_mul_f32 v66, v66, v50
    v_mul_f32 v59, v59, v48
    v_mul_f32 v67, v67, v50
    v_mul_f32 v60, v60, v48
    v_mul_f32 v68, v68, v50
    v_mul_f32 v61, v61, v48
    v_mul_f32 v69, v69, v50
    v_cvt_pk_bf16_f32 v24, v54, v55
    v_cvt_pk_bf16_f32 v25, v56, v57
    v_cvt_pk_bf16_f32 v26, v58, v59
    v_cvt_pk_bf16_f32 v27, v60, v61
    v_cvt_pk_bf16_f32 v28, v62, v63
    v_cvt_pk_bf16_f32 v29, v64, v65
    v_cvt_pk_bf16_f32 v30, v66, v67
    v_cvt_pk_bf16_f32 v31, v68, v69
    ds_write_b64 v12, v[24:25] offset:0
    ds_write_b64 v12, v[26:27] offset:16
    ds_write_b64 v12, v[28:29] offset:32
    ds_write_b64 v12, v[30:31] offset:48
    ds_read_b64_tr_b16 v[80:81], v7 offset:0
    ds_read_b64_tr_b16 v[82:83], v7 offset:288
    ds_read_b64_tr_b16 v[84:85], v7 offset:1152
    ds_read_b64_tr_b16 v[86:87], v7 offset:1440
    v_max3_f32 v48, v32, v33, v34
    v_min3_f32 v50, v32, v33, v34
    buffer_load_dwordx4 v[148:151], v11, s[28:31], s34 offen offset:1024 sc1
    v_max3_f32 v52, v35, v36, v37
    v_min3_f32 v53, v35, v36, v37
    v_max3_f32 v48, v48, v38, v39
    v_min3_f32 v50, v50, v38, v39
    v_max_f32 v48, v48, v52
    v_min_f32 v50, v50, v53
    v_sub_f32 v50, 0, v50
    s_nop 1
    v_permlane32_swap_b32 v48, v50
    v_max_f32 v48, v48, v50
    v_mul_f32 v48, v48, -v104
    v_mov_b32 v50, v48
    s_nop 1
    v_permlane32_swap_b32 v48, v50
    v_fma_f32 v54, v32, v104, v48
    v_fma_f32 v62, -v32, v104, v50
    v_fma_f32 v55, v33, v104, v48
    v_fma_f32 v63, -v33, v104, v50
    v_fma_f32 v56, v34, v104, v48
    v_fma_f32 v64, -v34, v104, v50
    v_fma_f32 v57, v35, v104, v48
    v_fma_f32 v65, -v35, v104, v50
    v_fma_f32 v58, v36, v104, v48
    v_fma_f32 v66, -v36, v104, v50
    v_fma_f32 v59, v37, v104, v48
    v_fma_f32 v67, -v37, v104, v50
    v_fma_f32 v60, v38, v104, v48
    v_fma_f32 v68, -v38, v104, v50
    v_fma_f32 v61, v39, v104, v48
    v_fma_f32 v69, -v39, v104, v50
    v_mfma_f32_32x32x16_bf16 v[32:47], v[16:19], v[100:103], 0
    v_exp_f32 v54, v54
    v_exp_f32 v55, v55
    v_exp_f32 v56, v56
    v_exp_f32 v57, v57
    v_exp_f32 v58, v58
    v_exp_f32 v59, v59
    v_exp_f32 v60, v60
    v_exp_f32 v61, v61
    v_exp_f32 v62, v62
    v_exp_f32 v63, v63
    v_exp_f32 v64, v64
    v_exp_f32 v65, v65
    v_exp_f32 v66, v66
    v_exp_f32 v67, v67
    v_exp_f32 v68, v68
    v_exp_f32 v69, v69
    v_add_f32 v48, v54, v55
    s_lshl_b32 s34, s13, 1
    buffer_load_dwordx4 v[152:155], v11, s[28:31], s34 offen offset:0 sc1
    v_add_f32 v49, v56, v57
    v_add_f32 v52, v58, v59
    v_add_f32 v50, v62, v63
    v_add_f32 v51, v64, v65
    v_add_f32 v53, v66, v67
    v_add_f32 v48, v48, v60
    v_add_f32 v49, v49, v61
    v_add_f32 v50, v50, v68
    v_add_f32 v51, v51, v69
    v_add_f32 v48, v48, v52
    v_add_f32 v50, v50, v53
    v_add_f32 v48, v48, v49
    v_add_f32 v50, v50, v51
    s_nop 1
    v_permlane32_swap_b32 v48, v50
    v_add_f32 v48, v48, v50
    v_rcp_f32 v48, v48
    s_nop 0
    v_mov_b32 v50, v48
    s_nop 1
    v_permlane32_swap_b32 v48, v50
    v_mul_f32 v54, v54, v48
    v_mul_f32 v62, v62, v50
    v_mul_f32 v55, v55, v48
    v_mul_f32 v63, v63, v50
    v_mul_f32 v56, v56, v48
    v_mul_f32 v64, v64, v50
    v_mul_f32 v57, v57, v48
    v_mul_f32 v65, v65, v50
    v_mul_f32 v58, v58, v48
    v_mul_f32 v66, v66, v50
    v_mul_f32 v59, v59, v48
    v_mul_f32 v67, v67, v50
    v_mul_f32 v60, v60, v48
    v_mul_f32 v68, v68, v50
    v_mul_f32 v61, v61, v48
    v_mul_f32 v69, v69, v50
    v_cvt_pk_bf16_f32 v24, v54, v55
    v_cvt_pk_bf16_f32 v25, v56, v57
    v_cvt_pk_bf16_f32 v26, v58, v59
    v_cvt_pk_bf16_f32 v27, v60, v61
    v_cvt_pk_bf16_f32 v28, v62, v63
    v_cvt_pk_bf16_f32 v29, v64, v65
    v_cvt_pk_bf16_f32 v30, v66, v67
    v_cvt_pk_bf16_f32 v31, v68, v69
    ds_write_b64 v12, v[24:25] offset:0
    ds_write_b64 v12, v[26:27] offset:16
    ds_write_b64 v12, v[28:29] offset:32
    ds_write_b64 v12, v[30:31] offset:48
    ds_read_b64_tr_b16 v[88:89], v7 offset:0
    ds_read_b64_tr_b16 v[90:91], v7 offset:288
    ds_read_b64_tr_b16 v[92:93], v7 offset:1152
    ds_read_b64_tr_b16 v[94:95], v7 offset:1440
    v_max3_f32 v48, v32, v33, v34
    v_min3_f32 v50, v32, v33, v34
    v_max3_f32 v52, v35, v36, v37
    v_min3_f32 v53, v35, v36, v37
    v_max3_f32 v48, v48, v38, v39
    v_min3_f32 v50, v50, v38, v39
    v_max_f32 v48, v48, v52
    v_min_f32 v50, v50, v53
    v_sub_f32 v50, 0, v50
    s_nop 1
    v_permlane32_swap_b32 v48, v50
    v_max_f32 v48, v48, v50
    v_mul_f32 v48, v48, -v106
    v_mov_b32 v50, v48
    s_nop 1
    v_permlane32_swap_b32 v48, v50
    v_fma_f32 v54, v32, v106, v48
    v_fma_f32 v62, -v32, v106, v50
    v_fma_f32 v55, v33, v106, v48
    v_fma_f32 v63, -v33, v106, v50
    v_fma_f32 v56, v34, v106, v48
    v_fma_f32 v64, -v34, v106, v50
    v_fma_f32 v57, v35, v106, v48
    v_fma_f32 v65, -v35, v106, v50
    v_fma_f32 v58, v36, v106, v48
    v_fma_f32 v66, -v36, v106, v50
    v_fma_f32 v59, v37, v106, v48
    v_fma_f32 v67, -v37, v106, v50
    v_fma_f32 v60, v38, v106, v48
    v_fma_f32 v68, -v38, v106, v50
    v_fma_f32 v61, v39, v106, v48
    v_fma_f32 v69, -v39, v106, v50
    v_exp_f32 v54, v54
    v_exp_f32 v55, v55
    v_exp_f32 v56, v56
    v_exp_f32 v57, v57
    v_exp_f32 v58, v58
    v_exp_f32 v59, v59
    v_exp_f32 v60, v60
    v_exp_f32 v61, v61
    v_exp_f32 v62, v62
    v_exp_f32 v63, v63
    v_exp_f32 v64, v64
    v_exp_f32 v65, v65
    v_exp_f32 v66, v66
    v_exp_f32 v67, v67
    v_exp_f32 v68, v68
    v_exp_f32 v69, v69
    v_add_f32 v48, v54, v55
    v_add_f32 v49, v56, v57
    v_add_f32 v52, v58, v59
    v_add_f32 v50, v62, v63
    v_add_f32 v51, v64, v65
    v_add_f32 v53, v66, v67
    v_add_f32 v48, v48, v60
    v_add_f32 v49, v49, v61
    v_add_f32 v50, v50, v68
    v_add_f32 v51, v51, v69
    v_add_f32 v48, v48, v52
    v_add_f32 v50, v50, v53
    v_add_f32 v48, v48, v49
    v_add_f32 v50, v50, v51
    s_nop 1
    v_permlane32_swap_b32 v48, v50
    v_add_f32 v48, v48, v50
    v_rcp_f32 v48, v48
    s_nop 0
    v_mov_b32 v50, v48
    s_nop 1
    v_permlane32_swap_b32 v48, v50
    v_mul_f32 v54, v54, v48
    v_mul_f32 v62, v62, v50
    v_mul_f32 v55, v55, v48
    v_mul_f32 v63, v63, v50
    v_mul_f32 v56, v56, v48
    v_mul_f32 v64, v64, v50
    v_mul_f32 v57, v57, v48
    v_mul_f32 v65, v65, v50
    v_mul_f32 v58, v58, v48
    v_mul_f32 v66, v66, v50
    v_mul_f32 v59, v59, v48
    v_mul_f32 v67, v67, v50
    v_mul_f32 v60, v60, v48
    v_mul_f32 v68, v68, v50
    v_mul_f32 v61, v61, v48
    v_mul_f32 v69, v69, v50
    v_cvt_pk_bf16_f32 v24, v54, v55
    v_cvt_pk_bf16_f32 v25, v56, v57
    v_cvt_pk_bf16_f32 v26, v58, v59
    v_cvt_pk_bf16_f32 v27, v60, v61
    v_cvt_pk_bf16_f32 v28, v62, v63
    v_cvt_pk_bf16_f32 v29, v64, v65
    v_cvt_pk_bf16_f32 v30, v66, v67
    v_cvt_pk_bf16_f32 v31, v68, v69
    ds_write_b64 v12, v[24:25] offset:0
    ds_write_b64 v12, v[26:27] offset:16
    ds_write_b64 v12, v[28:29] offset:32
    ds_write_b64 v12, v[30:31] offset:48
    ds_read_b64_tr_b16 v[96:97], v7 offset:0
    ds_read_b64_tr_b16 v[98:99], v7 offset:288
    ds_read_b64_tr_b16 v[100:101], v7 offset:1152
    ds_read_b64_tr_b16 v[102:103], v7 offset:1440
    s_lshr_b32 s72, s70, 1
    s_add_u32 s73, s72, 2
    s_mov_b32 s67, 0
L_lw_v0f:
    ds_read_b128 v[24:27], v13 offset:0
    s_add_u32 s67, s67, 1
    s_waitcnt lgkmcnt(0)
    v_min_u32 v24, v24, v25
    v_min3_u32 v24, v24, v26, v27
    s_nop 0
    v_readfirstlane_b32 s74, v24
    s_cmp_gt_u32 s67, 1600000
    s_cbranch_scc1 L_lx_v0f
    s_cmp_lt_u32 s74, s73
    s_cbranch_scc1 L_lw_v0f
L_lx_v0f:
    ds_read_b64_tr_b16 v[48:49], v6 offset:0
    ds_read_b64_tr_b16 v[50:51], v6 offset:544
    ds_read_b64_tr_b16 v[52:53], v6 offset:2176
    ds_read_b64_tr_b16 v[54:55], v6 offset:2720
    ds_read_b64_tr_b16 v[56:57], v6 offset:4352
    ds_read_b64_tr_b16 v[58:59], v6 offset:4896
    ds_read_b64_tr_b16 v[60:61], v6 offset:6528
    ds_read_b64_tr_b16 v[62:63], v6 offset:7072
    ds_read_b64_tr_b16 v[64:65], v6 offset:8704
    ds_read_b64_tr_b16 v[66:67], v6 offset:9248
    ds_read_b64_tr_b16 v[68:69], v6 offset:10880
    ds_read_b64_tr_b16 v[70:71], v6 offset:11424
    s_waitcnt lgkmcnt(8)
    ds_read_b64_tr_b16 v[24:25], v6 offset:13056
    ds_read_b64_tr_b16 v[26:27], v6 offset:13600
    ds_read_b64_tr_b16 v[28:29], v6 offset:15232
    ds_read_b64_tr_b16 v[30:31], v6 offset:15776
    v_mfma_f32_32x32x16_bf16 v[32:47], v[48:51], v[72:75], 0
    v_mfma_f32_32x32x16_bf16 v[32:47], v[52:55], v[76:79], v[32:47]
    s_waitcnt lgkmcnt(8)
    v_mfma_f32_32x32x16_bf16 v[32:47], v[56:59], v[80:83], v[32:47]
    v_mfma_f32_32x32x16_bf16 v[32:47], v[60:63], v[84:87], v[32:47]
    s_waitcnt lgkmcnt(4)
    v_mfma_f32_32x32x16_bf16 v[32:47], v[64:67], v[88:91], v[32:47]
    v_mfma_f32_32x32x16_bf16 v[32:47], v[68:71], v[92:95], v[32:47]
    s_waitcnt lgkmcnt(0)
    v_mfma_f32_32x32x16_bf16 v[32:47], v[24:27], v[96:99], v[32:47]
    v_mfma_f32_32x32x16_bf16 v[32:47], v[28:31], v[100:103], v[32:47]
    v_mov_b32 v7, 1
    s_mov_b64 exec, 1
    ds_add_u32 v13, v7 offset:48
    s_mov_b64 exec, -1
    s_waitcnt vmcnt(11)
    v_cmp_ne_u32 vcc, s39, v110
    s_nop 0
    s_cmp_eq_u64 vcc, 0
    s_cbranch_scc1 L_pok_z0f
    s_mov_b32 s67, 0
L_poll_z0f:
    s_sleep 1
    buffer_load_dword v110, v111, s[28:31], s62 offen sc1
    s_waitcnt vmcnt(0)
    v_cmp_ne_u32 vcc, s39, v110
    s_nop 0
    s_cmp_eq_u64 vcc, 0
    s_cbranch_scc1 L_pok_z0f
    s_add_u32 s67, s67, 1
    s_cmp_gt_u32 s67, 200000
    s_cbranch_scc0 L_poll_z0f
L_pok_z0f:
    s_mov_b32 s72, 0
    s_mov_b32 s73, 0x41900000
    s_add_u32 s74, s63, 4096
    s_nop 7
    s_nop 1
    v_cvt_f64_f32 v[48:49], v32
    v_add_f64 v[48:49], v[48:49], s[72:73]
    buffer_atomic_add_f64 v[48:49], v1, s[28:31], s63 offen offset:0
    v_cvt_f64_f32 v[50:51], v33
    v_add_f64 v[50:51], v[50:51], s[72:73]
    buffer_atomic_add_f64 v[50:51], v1, s[28:31], s63 offen offset:256
    v_cvt_f64_f32 v[52:53], v34
    v_add_f64 v[52:53], v[52:53], s[72:73]
    buffer_atomic_add_f64 v[52:53], v1, s[28:31], s63 offen offset:512
    v_cvt_f64_f32 v[54:55], v35
    v_add_f64 v[54:55], v[54:55], s[72:73]
    buffer_atomic_add_f64 v[54:55], v1, s[28:31], s63 offen offset:768
    v_cvt_f64_f32 v[56:57], v36
    v_add_f64 v[56:57], v[56:57], s[72:73]
    buffer_atomic_add_f64 v[56:57], v1, s[28:31], s63 offen offset:2048
    v_cvt_f64_f32 v[58:59], v37
    v_add_f64 v[58:59], v[58:59], s[72:73]
    buffer_atomic_add_f64 v[58:59], v1, s[28:31], s63 offen offset:2304
    v_cvt_f64_f32 v[60:61], v38
    v_add_f64 v[60:61], v[60:61], s[72:73]
    buffer_atomic_add_f64 v[60:61], v1, s[28:31], s63 offen offset:2560
    v_cvt_f64_f32 v[62:63], v39
    v_add_f64 v[62:63], v[62:63], s[72:73]
    buffer_atomic_add_f64 v[62:63], v1, s[28:31], s63 offen offset:2816
    v_cvt_f64_f32 v[64:65], v40
    v_add_f64 v[64:65], v[64:65], s[72:73]
    s_mov_b32 exec_hi, 0
    buffer_atomic_add_f64 v[64:65], v1, s[28:31], s74 offen offset:0
    s_mov_b64 exec, -1
    s_setprio 0
    s_waitcnt vmcnt(15)
    buffer_load_dwordx4 v[156:159], v11, s[28:31], s34 offen offset:1024 sc1
    s_lshl_b32 s34, s14, 1
    s_waitcnt vmcnt(15)
    buffer_load_dwordx4 v[160:163], v11, s[28:31], s34 offen offset:0 sc1
    s_waitcnt vmcnt(15)
    buffer_load_dwordx4 v[164:167], v11, s[28:31], s34 offen offset:1024 sc1
    s_lshl_b32 s34, s15, 1
    s_waitcnt vmcnt(15)
    buffer_load_dwordx4 v[168:171], v11, s[28:31], s34 offen offset:0 sc1
    s_waitcnt vmcnt(15)
    buffer_load_dwordx4 v[172:175], v11, s[28:31], s34 offen offset:1024 sc1
    s_lshl_b32 s34, s16, 1
    s_waitcnt vmcnt(15)
    buffer_load_dwordx4 v[176:179], v11, s[28:31], s34 offen offset:0 sc1
    s_waitcnt vmcnt(15)
    buffer_load_dwordx4 v[180:183], v11, s[28:31], s34 offen offset:1024 sc1
    s_lshl_b32 s34, s17, 1
    s_waitcnt vmcnt(15)
    buffer_load_dwordx4 v[184:187], v11, s[28:31], s34 offen offset:0 sc1
    s_waitcnt vmcnt(15)
    buffer_load_dwordx4 v[188:191], v11, s[28:31], s34 offen offset:1024 sc1
    s_lshl_b32 s34, s18, 1
    s_waitcnt vmcnt(15)
    buffer_load_dwordx4 v[192:195], v11, s[28:31], s34 offen offset:0 sc1
    s_waitcnt vmcnt(15)
    buffer_load_dwordx4 v[196:199], v11, s[28:31], s34 offen offset:1024 sc1
    s_lshl_b32 s34, s19, 1
    s_waitcnt vmcnt(15)
    buffer_load_dwordx4 v[200:203], v11, s[28:31], s34 offen offset:0 sc1
    s_waitcnt vmcnt(15)
    buffer_load_dwordx4 v[204:207], v11, s[28:31], s34 offen offset:1024 sc1
    s_lshl_b32 s34, s20, 1
    s_waitcnt vmcnt(15)
    buffer_load_dwordx4 v[208:211], v11, s[28:31], s34 offen offset:0 sc1
    s_waitcnt vmcnt(15)
    buffer_load_dwordx4 v[212:215], v11, s[28:31], s34 offen offset:1024 sc1
    s_lshl_b32 s34, s21, 1
    s_waitcnt vmcnt(15)
    buffer_load_dwordx4 v[216:219], v11, s[28:31], s34 offen offset:0 sc1
    s_waitcnt vmcnt(15)
    buffer_load_dwordx4 v[220:223], v11, s[28:31], s34 offen offset:1024 sc1
    s_lshl_b32 s34, s22, 1
    s_waitcnt vmcnt(15)
    buffer_load_dwordx4 v[224:227], v11, s[28:31], s34 offen offset:0 sc1
    s_waitcnt vmcnt(15)
    buffer_load_dwordx4 v[228:231], v11, s[28:31], s34 offen offset:1024 sc1
    s_lshl_b32 s34, s23, 1
    s_waitcnt vmcnt(15)
    buffer_load_dwordx4 v[232:235], v11, s[28:31], s34 offen offset:0 sc1
    s_waitcnt vmcnt(15)
    buffer_load_dwordx4 v[236:239], v11, s[28:31], s34 offen offset:1024 sc1
    s_lshl_b32 s34, s32, 1
    s_waitcnt vmcnt(15)
    buffer_load_dwordx4 v[240:243], v11, s[28:31], s34 offen offset:0 sc1
    s_waitcnt vmcnt(15)
    buffer_load_dwordx4 v[244:247], v11, s[28:31], s34 offen offset:1024 sc1
    s_lshl_b32 s34, s33, 1
    s_waitcnt vmcnt(15)
    buffer_load_dwordx4 v[248:251], v11, s[28:31], s34 offen offset:0 sc1
    s_waitcnt vmcnt(15)
    buffer_load_dwordx4 v[252:255], v11, s[28:31], s34 offen offset:1024 sc1
    s_branch L_p2h
L_slow0:
    buffer_load_dword v110, v111, s[28:31], s62 offen sc1
    s_waitcnt vmcnt(1)
    s_barrier
    s_setprio 3
    s_lshl_b32 s72, s70, 9
    v_add_u32 v6, s72, v6
    ds_read_b64_tr_b16 v[16:17], v6
    ds_read_b64_tr_b16 v[18:19], v6 offset:256
    ds_read_b128 v[88:91], v15 offset:0
    ds_read_b128 v[92:95], v15 offset:4096
    ds_read_b128 v[96:99], v15 offset:8192
    ds_read_b128 v[100:103], v15 offset:12288
    v_lshlrev_b32 v6, 2, v2
    v_add_u32 v6, 157696, v6
    ds_read_b32 v8, v6 offset:0
    ds_read_b32 v10, v6 offset:128
    ds_read_b32 v104, v6 offset:256
    ds_read_b32 v106, v6 offset:384
    s_mul_i32 s72, s70, 2304
    s_add_u32 s72, s72, 82944
    v_mul_u32_u24 v6, 72, v2
    v_lshl_add_u32 v6, v3, 3, v6
    v_add_u32 v12, s72, v6
    v_lshl_add_u32 v6, v3, 3, v4
    v_mul_u32_u24 v7, 72, v6
    v_lshl_add_u32 v7, v5, 3, v7
    v_bfe_u32 v1, v0, 4, 1
    v_lshl_add_u32 v7, v1, 5, v7
    v_add_u32 v7, s72, v7
    s_waitcnt lgkmcnt(7)
    v_mfma_f32_32x32x16_bf16 v[32:47], v[16:19], v[88:91], 0
    v_mul_u32_u24 v6, 136, v6
    s_lshl_b32 s72, s70, 5
    v_lshl_add_u32 v108, v5, 3, s72
    v_cmp_eq_u32 vcc, 1, v1
    v_mov_b32 v109, 128
    s_nop 0
    v_cndmask_b32 v108, v108, v109, vcc
    v_add_u32 v6, v6, v108
    v_add_u32 v6, 65536, v6
    v_bfe_u32 v1, v0, 2, 1
    v_lshlrev_b32 v1, 7, v1
    v_bfe_u32 v108, v0, 3, 2
    v_lshl_add_u32 v1, v108, 5, v1
    v_lshl_add_u32 v1, v5, 3, v1
    v_lshl_add_u32 v1, v3, 10, v1
    s_waitcnt lgkmcnt(0)
    v_mul_f32 v8, 1069066811, v8
    v_mul_f32 v10, 1069066811, v10
    v_mul_f32 v104, 1069066811, v104
    v_mul_f32 v106, 1069066811, v106
    v_max3_f32 v48, v32, v33, v34
    v_min3_f32 v50, v32, v33, v34
    v_max3_f32 v52, v35, v36, v37
    v_min3_f32 v53, v35, v36, v37
    v_max3_f32 v48, v48, v38, v39
    v_min3_f32 v50, v50, v38, v39
    v_max_f32 v48, v48, v52
    v_min_f32 v50, v50, v53
    v_sub_f32 v50, 0, v50
    s_nop 1
    v_permlane32_swap_b32 v48, v50
    v_max_f32 v48, v48, v50
    v_mul_f32 v48, v48, -v8
    v_mov_b32 v50, v48
    s_nop 1
    v_permlane32_swap_b32 v48, v50
    v_fma_f32 v54, v32, v8, v48
    v_fma_f32 v62, -v32, v8, v50
    v_fma_f32 v55, v33, v8, v48
    v_fma_f32 v63, -v33, v8, v50
    v_fma_f32 v56, v34, v8, v48
    v_fma_f32 v64, -v34, v8, v50
    v_fma_f32 v57, v35, v8, v48
    v_fma_f32 v65, -v35, v8, v50
    v_fma_f32 v58, v36, v8, v48
    v_fma_f32 v66, -v36, v8, v50
    v_fma_f32 v59, v37, v8, v48
    v_fma_f32 v67, -v37, v8, v50
    v_fma_f32 v60, v38, v8, v48
    v_fma_f32 v68, -v38, v8, v50
    v_fma_f32 v61, v39, v8, v48
    v_fma_f32 v69, -v39, v8, v50
    v_mfma_f32_32x32x16_bf16 v[32:47], v[16:19], v[92:95], 0
    v_exp_f32 v54, v54
    v_exp_f32 v55, v55
    v_exp_f32 v56, v56
    v_exp_f32 v57, v57
    v_exp_f32 v58, v58
    v_exp_f32 v59, v59
    v_exp_f32 v60, v60
    v_exp_f32 v61, v61
    v_exp_f32 v62, v62
    v_exp_f32 v63, v63
    v_exp_f32 v64, v64
    v_exp_f32 v65, v65
    v_exp_f32 v66, v66
    v_exp_f32 v67, v67
    v_exp_f32 v68, v68
    v_exp_f32 v69, v69
    v_add_f32 v48, v54, v55
    v_add_f32 v49, v56, v57
    v_add_f32 v52, v58, v59
    v_add_f32 v50, v62, v63
    v_add_f32 v51, v64, v65
    v_add_f32 v53, v66, v67
    v_add_f32 v48, v48, v60
    v_add_f32 v49, v49, v61
    v_add_f32 v50, v50, v68
    v_add_f32 v51, v51, v69
    v_add_f32 v48, v48, v52
    v_add_f32 v50, v50, v53
    v_add_f32 v48, v48, v49
    v_add_f32 v50, v50, v51
    s_nop 1
    v_permlane32_swap_b32 v48, v50
    v_add_f32 v48, v48, v50
    v_rcp_f32 v48, v48
    s_nop 0
    v_mov_b32 v50, v48
    s_nop 1
    v_permlane32_swap_b32 v48, v50
    v_mul_f32 v54, v54, v48
    v_mul_f32 v62, v62, v50
    v_mul_f32 v55, v55, v48
    v_mul_f32 v63, v63, v50
    v_mul_f32 v56, v56, v48
    v_mul_f32 v64, v64, v50
    v_mul_f32 v57, v57, v48
    v_mul_f32 v65, v65, v50
    v_mul_f32 v58, v58, v48
    v_mul_f32 v66, v66, v50
    v_mul_f32 v59, v59, v48
    v_mul_f32 v67, v67, v50
    v_mul_f32 v60, v60, v48
    v_mul_f32 v68, v68, v50
    v_mul_f32 v61, v61, v48
    v_mul_f32 v69, v69, v50
    v_cvt_pk_bf16_f32 v24, v54, v55
    v_cvt_pk_bf16_f32 v25, v56, v57
    v_cvt_pk_bf16_f32 v26, v58, v59
    v_cvt_pk_bf16_f32 v27, v60, v61
    v_cvt_pk_bf16_f32 v28, v62, v63
    v_cvt_pk_bf16_f32 v29, v64, v65
    v_cvt_pk_bf16_f32 v30, v66, v67
    v_cvt_pk_bf16_f32 v31, v68, v69
    ds_write_b64 v12, v[24:25] offset:0
    ds_write_b64 v12, v[26:27] offset:16
    ds_write_b64 v12, v[28:29] offset:32
    ds_write_b64 v12, v[30:31] offset:48
    ds_read_b64_tr_b16 v[72:73], v7 offset:0
    ds_read_b64_tr_b16 v[74:75], v7 offset:288
    ds_read_b64_tr_b16 v[76:77], v7 offset:1152
    ds_read_b64_tr_b16 v[78:79], v7 offset:1440
    v_max3_f32 v48, v32, v33, v34
    v_min3_f32 v50, v32, v33, v34
    v_max3_f32 v52, v35, v36, v37
    v_min3_f32 v53, v35, v36, v37
    v_max3_f32 v48, v48, v38, v39
    v_min3_f32 v50, v50, v38, v39
    v_max_f32 v48, v48, v52
    v_min_f32 v50, v50, v53
    v_sub_f32 v50, 0, v50
    s_nop 1
    v_permlane32_swap_b32 v48, v50
    v_max_f32 v48, v48, v50
    v_mul_f32 v48, v48, -v10
    v_mov_b32 v50, v48
    s_nop 1
    v_permlane32_swap_b32 v48, v50
    v_fma_f32 v54, v32, v10, v48
    v_fma_f32 v62, -v32, v10, v50
    v_fma_f32 v55, v33, v10, v48
    v_fma_f32 v63, -v33, v10, v50
    v_fma_f32 v56, v34, v10, v48
    v_fma_f32 v64, -v34, v10, v50
    v_fma_f32 v57, v35, v10, v48
    v_fma_f32 v65, -v35, v10, v50
    v_fma_f32 v58, v36, v10, v48
    v_fma_f32 v66, -v36, v10, v50
    v_fma_f32 v59, v37, v10, v48
    v_fma_f32 v67, -v37, v10, v50
    v_fma_f32 v60, v38, v10, v48
    v_fma_f32 v68, -v38, v10, v50
    v_fma_f32 v61, v39, v10, v48
    v_fma_f32 v69, -v39, v10, v50
    v_mfma_f32_32x32x16_bf16 v[32:47], v[16:19], v[96:99], 0
    v_exp_f32 v54, v54
    v_exp_f32 v55, v55
    v_exp_f32 v56, v56
    v_exp_f32 v57, v57
    v_exp_f32 v58, v58
    v_exp_f32 v59, v59
    v_exp_f32 v60, v60
    v_exp_f32 v61, v61
    v_exp_f32 v62, v62
    v_exp_f32 v63, v63
    v_exp_f32 v64, v64
    v_exp_f32 v65, v65
    v_exp_f32 v66, v66
    v_exp_f32 v67, v67
    v_exp_f32 v68, v68
    v_exp_f32 v69, v69
    v_add_f32 v48, v54, v55
    v_add_f32 v49, v56, v57
    v_add_f32 v52, v58, v59
    v_add_f32 v50, v62, v63
    v_add_f32 v51, v64, v65
    v_add_f32 v53, v66, v67
    v_add_f32 v48, v48, v60
    v_add_f32 v49, v49, v61
    v_add_f32 v50, v50, v68
    v_add_f32 v51, v51, v69
    v_add_f32 v48, v48, v52
    v_add_f32 v50, v50, v53
    v_add_f32 v48, v48, v49
    v_add_f32 v50, v50, v51
    s_nop 1
    v_permlane32_swap_b32 v48, v50
    v_add_f32 v48, v48, v50
    v_rcp_f32 v48, v48
    s_nop 0
    v_mov_b32 v50, v48
    s_nop 1
    v_permlane32_swap_b32 v48, v50
    v_mul_f32 v54, v54, v48
    v_mul_f32 v62, v62, v50
    v_mul_f32 v55, v55, v48
    v_mul_f32 v63, v63, v50
    v_mul_f32 v56, v56, v48
    v_mul_f32 v64, v64, v50
    v_mul_f32 v57, v57, v48
    v_mul_f32 v65, v65, v50
    v_mul_f32 v58, v58, v48
    v_mul_f32 v66, v66, v50
    v_mul_f32 v59, v59, v48
    v_mul_f32 v67, v67, v50
    v_mul_f32 v60, v60, v48
    v_mul_f32 v68, v68, v50
    v_mul_f32 v61, v61, v48
    v_mul_f32 v69, v69, v50
    v_cvt_pk_bf16_f32 v24, v54, v55
    v_cvt_pk_bf16_f32 v25, v56, v57
    v_cvt_pk_bf16_f32 v26, v58, v59
    v_cvt_pk_bf16_f32 v27, v60, v61
    v_cvt_pk_bf16_f32 v28, v62, v63
    v_cvt_pk_bf16_f32 v29, v64, v65
    v_cvt_pk_bf16_f32 v30, v66, v67
    v_cvt_pk_bf16_f32 v31, v68, v69
    ds_write_b64 v12, v[24:25] offset:0
    ds_write_b64 v12, v[26:27] offset:16
    ds_write_b64 v12, v[28:29] offset:32
    ds_write_b64 v12, v[30:31] offset:48
    ds_read_b64_tr_b16 v[80:81], v7 offset:0
    ds_read_b64_tr_b16 v[82:83], v7 offset:288
    ds_read_b64_tr_b16 v[84:85], v7 offset:1152
    ds_read_b64_tr_b16 v[86:87], v7 offset:1440
    v_max3_f32 v48, v32, v33, v34
    v_min3_f32 v50, v32, v33, v34
    v_max3_f32 v52, v35, v36, v37
    v_min3_f32 v53, v35, v36, v37
    v_max3_f32 v48, v48, v38, v39
    v_min3_f32 v50, v50, v38, v39
    v_max_f32 v48, v48, v52
    v_min_f32 v50, v50, v53
    v_sub_f32 v50, 0, v50
    s_nop 1
    v_permlane32_swap_b32 v48, v50
    v_max_f32 v48, v48, v50
    v_mul_f32 v48, v48, -v104
    v_mov_b32 v50, v48
    s_nop 1
    v_permlane32_swap_b32 v48, v50
    v_fma_f32 v54, v32, v104, v48
    v_fma_f32 v62, -v32, v104, v50
    v_fma_f32 v55, v33, v104, v48
    v_fma_f32 v63, -v33, v104, v50
    v_fma_f32 v56, v34, v104, v48
    v_fma_f32 v64, -v34, v104, v50
    v_fma_f32 v57, v35, v104, v48
    v_fma_f32 v65, -v35, v104, v50
    v_fma_f32 v58, v36, v104, v48
    v_fma_f32 v66, -v36, v104, v50
    v_fma_f32 v59, v37, v104, v48
    v_fma_f32 v67, -v37, v104, v50
    v_fma_f32 v60, v38, v104, v48
    v_fma_f32 v68, -v38, v104, v50
    v_fma_f32 v61, v39, v104, v48
    v_fma_f32 v69, -v39, v104, v50
    v_mfma_f32_32x32x16_bf16 v[32:47], v[16:19], v[100:103], 0
    v_exp_f32 v54, v54
    v_exp_f32 v55, v55
    v_exp_f32 v56, v56
    v_exp_f32 v57, v57
    v_exp_f32 v58, v58
    v_exp_f32 v59, v59
    v_exp_f32 v60, v60
    v_exp_f32 v61, v61
    v_exp_f32 v62, v62
    v_exp_f32 v63, v63
    v_exp_f32 v64, v64
    v_exp_f32 v65, v65
    v_exp_f32 v66, v66
    v_exp_f32 v67, v67
    v_exp_f32 v68, v68
    v_exp_f32 v69, v69
    v_add_f32 v48, v54, v55
    v_add_f32 v49, v56, v57
    v_add_f32 v52, v58, v59
    v_add_f32 v50, v62, v63
    v_add_f32 v51, v64, v65
    v_add_f32 v53, v66, v67
    v_add_f32 v48, v48, v60
    v_add_f32 v49, v49, v61
    v_add_f32 v50, v50, v68
    v_add_f32 v51, v51, v69
    v_add_f32 v48, v48, v52
    v_add_f32 v50, v50, v53
    v_add_f32 v48, v48, v49
    v_add_f32 v50, v50, v51
    s_nop 1
    v_permlane32_swap_b32 v48, v50
    v_add_f32 v48, v48, v50
    v_rcp_f32 v48, v48
    s_nop 0
    v_mov_b32 v50, v48
    s_nop 1
    v_permlane32_swap_b32 v48, v50
    v_mul_f32 v54, v54, v48
    v_mul_f32 v62, v62, v50
    v_mul_f32 v55, v55, v48
    v_mul_f32 v63, v63, v50
    v_mul_f32 v56, v56, v48
    v_mul_f32 v64, v64, v50
    v_mul_f32 v57, v57, v48
    v_mul_f32 v65, v65, v50
    v_mul_f32 v58, v58, v48
    v_mul_f32 v66, v66, v50
    v_mul_f32 v59, v59, v48
    v_mul_f32 v67, v67, v50
    v_mul_f32 v60, v60, v48
    v_mul_f32 v68, v68, v50
    v_mul_f32 v61, v61, v48
    v_mul_f32 v69, v69, v50
    v_cvt_pk_bf16_f32 v24, v54, v55
    v_cvt_pk_bf16_f32 v25, v56, v57
    v_cvt_pk_bf16_f32 v26, v58, v59
    v_cvt_pk_bf16_f32 v27, v60, v61
    v_cvt_pk_bf16_f32 v28, v62, v63
    v_cvt_pk_bf16_f32 v29, v64, v65
    v_cvt_pk_bf16_f32 v30, v66, v67
    v_cvt_pk_bf16_f32 v31, v68, v69
    ds_write_b64 v12, v[24:25] offset:0
    ds_write_b64 v12, v[26:27] offset:16
    ds_write_b64 v12, v[28:29] offset:32
    ds_write_b64 v12, v[30:31] offset:48
    ds_read_b64_tr_b16 v[88:89], v7 offset:0
    ds_read_b64_tr_b16 v[90:91], v7 offset:288
    ds_read_b64_tr_b16 v[92:93], v7 offset:1152
    ds_read_b64_tr_b16 v[94:95], v7 offset:1440
    v_max3_f32 v48, v32, v33, v34
    v_min3_f32 v50, v32, v33, v34
    v_max3_f32 v52, v35, v36, v37
    v_min3_f32 v53, v35, v36, v37
    v_max3_f32 v48, v48, v38, v39
    v_min3_f32 v50, v50, v38, v39
    v_max_f32 v48, v48, v52
    v_min_f32 v50, v50, v53
    v_sub_f32 v50, 0, v50
    s_nop 1
    v_permlane32_swap_b32 v48, v50
    v_max_f32 v48, v48, v50
    v_mul_f32 v48, v48, -v106
    v_mov_b32 v50, v48
    s_nop 1
    v_permlane32_swap_b32 v48, v50
    v_fma_f32 v54, v32, v106, v48
    v_fma_f32 v62, -v32, v106, v50
    v_fma_f32 v55, v33, v106, v48
    v_fma_f32 v63, -v33, v106, v50
    v_fma_f32 v56, v34, v106, v48
    v_fma_f32 v64, -v34, v106, v50
    v_fma_f32 v57, v35, v106, v48
    v_fma_f32 v65, -v35, v106, v50
    v_fma_f32 v58, v36, v106, v48
    v_fma_f32 v66, -v36, v106, v50
    v_fma_f32 v59, v37, v106, v48
    v_fma_f32 v67, -v37, v106, v50
    v_fma_f32 v60, v38, v106, v48
    v_fma_f32 v68, -v38, v106, v50
    v_fma_f32 v61, v39, v106, v48
    v_fma_f32 v69, -v39, v106, v50
    v_exp_f32 v54, v54
    v_exp_f32 v55, v55
    v_exp_f32 v56, v56
    v_exp_f32 v57, v57
    v_exp_f32 v58, v58
    v_exp_f32 v59, v59
    v_exp_f32 v60, v60
    v_exp_f32 v61, v61
    v_exp_f32 v62, v62
    v_exp_f32 v63, v63
    v_exp_f32 v64, v64
    v_exp_f32 v65, v65
    v_exp_f32 v66, v66
    v_exp_f32 v67, v67
    v_exp_f32 v68, v68
    v_exp_f32 v69, v69
    v_add_f32 v48, v54, v55
    v_add_f32 v49, v56, v57
    v_add_f32 v52, v58, v59
    v_add_f32 v50, v62, v63
    v_add_f32 v51, v64, v65
    v_add_f32 v53, v66, v67
    v_add_f32 v48, v48, v60
    v_add_f32 v49, v49, v61
    v_add_f32 v50, v50, v68
    v_add_f32 v51, v51, v69
    v_add_f32 v48, v48, v52
    v_add_f32 v50, v50, v53
    v_add_f32 v48, v48, v49
    v_add_f32 v50, v50, v51
    s_nop 1
    v_permlane32_swap_b32 v48, v50
    v_add_f32 v48, v48, v50
    v_rcp_f32 v48, v48
    s_nop 0
    v_mov_b32 v50, v48
    s_nop 1
    v_permlane32_swap_b32 v48, v50
    v_mul_f32 v54, v54, v48
    v_mul_f32 v62, v62, v50
    v_mul_f32 v55, v55, v48
    v_mul_f32 v63, v63, v50
    v_mul_f32 v56, v56, v48
    v_mul_f32 v64, v64, v50
    v_mul_f32 v57, v57, v48
    v_mul_f32 v65, v65, v50
    v_mul_f32 v58, v58, v48
    v_mul_f32 v66, v66, v50
    v_mul_f32 v59, v59, v48
    v_mul_f32 v67, v67, v50
    v_mul_f32 v60, v60, v48
    v_mul_f32 v68, v68, v50
    v_mul_f32 v61, v61, v48
    v_mul_f32 v69, v69, v50
    v_cvt_pk_bf16_f32 v24, v54, v55
    v_cvt_pk_bf16_f32 v25, v56, v57
    v_cvt_pk_bf16_f32 v26, v58, v59
    v_cvt_pk_bf16_f32 v27, v60, v61
    v_cvt_pk_bf16_f32 v28, v62, v63
    v_cvt_pk_bf16_f32 v29, v64, v65
    v_cvt_pk_bf16_f32 v30, v66, v67
    v_cvt_pk_bf16_f32 v31, v68, v69
    ds_write_b64 v12, v[24:25] offset:0
    ds_write_b64 v12, v[26:27] offset:16
    ds_write_b64 v12, v[28:29] offset:32
    ds_write_b64 v12, v[30:31] offset:48
    ds_read_b64_tr_b16 v[96:97], v7 offset:0
    ds_read_b64_tr_b16 v[98:99], v7 offset:288
    ds_read_b64_tr_b16 v[100:101], v7 offset:1152
    ds_read_b64_tr_b16 v[102:103], v7 offset:1440
    s_lshr_b32 s72, s70, 1
    s_add_u32 s73, s72, 2
    s_mov_b32 s67, 0
L_lw_v0s:
    ds_read_b128 v[24:27], v13 offset:0
    s_add_u32 s67, s67, 1
    s_waitcnt lgkmcnt(0)
    v_min_u32 v24, v24, v25
    v_min3_u32 v24, v24, v26, v27
    s_nop 0
    v_readfirstlane_b32 s74, v24
    s_cmp_gt_u32 s67, 1600000
    s_cbranch_scc1 L_lx_v0s
    s_cmp_lt_u32 s74, s73
    s_cbranch_scc1 L_lw_v0s
L_lx_v0s:
    ds_read_b64_tr_b16 v[48:49], v6 offset:0
    ds_read_b64_tr_b16 v[50:51], v6 offset:544
    ds_read_b64_tr_b16 v[52:53], v6 offset:2176
    ds_read_b64_tr_b16 v[54:55], v6 offset:2720
    ds_read_b64_tr_b16 v[56:57], v6 offset:4352
    ds_read_b64_tr_b16 v[58:59], v6 offset:4896
    ds_read_b64_tr_b16 v[60:61], v6 offset:6528
    ds_read_b64_tr_b16 v[62:63], v6 offset:7072
    ds_read_b64_tr_b16 v[64:65], v6 offset:8704
    ds_read_b64_tr_b16 v[66:67], v6 offset:9248
    ds_read_b64_tr_b16 v[68:69], v6 offset:10880
    ds_read_b64_tr_b16 v[70:71], v6 offset:11424
    s_waitcnt lgkmcnt(8)
    ds_read_b64_tr_b16 v[24:25], v6 offset:13056
    ds_read_b64_tr_b16 v[26:27], v6 offset:13600
    ds_read_b64_tr_b16 v[28:29], v6 offset:15232
    ds_read_b64_tr_b16 v[30:31], v6 offset:15776
    v_mfma_f32_32x32x16_bf16 v[32:47], v[48:51], v[72:75], 0
    v_mfma_f32_32x32x16_bf16 v[32:47], v[52:55], v[76:79], v[32:47]
    s_waitcnt lgkmcnt(8)
    v_mfma_f32_32x32x16_bf16 v[32:47], v[56:59], v[80:83], v[32:47]
    v_mfma_f32_32x32x16_bf16 v[32:47], v[60:63], v[84:87], v[32:47]
    s_waitcnt lgkmcnt(4)
    v_mfma_f32_32x32x16_bf16 v[32:47], v[64:67], v[88:91], v[32:47]
    v_mfma_f32_32x32x16_bf16 v[32:47], v[68:71], v[92:95], v[32:47]
    s_waitcnt lgkmcnt(0)
    v_mfma_f32_32x32x16_bf16 v[32:47], v[24:27], v[96:99], v[32:47]
    v_mfma_f32_32x32x16_bf16 v[32:47], v[28:31], v[100:103], v[32:47]
    v_mov_b32 v7, 1
    s_mov_b64 exec, 1
    ds_add_u32 v13, v7 offset:48
    s_mov_b64 exec, -1
    s_waitcnt vmcnt(0)
    v_cmp_ne_u32 vcc, s39, v110
    s_nop 0
    s_cmp_eq_u64 vcc, 0
    s_cbranch_scc1 L_pok_z0s
    s_mov_b32 s67, 0
L_poll_z0s:
    s_sleep 1
    buffer_load_dword v110, v111, s[28:31], s62 offen sc1
    s_waitcnt vmcnt(0)
    v_cmp_ne_u32 vcc, s39, v110
    s_nop 0
    s_cmp_eq_u64 vcc, 0
    s_cbranch_scc1 L_pok_z0s
    s_add_u32 s67, s67, 1
    s_cmp_gt_u32 s67, 200000
    s_cbranch_scc0 L_poll_z0s
L_pok_z0s:
    s_mov_b32 s72, 0
    s_mov_b32 s73, 0x41900000
    s_add_u32 s74, s63, 4096
    s_nop 7
    s_nop 1
    v_cvt_f64_f32 v[48:49], v32
    v_add_f64 v[48:49], v[48:49], s[72:73]
    buffer_atomic_add_f64 v[48:49], v1, s[28:31], s63 offen offset:0
    v_cvt_f64_f32 v[50:51], v33
    v_add_f64 v[50:51], v[50:51], s[72:73]
    buffer_atomic_add_f64 v[50:51], v1, s[28:31], s63 offen offset:256
    v_cvt_f64_f32 v[52:53], v34
    v_add_f64 v[52:53], v[52:53], s[72:73]
    buffer_atomic_add_f64 v[52:53], v1, s[28:31], s63 offen offset:512
    v_cvt_f64_f32 v[54:55], v35
    v_add_f64 v[54:55], v[54:55], s[72:73]
    buffer_atomic_add_f64 v[54:55], v1, s[28:31], s63 offen offset:768
    v_cvt_f64_f32 v[56:57], v36
    v_add_f64 v[56:57], v[56:57], s[72:73]
    buffer_atomic_add_f64 v[56:57], v1, s[28:31], s63 offen offset:2048
    v_cvt_f64_f32 v[58:59], v37
    v_add_f64 v[58:59], v[58:59], s[72:73]
    buffer_atomic_add_f64 v[58:59], v1, s[28:31], s63 offen offset:2304
    v_cvt_f64_f32 v[60:61], v38
    v_add_f64 v[60:61], v[60:61], s[72:73]
    buffer_atomic_add_f64 v[60:61], v1, s[28:31], s63 offen offset:2560
    v_cvt_f64_f32 v[62:63], v39
    v_add_f64 v[62:63], v[62:63], s[72:73]
    buffer_atomic_add_f64 v[62:63], v1, s[28:31], s63 offen offset:2816
    v_cvt_f64_f32 v[64:65], v40
    v_add_f64 v[64:65], v[64:65], s[72:73]
    s_mov_b32 exec_hi, 0
    buffer_atomic_add_f64 v[64:65], v1, s[28:31], s74 offen offset:0
    s_mov_b64 exec, -1
    s_setprio 0
    v_and_b32 v26, 7, v0
    v_lshlrev_b32 v26, 2, v26
    s_mov_b32 s67, 0
L_poll_bt0:
    s_sleep 1
    buffer_load_dword v27, v26, s[28:31], s61 offen sc1
    s_waitcnt vmcnt(0)
    v_cmp_ne_u32 vcc, s39, v27
    s_nop 0
    s_cmp_eq_u64 vcc, 0
    s_cbranch_scc1 L_pok_bt0
    s_add_u32 s67, s67, 1
    s_cmp_gt_u32 s67, 200000
    s_cbranch_scc0 L_poll_bt0
L_pok_bt0:
    s_lshl_b32 s34, s8, 1
    buffer_load_dwordx4 v[112:115], v11, s[28:31], s34 offen offset:0 sc1
    buffer_load_dwordx4 v[116:119], v11, s[28:31], s34 offen offset:1024 sc1
    s_lshl_b32 s34, s9, 1
    buffer_load_dwordx4 v[120:123], v11, s[28:31], s34 offen offset:0 sc1
    buffer_load_dwordx4 v[124:127], v11, s[28:31], s34 offen offset:1024 sc1
    s_lshl_b32 s34, s10, 1
    buffer_load_dwordx4 v[128:131], v11, s[28:31], s34 offen offset:0 sc1
    buffer_load_dwordx4 v[132:135], v11, s[28:31], s34 offen offset:1024 sc1
    s_lshl_b32 s34, s11, 1
    buffer_load_dwordx4 v[136:139], v11, s[28:31], s34 offen offset:0 sc1
    buffer_load_dwordx4 v[140:143], v11, s[28:31], s34 offen offset:1024 sc1
    s_lshl_b32 s34, s12, 1
    buffer_load_dwordx4 v[144:147], v11, s[28:31], s34 offen offset:0 sc1
    buffer_load_dwordx4 v[148:151], v11, s[28:31], s34 offen offset:1024 sc1
    s_lshl_b32 s34, s13, 1
    buffer_load_dwordx4 v[152:155], v11, s[28:31], s34 offen offset:0 sc1
    buffer_load_dwordx4 v[156:159], v11, s[28:31], s34 offen offset:1024 sc1
    s_lshl_b32 s34, s14, 1
    buffer_load_dwordx4 v[160:163], v11, s[28:31], s34 offen offset:0 sc1
    buffer_load_dwordx4 v[164:167], v11, s[28:31], s34 offen offset:1024 sc1
    s_lshl_b32 s34, s15, 1
    buffer_load_dwordx4 v[168:171], v11, s[28:31], s34 offen offset:0 sc1
    buffer_load_dwordx4 v[172:175], v11, s[28:31], s34 offen offset:1024 sc1
    s_lshl_b32 s34, s16, 1
    s_waitcnt vmcnt(15)
    buffer_load_dwordx4 v[176:179], v11, s[28:31], s34 offen offset:0 sc1
    s_waitcnt vmcnt(15)
    buffer_load_dwordx4 v[180:183], v11, s[28:31], s34 offen offset:1024 sc1
    s_lshl_b32 s34, s17, 1
    s_waitcnt vmcnt(15)
    buffer_load_dwordx4 v[184:187], v11, s[28:31], s34 offen offset:0 sc1
    s_waitcnt vmcnt(15)
    buffer_load_dwordx4 v[188:191], v11, s[28:31], s34 offen offset:1024 sc1
    s_lshl_b32 s34, s18, 1
    s_waitcnt vmcnt(15)
    buffer_load_dwordx4 v[192:195], v11, s[28:31], s34 offen offset:0 sc1
    s_waitcnt vmcnt(15)
    buffer_load_dwordx4 v[196:199], v11, s[28:31], s34 offen offset:1024 sc1
    s_lshl_b32 s34, s19, 1
    s_waitcnt vmcnt(15)
    buffer_load_dwordx4 v[200:203], v11, s[28:31], s34 offen offset:0 sc1
    s_waitcnt vmcnt(15)
    buffer_load_dwordx4 v[204:207], v11, s[28:31], s34 offen offset:1024 sc1
    s_lshl_b32 s34, s20, 1
    s_waitcnt vmcnt(15)
    buffer_load_dwordx4 v[208:211], v11, s[28:31], s34 offen offset:0 sc1
    s_waitcnt vmcnt(15)
    buffer_load_dwordx4 v[212:215], v11, s[28:31], s34 offen offset:1024 sc1
    s_lshl_b32 s34, s21, 1
    s_waitcnt vmcnt(15)
    buffer_load_dwordx4 v[216:219], v11, s[28:31], s34 offen offset:0 sc1
    s_waitcnt vmcnt(15)
    buffer_load_dwordx4 v[220:223], v11, s[28:31], s34 offen offset:1024 sc1
    s_lshl_b32 s34, s22, 1
    s_waitcnt vmcnt(15)
    buffer_load_dwordx4 v[224:227], v11, s[28:31], s34 offen offset:0 sc1
    s_waitcnt vmcnt(15)
    buffer_load_dwordx4 v[228:231], v11, s[28:31], s34 offen offset:1024 sc1
    s_lshl_b32 s34, s23, 1
    s_waitcnt vmcnt(15)
    buffer_load_dwordx4 v[232:235], v11, s[28:31], s34 offen offset:0 sc1
    s_waitcnt vmcnt(15)
    buffer_load_dwordx4 v[236:239], v11, s[28:31], s34 offen offset:1024 sc1
    s_lshl_b32 s34, s32, 1
    s_waitcnt vmcnt(15)
    buffer_load_dwordx4 v[240:243], v11, s[28:31], s34 offen offset:0 sc1
    s_waitcnt vmcnt(15)
    buffer_load_dwordx4 v[244:247], v11, s[28:31], s34 offen offset:1024 sc1
    s_lshl_b32 s34, s33, 1
    s_waitcnt vmcnt(15)
    buffer_load_dwordx4 v[248:251], v11, s[28:31], s34 offen offset:0 sc1
    s_waitcnt vmcnt(15)
    buffer_load_dwordx4 v[252:255], v11, s[28:31], s34 offen offset:1024 sc1
    s_branch L_p2h
L_hq:
    v_mul_u32_u24 v16, 3584, v2
    s_add_u32 s72, s65, 128
    v_add3_u32 v16, v16, v3, s72
    v_add_u32 v17, 27648, v16
    v_add_u32 v18, 128, v16
    v_add_u32 v19, 128, v17
    s_mul_i32 s74, s43, 229376
    s_waitcnt lgkmcnt(0)
    s_mov_b32 s12, s60
    s_and_b32 s13, s61, 0xffff
    s_mov_b32 s14, 1835008
    s_mov_b32 s15, 0x00020000
    s_add_u32 m0, s69, 16384
    s_nop 0
    buffer_load_dwordx4 v16, s[12:15], s74 offen offset:0 lds
    buffer_load_dwordx4 v17, s[12:15], s74 offen offset:1024 lds
    s_add_u32 m0, s69, 24576
    s_nop 0
    buffer_load_dwordx4 v18, s[12:15], s74 offen offset:0 lds
    buffer_load_dwordx4 v19, s[12:15], s74 offen offset:1024 lds
    s_add_u32 s74, s58, 19070976
    s_addc_u32 s75, s59, 0
    s_load_dword s99, s[74:75], 0
    s_mov_b32 s8, s46
    s_and_b32 s9, s47, 0xffff
    s_mov_b32 s10, 1572864
    s_mov_b32 s11, 0x00020000
    v_lshlrev_b32 v14, 4, v0
    s_mov_b32 s4, s44
    s_and_b32 s5, s45, 0xffff
    s_mov_b32 s6, 2097152
    s_mov_b32 s7, 0x00020000
    v_lshrrev_b32 v4, 3, v0
    s_lshl_b32 s71, s36, 2
    s_add_u32 s71, s71, s70
    s_lshl_b32 s71, s71, 15
    v_lshl_add_u32 v4, v4, 10, s71
    v_lshrrev_b32 v5, 4, v0
    v_and_b32 v6, 7, v0
    v_mov_b32 v7, v5
    v_xor_b32 v7, v7, v6
    v_lshl_add_u32 v8, v7, 4, v4
    v_add_u32 v7, 4, v5
    v_xor_b32 v7, v7, v6
    v_lshl_add_u32 v9, v7, 4, v4
    v_add_u32 v9, 7168, v9
    v_add_u32 v10, 14336, v8
    v_add_u32 v11, 14336, v9
    s_lshl_b32 s68, s70, 12
    s_add_u32 s74, s43, 2
    s_and_b32 s74, s74, 7
    s_lshl_b32 s75, s74, 7
    s_add_u32 m0, s68, 32768
    s_mul_i32 s74, s74, 229376
    buffer_load_dwordx4 v8, s[4:7], s75 offen offset:0 lds
    buffer_load_dwordx4 v9, s[4:7], s75 offen offset:1024 lds
    buffer_load_dwordx4 v10, s[4:7], s75 offen offset:2048 lds
    buffer_load_dwordx4 v11, s[4:7], s75 offen offset:3072 lds
    s_add_u32 m0, s69, 49152
    s_nop 0
    buffer_load_dwordx4 v16, s[12:15], s74 offen offset:0 lds
    buffer_load_dwordx4 v17, s[12:15], s74 offen offset:1024 lds
    s_add_u32 m0, s69, 57344
    s_nop 0
    buffer_load_dwordx4 v18, s[12:15], s74 offen offset:0 lds
    buffer_load_dwordx4 v19, s[12:15], s74 offen offset:1024 lds
    v_mul_u32_u24 v20, 3072, v2
    s_lshl_b32 s72, s100, 7
    v_add3_u32 v20, v20, v3, s72
    v_add_u32 v21, 23552, v20
    s_mul_i32 s75, s43, 196608
    s_add_u32 m0, s69, 131072
    s_nop 0
    buffer_load_dwordx4 v20, s[8:11], s75 offen offset:0 lds
    buffer_load_dwordx4 v21, s[8:11], s75 offen offset:1024 lds
    s_cmp_eq_u32 s66, 0
    s_cselect_b32 s72, 512, 0
    s_add_u32 s72, s72, s65
    s_sub_u32 s72, s72, 128
    v_mul_u32_u24 v22, 3584, v2
    v_add3_u32 v22, v22, v3, s72
    v_add_u32 v23, 27648, v22
    s_mul_i32 s75, s43, 229376
    s_add_u32 m0, s69, 139264
    s_nop 0
    buffer_load_dwordx4 v22, s[12:15], s75 offen offset:0 lds
    buffer_load_dwordx4 v23, s[12:15], s75 offen offset:1024 lds
    s_add_u32 s72, s72, s66
    v_lshrrev_b32 v4, 2, v0
    v_add_u32 v4, s64, v4
    v_mul_u32_u24 v4, 3584, v4
    v_and_b32 v5, 3, v0
    v_lshl_add_u32 v4, v5, 4, v4
    v_add_u32 v24, s72, v4
    s_mov_b32 s24, s48
    s_and_b32 s25, s49, 0xffff
    s_mov_b32 s26, 16384
    s_mov_b32 s27, 0x00020000
    s_lshl_b32 s72, s100, 11
    s_lshl_b32 s73, s70, 9
    s_add_u32 s72, s72, s73
    s_add_u32 m0, s73, 160320
    s_mov_b32 exec_hi, 0
    buffer_load_dwordx4 v14, s[24:27], s72 offen lds
    s_mov_b32 exec_hi, -1
    s_mov_b32 s28, s58
    s_and_b32 s29, s59, 0xffff
    s_mov_b32 s30, 134217728
    s_mov_b32 s31, 0x00020000
    v_mov_b32 v4, 160256
    v_mov_b32 v28, 0
    v_mov_b32 v29, 0
    v_mov_b32 v30, 0
    v_mov_b32 v31, 0
    ds_write_b128 v4, v[28:31] offset:0
    ds_write_b128 v4, v[28:31] offset:16
    ds_write_b128 v4, v[28:31] offset:32
    ds_write_b128 v4, v[28:31] offset:48
    s_waitcnt lgkmcnt(0)
    s_waitcnt vmcnt(13)
    s_barrier
    s_add_u32 s74, s43, 4
    s_and_b32 s74, s74, 7
    s_lshl_b32 s75, s74, 7
    s_add_u32 m0, s68, 65536
    s_mul_i32 s74, s74, 229376
    s_waitcnt vmcnt(8)
    buffer_load_dwordx4 v8, s[4:7], s75 offen offset:0 lds
    s_waitcnt vmcnt(8)
    buffer_load_dwordx4 v9, s[4:7], s75 offen offset:1024 lds
    s_waitcnt vmcnt(8)
    buffer_load_dwordx4 v10, s[4:7], s75 offen offset:2048 lds
    s_waitcnt vmcnt(8)
    buffer_load_dwordx4 v11, s[4:7], s75 offen offset:3072 lds
    s_add_u32 m0, s69, 81920
    s_waitcnt vmcnt(8)
    buffer_load_dwordx4 v16, s[12:15], s74 offen offset:0 lds
    s_waitcnt vmcnt(8)
    buffer_load_dwordx4 v17, s[12:15], s74 offen offset:1024 lds
    s_add_u32 m0, s69, 90112
    s_waitcnt vmcnt(8)
    buffer_load_dwordx4 v18, s[12:15], s74 offen offset:0 lds
    s_waitcnt vmcnt(8)
    buffer_load_dwordx4 v19, s[12:15], s74 offen offset:1024 lds
    s_barrier
    s_add_u32 s74, s43, 6
    s_and_b32 s74, s74, 7
    s_lshl_b32 s75, s74, 7
    s_add_u32 m0, s68, 98304
    s_mul_i32 s74, s74, 229376
    s_waitcnt vmcnt(8)
    buffer_load_dwordx4 v8, s[4:7], s75 offen offset:0 lds
    s_waitcnt vmcnt(8)
    buffer_load_dwordx4 v9, s[4:7], s75 offen offset:1024 lds
    s_waitcnt vmcnt(8)
    buffer_load_dwordx4 v10, s[4:7], s75 offen offset:2048 lds
    s_waitcnt vmcnt(8)
    buffer_load_dwordx4 v11, s[4:7], s75 offen offset:3072 lds
    s_add_u32 m0, s69, 114688
    s_waitcnt vmcnt(8)
    buffer_load_dwordx4 v16, s[12:15], s74 offen offset:0 lds
    s_waitcnt vmcnt(8)
    buffer_load_dwordx4 v17, s[12:15], s74 offen offset:1024 lds
    s_add_u32 m0, s69, 122880
    s_waitcnt vmcnt(8)
    buffer_load_dwordx4 v18, s[12:15], s74 offen offset:0 lds
    s_waitcnt vmcnt(8)
    buffer_load_dwordx4 v19, s[12:15], s74 offen offset:1024 lds
    s_waitcnt vmcnt(8)
    s_barrier
    s_add_u32 s74, s43, 1
    s_and_b32 s74, s74, 7
    s_lshl_b32 s75, s74, 7
    s_add_u32 m0, s68, 0
    s_mul_i32 s74, s74, 229376
    buffer_load_dwordx4 v8, s[4:7], s75 offen offset:0 lds
    s_waitcnt vmcnt(8)
    buffer_load_dwordx4 v9, s[4:7], s75 offen offset:1024 lds
    s_waitcnt vmcnt(8)
    buffer_load_dwordx4 v10, s[4:7], s75 offen offset:2048 lds
    s_waitcnt vmcnt(8)
    buffer_load_dwordx4 v11, s[4:7], s75 offen offset:3072 lds
    s_add_u32 m0, s69, 16384
    s_waitcnt vmcnt(8)
    buffer_load_dwordx4 v16, s[12:15], s74 offen offset:0 lds
    s_waitcnt vmcnt(8)
    buffer_load_dwordx4 v17, s[12:15], s74 offen offset:1024 lds
    s_add_u32 m0, s69, 24576
    s_waitcnt vmcnt(8)
    buffer_load_dwordx4 v18, s[12:15], s74 offen offset:0 lds
    s_waitcnt vmcnt(8)
    buffer_load_dwordx4 v19, s[12:15], s74 offen offset:1024 lds
    s_lshl_b32 s37, s100, 1
    s_add_u32 s37, s37, s101
    s_and_b32 s40, s42, 3
    s_lshl_b32 s41, s3, 2
    s_add_u32 s40, s40, s41
    s_lshr_b32 s41, s42, 2
    s_and_b32 s72, s42, 3
    s_lshl_b32 s96, s72, 1
    s_add_u32 s96, s96, s38
    s_and_b32 s96, s96, 7
    s_and_b32 s72, s72, 1
    s_lshl_b32 s73, s72, 2
    s_add_u32 s97, s41, s73
    s_and_b32 s97, s97, 7
    s_lshl_b32 s73, s72, 1
    s_add_u32 s98, s41, s73
    s_and_b32 s98, s98, 3
    s_mov_b32 s24, s56
    s_and_b32 s25, s57, 0xffff
    s_mov_b32 s26, 2097152
    s_mov_b32 s27, 0x00020000
    v_and_b32 v26, 7, v0
    v_lshlrev_b32 v26, 2, v26
    s_lshl_b32 s61, s41, 3
    s_add_u32 s61, s61, s96
    s_lshl_b32 s61, s61, 5
    s_add_u32 s61, s61, 19136512
    s_mul_i32 s39, s99, 0x9E3779B1
    s_add_u32 s39, s39, 0x7F4A7C15
    s_and_b32 s52, s99, 3
    s_xor_b32 s53, s52, 1
    s_bfe_u32 s54, s99, 0x20002
    s_bfe_u32 s55, s99, 0x20004
    s_mul_i32 s52, s52, 0x40008000
    s_and_b32 s52, s52, 0x80008000
    s_mul_i32 s53, s53, 0x40008000
    s_and_b32 s53, s53, 0x80008000
    s_mul_i32 s54, s54, 0x40008000
    s_and_b32 s54, s54, 0x80008000
    s_mul_i32 s55, s55, 0x40008000
    s_and_b32 s55, s55, 0x80008000
    s_waitcnt vmcnt(8)
    s_barrier
    s_add_u32 s74, s43, 3
    s_and_b32 s74, s74, 7
    s_lshl_b32 s75, s74, 7
    s_add_u32 m0, s68, 32768
    s_mul_i32 s74, s74, 229376
    buffer_load_dwordx4 v8, s[4:7], s75 offen offset:0 lds
    s_waitcnt vmcnt(8)
    buffer_load_dwordx4 v9, s[4:7], s75 offen offset:1024 lds
    s_waitcnt vmcnt(8)
    buffer_load_dwordx4 v10, s[4:7], s75 offen offset:2048 lds
    s_waitcnt vmcnt(8)
    buffer_load_dwordx4 v11, s[4:7], s75 offen offset:3072 lds
    s_add_u32 m0, s69, 49152
    s_waitcnt vmcnt(8)
    buffer_load_dwordx4 v16, s[12:15], s74 offen offset:0 lds
    s_waitcnt vmcnt(8)
    buffer_load_dwordx4 v17, s[12:15], s74 offen offset:1024 lds
    s_add_u32 m0, s69, 57344
    s_waitcnt vmcnt(8)
    buffer_load_dwordx4 v18, s[12:15], s74 offen offset:0 lds
    s_waitcnt vmcnt(8)
    buffer_load_dwordx4 v19, s[12:15], s74 offen offset:1024 lds
    s_waitcnt vmcnt(8)
    s_barrier
    s_add_u32 s74, s43, 5
    s_and_b32 s74, s74, 7
    s_lshl_b32 s75, s74, 7
    s_add_u32 m0, s68, 65536
    s_mul_i32 s74, s74, 229376
    buffer_load_dwordx4 v8, s[4:7], s75 offen offset:0 lds
    s_waitcnt vmcnt(8)
    buffer_load_dwordx4 v9, s[4:7], s75 offen offset:1024 lds
    s_waitcnt vmcnt(8)
    buffer_load_dwordx4 v10, s[4:7], s75 offen offset:2048 lds
    s_waitcnt vmcnt(8)
    buffer_load_dwordx4 v11, s[4:7], s75 offen offset:3072 lds
    s_add_u32 m0, s69, 81920
    s_waitcnt vmcnt(8)
    buffer_load_dwordx4 v16, s[12:15], s74 offen offset:0 lds
    s_waitcnt vmcnt(8)
    buffer_load_dwordx4 v17, s[12:15], s74 offen offset:1024 lds
    s_add_u32 m0, s69, 90112
    s_waitcnt vmcnt(8)
    buffer_load_dwordx4 v18, s[12:15], s74 offen offset:0 lds
    s_waitcnt vmcnt(8)
    buffer_load_dwordx4 v19, s[12:15], s74 offen offset:1024 lds
    s_waitcnt vmcnt(8)
    s_barrier
    s_add_u32 s74, s43, 7
    s_and_b32 s74, s74, 7
    s_lshl_b32 s75, s74, 7
    s_add_u32 m0, s68, 98304
    s_mul_i32 s74, s74, 229376
    buffer_load_dwordx4 v8, s[4:7], s75 offen offset:0 lds
    s_waitcnt vmcnt(8)
    buffer_load_dwordx4 v9, s[4:7], s75 offen offset:1024 lds
    s_waitcnt vmcnt(8)
    buffer_load_dwordx4 v10, s[4:7], s75 offen offset:2048 lds
    s_waitcnt vmcnt(8)
    buffer_load_dwordx4 v11, s[4:7], s75 offen offset:3072 lds
    s_add_u32 m0, s69, 114688
    s_waitcnt vmcnt(8)
    buffer_load_dwordx4 v16, s[12:15], s74 offen offset:0 lds
    s_waitcnt vmcnt(8)
    buffer_load_dwordx4 v17, s[12:15], s74 offen offset:1024 lds
    s_add_u32 m0, s69, 122880
    s_waitcnt vmcnt(8)
    buffer_load_dwordx4 v18, s[12:15], s74 offen offset:0 lds
    s_waitcnt vmcnt(8)
    buffer_load_dwordx4 v19, s[12:15], s74 offen offset:1024 lds
    s_waitcnt vmcnt(8)
    s_barrier
    s_add_u32 s74, s43, 2
    s_and_b32 s74, s74, 7
    s_mul_i32 s75, s74, 196608
    s_add_u32 m0, s69, 8192
    s_nop 0
    buffer_load_dwordx4 v20, s[8:11], s75 offen offset:0 lds
    s_waitcnt vmcnt(8)
    buffer_load_dwordx4 v21, s[8:11], s75 offen offset:1024 lds
    s_add_u32 s74, s43, 4
    s_and_b32 s74, s74, 7
    s_mul_i32 s75, s74, 196608
    s_add_u32 m0, s69, 16384
    s_waitcnt vmcnt(8)
    buffer_load_dwordx4 v20, s[8:11], s75 offen offset:0 lds
    s_waitcnt vmcnt(8)
    buffer_load_dwordx4 v21, s[8:11], s75 offen offset:1024 lds
    s_add_u32 s74, s43, 6
    s_and_b32 s74, s74, 7
    s_mul_i32 s75, s74, 196608
    s_add_u32 m0, s69, 24576
    s_waitcnt vmcnt(8)
    buffer_load_dwordx4 v20, s[8:11], s75 offen offset:0 lds
    s_waitcnt vmcnt(8)
    buffer_load_dwordx4 v21, s[8:11], s75 offen offset:1024 lds
    s_add_u32 s74, s43, 1
    s_and_b32 s74, s74, 7
    s_mul_i32 s75, s74, 196608
    s_add_u32 m0, s69, 32768
    s_waitcnt vmcnt(8)
    buffer_load_dwordx4 v20, s[8:11], s75 offen offset:0 lds
    s_waitcnt vmcnt(8)
    buffer_load_dwordx4 v21, s[8:11], s75 offen offset:1024 lds
    s_waitcnt vmcnt(8)
    s_barrier
    s_add_u32 s74, s43, 3
    s_and_b32 s74, s74, 7
    s_mul_i32 s75, s74, 196608
    s_add_u32 m0, s69, 40960
    s_nop 0
    buffer_load_dwordx4 v20, s[8:11], s75 offen offset:0 lds
    s_waitcnt vmcnt(8)
    buffer_load_dwordx4 v21, s[8:11], s75 offen offset:1024 lds
    s_add_u32 s74, s43, 5
    s_and_b32 s74, s74, 7
    s_mul_i32 s75, s74, 196608
    s_add_u32 m0, s69, 49152
    s_waitcnt vmcnt(8)
    buffer_load_dwordx4 v20, s[8:11], s75 offen offset:0 lds
    s_waitcnt vmcnt(8)
    buffer_load_dwordx4 v21, s[8:11], s75 offen offset:1024 lds
    s_add_u32 s74, s43, 7
    s_and_b32 s74, s74, 7
    s_mul_i32 s75, s74, 196608
    s_add_u32 m0, s69, 57344
    s_waitcnt vmcnt(8)
    buffer_load_dwordx4 v20, s[8:11], s75 offen offset:0 lds
    s_waitcnt vmcnt(8)
    buffer_load_dwordx4 v21, s[8:11], s75 offen offset:1024 lds
    s_waitcnt vmcnt(8)
    s_barrier
    buffer_load_dword v27, v26, s[28:31], s61 offen sc1
    s_lshl_b32 s72, s70, 10
    s_add_u32 s74, s43, 2
    s_and_b32 s74, s74, 7
    s_mul_i32 s75, s74, 229376
    s_add_u32 m0, s72, 69632
    s_waitcnt vmcnt(8)
    buffer_load_dwordx4 v24, s[12:15], s75 offen lds
    s_add_u32 s74, s43, 4
    s_and_b32 s74, s74, 7
    s_mul_i32 s75, s74, 229376
    s_add_u32 m0, s72, 73728
    s_waitcnt vmcnt(8)
    buffer_load_dwordx4 v24, s[12:15], s75 offen lds
    s_add_u32 s74, s43, 6
    s_and_b32 s74, s74, 7
    s_mul_i32 s75, s74, 229376
    s_add_u32 m0, s72, 77824
    s_waitcnt vmcnt(8)
    buffer_load_dwordx4 v24, s[12:15], s75 offen lds
    s_add_u32 s74, s43, 1
    s_and_b32 s74, s74, 7
    s_mul_i32 s75, s74, 229376
    s_add_u32 m0, s72, 81920
    s_waitcnt vmcnt(8)
    buffer_load_dwordx4 v24, s[12:15], s75 offen lds
    s_add_u32 s74, s43, 3
    s_and_b32 s74, s74, 7
    s_mul_i32 s75, s74, 229376
    s_add_u32 m0, s72, 86016
    s_waitcnt vmcnt(8)
    buffer_load_dwordx4 v24, s[12:15], s75 offen lds
    s_add_u32 s74, s43, 5
    s_and_b32 s74, s74, 7
    s_mul_i32 s75, s74, 229376
    s_add_u32 m0, s72, 90112
    s_waitcnt vmcnt(8)
    buffer_load_dwordx4 v24, s[12:15], s75 offen lds
    s_add_u32 s74, s43, 7
    s_and_b32 s74, s74, 7
    s_mul_i32 s75, s74, 229376
    s_add_u32 m0, s72, 94208
    s_waitcnt vmcnt(8)
    buffer_load_dwordx4 v24, s[12:15], s75 offen lds
    s_add_u32 s8, s97, 0
    s_and_b32 s8, s8, 7
    s_lshl_b32 s8, s8, 10
    s_add_u32 s9, s97, 1
    s_and_b32 s9, s9, 7
    s_lshl_b32 s9, s9, 10
    s_add_u32 s10, s97, 2
    s_and_b32 s10, s10, 7
    s_lshl_b32 s10, s10, 10
    s_add_u32 s11, s97, 3
    s_and_b32 s11, s11, 7
    s_lshl_b32 s11, s11, 10
    s_add_u32 s12, s97, 4
    s_and_b32 s12, s12, 7
    s_lshl_b32 s12, s12, 10
    s_add_u32 s13, s97, 5
    s_and_b32 s13, s13, 7
    s_lshl_b32 s13, s13, 10
    s_add_u32 s14, s97, 6
    s_and_b32 s14, s14, 7
    s_lshl_b32 s14, s14, 10
    s_add_u32 s15, s97, 7
    s_and_b32 s15, s15, 7
    s_lshl_b32 s15, s15, 10
    s_add_u32 s16, s98, 0
    s_and_b32 s16, s16, 3
    s_lshl_b32 s16, s16, 10
    s_add_u32 s16, s16, 8192
    s_add_u32 s17, s98, 1
    s_and_b32 s17, s17, 3
    s_lshl_b32 s17, s17, 10
    s_add_u32 s17, s17, 8192
    s_add_u32 s18, s98, 2
    s_and_b32 s18, s18, 3
    s_lshl_b32 s18, s18, 10
    s_add_u32 s18, s18, 8192
    s_add_u32 s19, s98, 3
    s_and_b32 s19, s19, 3
    s_lshl_b32 s19, s19, 10
    s_add_u32 s19, s19, 8192
    s_mov_b32 s20, 12288
    s_mov_b32 s21, 13312
    s_add_u32 s22, s16, 6144
    s_add_u32 s23, s17, 6144
    s_add_u32 s32, s18, 6144
    s_add_u32 s33, s19, 6144
    s_lshl_b32 s72, s96, 3
    s_add_u32 s72, s72, s41
    s_mul_i32 s72, s72, 36864
    s_add_u32 s72, s72, 20971520
    v_add_u32 v11, s72, v14
    v_lshrrev_b32 v3, 5, v0
    v_bfe_u32 v4, v0, 2, 2
    v_and_b32 v5, 3, v0
    v_and_b32 v2, 31, v0
    v_lshl_add_u32 v6, v3, 2, v4
    v_lshlrev_b32 v6, 5, v6
    v_lshl_add_u32 v6, v5, 3, v6
    v_add_u32 v6, 160320, v6
    s_add_u32 s72, s69, 98304
    v_add_u32 v15, s72, v14
    v_mov_b32 v13, 160256
    s_lshl_b32 s72, s100, 2
    s_add_u32 s72, s72, s70
    s_lshl_b32 s62, s72, 2
    s_add_u32 s62, s62, 19005440
    s_mul_i32 s63, s72, 4352
    s_add_u32 s63, s63, 17825792
    s_lshl_b32 s60, s72, 7
    s_add_u32 s60, s60, 18939904
    v_mov_b32 v111, 0
    s_waitcnt vmcnt(8)
    s_barrier
    s_lshl_b32 s72, s70, 2
    v_add_u32 v12, s72, v13
    v_mov_b32 v7, 1
    s_waitcnt vmcnt(0)
    ds_write_b32 v12, v7 offset:16
    v_cmp_ne_u32 vcc, s39, v27
    s_nop 0
    s_cmp_eq_u64 vcc, 0
    s_cbranch_scc1 L_pok_bt1
    s_mov_b32 s67, 0
L_poll_bt1:
    s_sleep 1
    buffer_load_dword v27, v26, s[28:31], s61 offen sc1
    s_waitcnt vmcnt(0)
    v_cmp_ne_u32 vcc, s39, v27
    s_nop 0
    s_cmp_eq_u64 vcc, 0
    s_cbranch_scc1 L_pok_bt1
    s_add_u32 s67, s67, 1
    s_cmp_gt_u32 s67, 200000
    s_cbranch_scc0 L_poll_bt1
L_pok_bt1:
    buffer_load_dword v110, v111, s[28:31], s62 offen sc1
    s_lshl_b32 s34, s8, 1
    buffer_load_dwordx4 v[112:115], v11, s[28:31], s34 offen offset:0 sc1
    buffer_load_dwordx4 v[116:119], v11, s[28:31], s34 offen offset:1024 sc1
    s_lshl_b32 s34, s9, 1
    buffer_load_dwordx4 v[120:123], v11, s[28:31], s34 offen offset:0 sc1
    buffer_load_dwordx4 v[124:127], v11, s[28:31], s34 offen offset:1024 sc1
    s_lshl_b32 s34, s10, 1
    buffer_load_dwordx4 v[128:131], v11, s[28:31], s34 offen offset:0 sc1
    buffer_load_dwordx4 v[132:135], v11, s[28:31], s34 offen offset:1024 sc1
    s_lshl_b32 s34, s11, 1
    buffer_load_dwordx4 v[136:139], v11, s[28:31], s34 offen offset:0 sc1
    buffer_load_dwordx4 v[140:143], v11, s[28:31], s34 offen offset:1024 sc1
    s_lshl_b32 s34, s12, 1
    buffer_load_dwordx4 v[144:147], v11, s[28:31], s34 offen offset:0 sc1
    buffer_load_dwordx4 v[148:151], v11, s[28:31], s34 offen offset:1024 sc1
    s_lshl_b32 s34, s13, 1
    buffer_load_dwordx4 v[152:155], v11, s[28:31], s34 offen offset:0 sc1
    buffer_load_dwordx4 v[156:159], v11, s[28:31], s34 offen offset:1024 sc1
    s_lshl_b32 s34, s14, 1
    buffer_load_dwordx4 v[160:163], v11, s[28:31], s34 offen offset:0 sc1
    buffer_load_dwordx4 v[164:167], v11, s[28:31], s34 offen offset:1024 sc1
    s_lshl_b32 s34, s15, 1
    buffer_load_dwordx4 v[168:171], v11, s[28:31], s34 offen offset:0 sc1
    buffer_load_dwordx4 v[172:175], v11, s[28:31], s34 offen offset:1024 sc1
    s_lshl_b32 s34, s16, 1
    buffer_load_dwordx4 v[176:179], v11, s[28:31], s34 offen offset:0 sc1
    buffer_load_dwordx4 v[180:183], v11, s[28:31], s34 offen offset:1024 sc1
    s_lshl_b32 s34, s17, 1
    buffer_load_dwordx4 v[184:187], v11, s[28:31], s34 offen offset:0 sc1
    buffer_load_dwordx4 v[188:191], v11, s[28:31], s34 offen offset:1024 sc1
    s_setprio 3
    ds_read_b64_tr_b16 v[16:17], v6 offset:0
    ds_read_b64_tr_b16 v[18:19], v6 offset:256
    ds_read_b64_tr_b16 v[100:101], v6 offset:512
    ds_read_b64_tr_b16 v[102:103], v6 offset:768
    ds_read_b64_tr_b16 v[104:105], v6 offset:1024
    ds_read_b64_tr_b16 v[106:107], v6 offset:1280
    ds_read_b64_tr_b16 v[88:89], v6 offset:1536
    ds_read_b64_tr_b16 v[90:91], v6 offset:1792
    v_lshlrev_b32 v6, 2, v2
    s_lshl_b32 s72, s70, 7
    s_add_u32 s72, s72, 157696
    v_add_u32 v6, s72, v6
    ds_read_b32 v8, v6
    s_waitcnt lgkmcnt(0)
    v_mul_f32 v8, 1069066811, v8
    s_mov_b32 s67, 0
L_lw_q01:
    ds_read_b32 v1, v12 offset:0
    s_add_u32 s67, s67, 1
    s_waitcnt lgkmcnt(0)
    v_readfirstlane_b32 s74, v1
    s_cmp_gt_u32 s67, 1600000
    s_cbranch_scc1 L_lx_q01
    s_cmp_lt_u32 s74, 1
    s_cbranch_scc1 L_lw_q01
L_lx_q01:
    ds_read_b128 v[72:75], v15 offset:0
    ds_read_b128 v[76:79], v15 offset:1024
    s_waitcnt lgkmcnt(1)
    v_mfma_f32_32x32x16_bf16 v[32:47], v[16:19], v[72:75], 0
    s_waitcnt lgkmcnt(0)
    s_nop 10
    v_max3_f32 v48, v32, v33, v34
    v_min3_f32 v50, v32, v33, v34
    v_max3_f32 v52, v35, v36, v37
    v_min3_f32 v53, v35, v36, v37
    v_max3_f32 v48, v48, v38, v39
    v_min3_f32 v50, v50, v38, v39
    v_max_f32 v48, v48, v52
    v_min_f32 v50, v50, v53
    v_sub_f32 v50, 0, v50
    s_nop 1
    v_permlane32_swap_b32 v48, v50
    v_max_f32 v48, v48, v50
    v_mul_f32 v48, v48, -v8
    v_mov_b32 v50, v48
    s_nop 1
    v_permlane32_swap_b32 v48, v50
    v_fma_f32 v54, v32, v8, v48
    v_fma_f32 v62, -v32, v8, v50
    v_fma_f32 v55, v33, v8, v48
    v_fma_f32 v63, -v33, v8, v50
    v_fma_f32 v56, v34, v8, v48
    v_fma_f32 v64, -v34, v8, v50
    v_fma_f32 v57, v35, v8, v48
    v_fma_f32 v65, -v35, v8, v50
    v_fma_f32 v58, v36, v8, v48
    v_fma_f32 v66, -v36, v8, v50
    v_fma_f32 v59, v37, v8, v48
    v_fma_f32 v67, -v37, v8, v50
    v_fma_f32 v60, v38, v8, v48
    v_fma_f32 v68, -v38, v8, v50
    v_fma_f32 v61, v39, v8, v48
    v_fma_f32 v69, -v39, v8, v50
    v_mfma_f32_32x32x16_bf16 v[32:47], v[100:103], v[76:79], 0
    v_exp_f32 v54, v54
    v_exp_f32 v55, v55
    v_exp_f32 v56, v56
    v_exp_f32 v57, v57
    v_exp_f32 v58, v58
    v_exp_f32 v59, v59
    v_exp_f32 v60, v60
    v_exp_f32 v61, v61
    v_exp_f32 v62, v62
    v_exp_f32 v63, v63
    v_exp_f32 v64, v64
    v_exp_f32 v65, v65
    v_exp_f32 v66, v66
    v_exp_f32 v67, v67
    v_exp_f32 v68, v68
    v_exp_f32 v69, v69
    v_add_f32 v48, v54, v55
    v_add_f32 v49, v56, v57
    v_add_f32 v52, v58, v59
    v_add_f32 v50, v62, v63
    v_add_f32 v51, v64, v65
    v_add_f32 v53, v66, v67
    v_add_f32 v48, v48, v60
    v_add_f32 v49, v49, v61
    v_add_f32 v50, v50, v68
    v_add_f32 v51, v51, v69
    v_add_f32 v48, v48, v52
    v_add_f32 v50, v50, v53
    v_add_f32 v48, v48, v49
    v_add_f32 v50, v50, v51
    s_nop 1
    v_permlane32_swap_b32 v48, v50
    v_add_f32 v48, v48, v50
    v_rcp_f32 v48, v48
    s_nop 0
    v_mov_b32 v50, v48
    s_nop 1
    v_permlane32_swap_b32 v48, v50
    v_mul_f32 v54, v54, v48
    v_mul_f32 v62, v62, v50
    v_mul_f32 v55, v55, v48
    v_mul_f32 v63, v63, v50
    v_mul_f32 v56, v56, v48
    v_mul_f32 v64, v64, v50
    v_mul_f32 v57, v57, v48
    v_mul_f32 v65, v65, v50
    v_mul_f32 v58, v58, v48
    v_mul_f32 v66, v66, v50
    v_mul_f32 v59, v59, v48
    v_mul_f32 v67, v67, v50
    v_mul_f32 v60, v60, v48
    v_mul_f32 v68, v68, v50
    v_mul_f32 v61, v61, v48
    v_mul_f32 v69, v69, v50
    v_cvt_pk_bf16_f32 v24, v54, v55
    v_cvt_pk_bf16_f32 v25, v56, v57
    v_cvt_pk_bf16_f32 v26, v58, v59
    v_cvt_pk_bf16_f32 v27, v60, v61
    v_cvt_pk_bf16_f32 v28, v62, v63
    v_cvt_pk_bf16_f32 v29, v64, v65
    v_cvt_pk_bf16_f32 v30, v66, v67
    v_cvt_pk_bf16_f32 v31, v68, v69
    ds_write_b128 v15, v[24:27] offset:16384
    ds_write_b128 v15, v[28:31] offset:17408
    v_max3_f32 v48, v32, v33, v34
    v_min3_f32 v50, v32, v33, v34
    v_max3_f32 v52, v35, v36, v37
    v_min3_f32 v53, v35, v36, v37
    v_max3_f32 v48, v48, v38, v39
    v_min3_f32 v50, v50, v38, v39
    v_max_f32 v48, v48, v52
    v_min_f32 v50, v50, v53
    v_sub_f32 v50, 0, v50
    s_nop 1
    v_permlane32_swap_b32 v48, v50
    v_max_f32 v48, v48, v50
    v_mul_f32 v48, v48, -v8
    v_mov_b32 v50, v48
    s_nop 1
    v_permlane32_swap_b32 v48, v50
    v_fma_f32 v54, v32, v8, v48
    v_fma_f32 v62, -v32, v8, v50
    v_fma_f32 v55, v33, v8, v48
    v_fma_f32 v63, -v33, v8, v50
    v_fma_f32 v56, v34, v8, v48
    v_fma_f32 v64, -v34, v8, v50
    v_fma_f32 v57, v35, v8, v48
    v_fma_f32 v65, -v35, v8, v50
    v_fma_f32 v58, v36, v8, v48
    v_fma_f32 v66, -v36, v8, v50
    v_fma_f32 v59, v37, v8, v48
    v_fma_f32 v67, -v37, v8, v50
    v_fma_f32 v60, v38, v8, v48
    v_fma_f32 v68, -v38, v8, v50
    v_fma_f32 v61, v39, v8, v48
    v_fma_f32 v69, -v39, v8, v50
    v_exp_f32 v54, v54
    v_exp_f32 v55, v55
    v_exp_f32 v56, v56
    v_exp_f32 v57, v57
    v_exp_f32 v58, v58
    v_exp_f32 v59, v59
    v_exp_f32 v60, v60
    v_exp_f32 v61, v61
    v_exp_f32 v62, v62
    v_exp_f32 v63, v63
    v_exp_f32 v64, v64
    v_exp_f32 v65, v65
    v_exp_f32 v66, v66
    v_exp_f32 v67, v67
    v_exp_f32 v68, v68
    v_exp_f32 v69, v69
    v_add_f32 v48, v54, v55
    v_add_f32 v49, v56, v57
    v_add_f32 v52, v58, v59
    v_add_f32 v50, v62, v63
    v_add_f32 v51, v64, v65
    v_add_f32 v53, v66, v67
    v_add_f32 v48, v48, v60
    v_add_f32 v49, v49, v61
    v_add_f32 v50, v50, v68
    v_add_f32 v51, v51, v69
    v_add_f32 v48, v48, v52
    v_add_f32 v50, v50, v53
    v_add_f32 v48, v48, v49
    v_add_f32 v50, v50, v51
    s_nop 1
    v_permlane32_swap_b32 v48, v50
    v_add_f32 v48, v48, v50
    v_rcp_f32 v48, v48
    s_nop 0
    v_mov_b32 v50, v48
    s_nop 1
    v_permlane32_swap_b32 v48, v50
    v_mul_f32 v54, v54, v48
    v_mul_f32 v62, v62, v50
    v_mul_f32 v55, v55, v48
    v_mul_f32 v63, v63, v50
    v_mul_f32 v56, v56, v48
    v_mul_f32 v64, v64, v50
    v_mul_f32 v57, v57, v48
    v_mul_f32 v65, v65, v50
    v_mul_f32 v58, v58, v48
    v_mul_f32 v66, v66, v50
    v_mul_f32 v59, v59, v48
    v_mul_f32 v67, v67, v50
    v_mul_f32 v60, v60, v48
    v_mul_f32 v68, v68, v50
    v_mul_f32 v61, v61, v48
    v_mul_f32 v69, v69, v50
    v_cvt_pk_bf16_f32 v80, v54, v55
    v_cvt_pk_bf16_f32 v81, v56, v57
    v_cvt_pk_bf16_f32 v82, v58, v59
    v_cvt_pk_bf16_f32 v83, v60, v61
    v_cvt_pk_bf16_f32 v84, v62, v63
    v_cvt_pk_bf16_f32 v85, v64, v65
    v_cvt_pk_bf16_f32 v86, v66, v67
    v_cvt_pk_bf16_f32 v87, v68, v69
    ds_write_b128 v15, v[80:83] offset:24576
    ds_write_b128 v15, v[84:87] offset:25600
    s_mov_b32 s67, 0
L_lw_q11:
    ds_read_b32 v1, v12 offset:0
    s_add_u32 s67, s67, 1
    s_waitcnt lgkmcnt(0)
    v_readfirstlane_b32 s74, v1
    s_cmp_gt_u32 s67, 1600000
    s_cbranch_scc1 L_lx_q11
    s_cmp_lt_u32 s74, 2
    s_cbranch_scc1 L_lw_q11
L_lx_q11:
    ds_read_b128 v[72:75], v15 offset:8192
    ds_read_b128 v[76:79], v15 offset:9216
    s_waitcnt lgkmcnt(1)
    v_mfma_f32_32x32x16_bf16 v[32:47], v[104:107], v[72:75], 0
    s_waitcnt lgkmcnt(0)
    s_nop 10
    v_max3_f32 v48, v32, v33, v34
    v_min3_f32 v50, v32, v33, v34
    v_max3_f32 v52, v35, v36, v37
    v_min3_f32 v53, v35, v36, v37
    v_max3_f32 v48, v48, v38, v39
    v_min3_f32 v50, v50, v38, v39
    v_max_f32 v48, v48, v52
    v_min_f32 v50, v50, v53
    v_sub_f32 v50, 0, v50
    s_nop 1
    v_permlane32_swap_b32 v48, v50
    v_max_f32 v48, v48, v50
    v_mul_f32 v48, v48, -v8
    v_mov_b32 v50, v48
    s_nop 1
    v_permlane32_swap_b32 v48, v50
    v_fma_f32 v54, v32, v8, v48
    v_fma_f32 v62, -v32, v8, v50
    v_fma_f32 v55, v33, v8, v48
    v_fma_f32 v63, -v33, v8, v50
    v_fma_f32 v56, v34, v8, v48
    v_fma_f32 v64, -v34, v8, v50
    v_fma_f32 v57, v35, v8, v48
    v_fma_f32 v65, -v35, v8, v50
    v_fma_f32 v58, v36, v8, v48
    v_fma_f32 v66, -v36, v8, v50
    v_fma_f32 v59, v37, v8, v48
    v_fma_f32 v67, -v37, v8, v50
    v_fma_f32 v60, v38, v8, v48
    v_fma_f32 v68, -v38, v8, v50
    v_fma_f32 v61, v39, v8, v48
    v_fma_f32 v69, -v39, v8, v50
    v_mfma_f32_32x32x16_bf16 v[32:47], v[88:91], v[76:79], 0
    v_exp_f32 v54, v54
    v_exp_f32 v55, v55
    v_exp_f32 v56, v56
    v_exp_f32 v57, v57
    v_exp_f32 v58, v58
    v_exp_f32 v59, v59
    v_exp_f32 v60, v60
    v_exp_f32 v61, v61
    v_exp_f32 v62, v62
    v_exp_f32 v63, v63
    v_exp_f32 v64, v64
    v_exp_f32 v65, v65
    v_exp_f32 v66, v66
    v_exp_f32 v67, v67
    v_exp_f32 v68, v68
    v_exp_f32 v69, v69
    v_add_f32 v48, v54, v55
    v_add_f32 v49, v56, v57
    v_add_f32 v52, v58, v59
    v_add_f32 v50, v62, v63
    v_add_f32 v51, v64, v65
    v_add_f32 v53, v66, v67
    v_add_f32 v48, v48, v60
    v_add_f32 v49, v49, v61
    v_add_f32 v50, v50, v68
    v_add_f32 v51, v51, v69
    v_add_f32 v48, v48, v52
    v_add_f32 v50, v50, v53
    v_add_f32 v48, v48, v49
    v_add_f32 v50, v50, v51
    s_nop 1
    v_permlane32_swap_b32 v48, v50
    v_add_f32 v48, v48, v50
    v_rcp_f32 v48, v48
    s_nop 0
    v_mov_b32 v50, v48
    s_nop 1
    v_permlane32_swap_b32 v48, v50
    v_mul_f32 v54, v54, v48
    v_mul_f32 v62, v62, v50
    v_mul_f32 v55, v55, v48
    v_mul_f32 v63, v63, v50
    v_mul_f32 v56, v56, v48
    v_mul_f32 v64, v64, v50
    v_mul_f32 v57, v57, v48
    v_mul_f32 v65, v65, v50
    v_mul_f32 v58, v58, v48
    v_mul_f32 v66, v66, v50
    v_mul_f32 v59, v59, v48
    v_mul_f32 v67, v67, v50
    v_mul_f32 v60, v60, v48
    v_mul_f32 v68, v68, v50
    v_mul_f32 v61, v61, v48
    v_mul_f32 v69, v69, v50
    v_cvt_pk_bf16_f32 v24, v54, v55
    v_cvt_pk_bf16_f32 v25, v56, v57
    v_cvt_pk_bf16_f32 v26, v58, v59
    v_cvt_pk_bf16_f32 v27, v60, v61
    v_cvt_pk_bf16_f32 v28, v62, v63
    v_cvt_pk_bf16_f32 v29, v64, v65
    v_cvt_pk_bf16_f32 v30, v66, v67
    v_cvt_pk_bf16_f32 v31, v68, v69
    ds_write_b128 v15, v[24:27] offset:0
    ds_write_b128 v15, v[28:31] offset:1024
    v_max3_f32 v48, v32, v33, v34
    v_min3_f32 v50, v32, v33, v34
    v_max3_f32 v52, v35, v36, v37
    v_min3_f32 v53, v35, v36, v37
    v_max3_f32 v48, v48, v38, v39
    v_min3_f32 v50, v50, v38, v39
    v_max_f32 v48, v48, v52
    v_min_f32 v50, v50, v53
    v_sub_f32 v50, 0, v50
    s_nop 1
    v_permlane32_swap_b32 v48, v50
    v_max_f32 v48, v48, v50
    v_mul_f32 v48, v48, -v8
    v_mov_b32 v50, v48
    s_nop 1
    v_permlane32_swap_b32 v48, v50
    v_fma_f32 v54, v32, v8, v48
    v_fma_f32 v62, -v32, v8, v50
    v_fma_f32 v55, v33, v8, v48
    v_fma_f32 v63, -v33, v8, v50
    v_fma_f32 v56, v34, v8, v48
    v_fma_f32 v64, -v34, v8, v50
    v_fma_f32 v57, v35, v8, v48
    v_fma_f32 v65, -v35, v8, v50
    v_fma_f32 v58, v36, v8, v48
    v_fma_f32 v66, -v36, v8, v50
    v_fma_f32 v59, v37, v8, v48
    v_fma_f32 v67, -v37, v8, v50
    v_fma_f32 v60, v38, v8, v48
    v_fma_f32 v68, -v38, v8, v50
    v_fma_f32 v61, v39, v8, v48
    v_fma_f32 v69, -v39, v8, v50
    v_exp_f32 v54, v54
    v_exp_f32 v55, v55
    v_exp_f32 v56, v56
    v_exp_f32 v57, v57
    v_exp_f32 v58, v58
    v_exp_f32 v59, v59
    v_exp_f32 v60, v60
    v_exp_f32 v61, v61
    v_exp_f32 v62, v62
    v_exp_f32 v63, v63
    v_exp_f32 v64, v64
    v_exp_f32 v65, v65
    v_exp_f32 v66, v66
    v_exp_f32 v67, v67
    v_exp_f32 v68, v68
    v_exp_f32 v69, v69
    v_add_f32 v48, v54, v55
    v_add_f32 v49, v56, v57
    v_add_f32 v52, v58, v59
    v_add_f32 v50, v62, v63
    v_add_f32 v51, v64, v65
    v_add_f32 v53, v66, v67
    v_add_f32 v48, v48, v60
    v_add_f32 v49, v49, v61
    v_add_f32 v50, v50, v68
    v_add_f32 v51, v51, v69
    v_add_f32 v48, v48, v52
    v_add_f32 v50, v50, v53
    v_add_f32 v48, v48, v49
    v_add_f32 v50, v50, v51
    s_nop 1
    v_permlane32_swap_b32 v48, v50
    v_add_f32 v48, v48, v50
    v_rcp_f32 v48, v48
    s_nop 0
    v_mov_b32 v50, v48
    s_nop 1
    v_permlane32_swap_b32 v48, v50
    v_mul_f32 v54, v54, v48
    v_mul_f32 v62, v62, v50
    v_mul_f32 v55, v55, v48
    v_mul_f32 v63, v63, v50
    v_mul_f32 v56, v56, v48
    v_mul_f32 v64, v64, v50
    v_mul_f32 v57, v57, v48
    v_mul_f32 v65, v65, v50
    v_mul_f32 v58, v58, v48
    v_mul_f32 v66, v66, v50
    v_mul_f32 v59, v59, v48
    v_mul_f32 v67, v67, v50
    v_mul_f32 v60, v60, v48
    v_mul_f32 v68, v68, v50
    v_mul_f32 v61, v61, v48
    v_mul_f32 v69, v69, v50
    v_cvt_pk_bf16_f32 v80, v54, v55
    v_cvt_pk_bf16_f32 v81, v56, v57
    v_cvt_pk_bf16_f32 v82, v58, v59
    v_cvt_pk_bf16_f32 v83, v60, v61
    v_cvt_pk_bf16_f32 v84, v62, v63
    v_cvt_pk_bf16_f32 v85, v64, v65
    v_cvt_pk_bf16_f32 v86, v66, v67
    v_cvt_pk_bf16_f32 v87, v68, v69
    ds_write_b128 v15, v[80:83] offset:8192
    ds_write_b128 v15, v[84:87] offset:9216
    ds_write_b32 v12, v7 offset:32
    s_lshl_b32 s72, s36, 5
    s_add_u32 s72, s72, s100
    s_mul_i32 s72, s72, 18432
    s_lshl_b32 s73, s70, 10
    s_add_u32 s72, s72, s73
    s_add_u32 s68, s72, 14336
    s_lshl_b32 s69, s36, 3
    s_add_u32 s69, s69, s100
    s_lshl_b32 s69, s69, 2
    s_add_u32 s69, s69, s70
    s_lshl_b32 s69, s69, 7
    s_add_u32 s69, s69, 19202048
    s_setprio 0
    v_min_u32 v193, 16, v2
    v_lshlrev_b32 v193, 6, v193
    v_lshl_add_u32 v193, v3, 5, v193
    s_add_u32 s60, s63, 4096
    s_add_u32 s72, s70, 2
    s_and_b32 s72, s72, 3
    s_lshl_b32 s72, s72, 13
    s_add_u32 s72, s72, 98304
    v_add_u32 v192, s72, v14
    v_add_u32 v193, s72, v193
    v_lshl_add_u32 v207, v0, 2, s72
    v_lshlrev_b32 v194, 2, v2
    v_add_u32 v194, 157696, v194
    v_mov_b32 v195, v11
    s_waitcnt vmcnt(20)
    v_cmp_ne_u32 vcc, s39, v110
    s_nop 0
    s_cmp_eq_u64 vcc, 0
    s_cbranch_scc1 L_pok_z1
    s_mov_b32 s67, 0
L_poll_z1:
    s_sleep 1
    buffer_load_dword v110, v111, s[28:31], s62 offen sc1
    s_waitcnt vmcnt(0)
    v_cmp_ne_u32 vcc, s39, v110
    s_nop 0
    s_cmp_eq_u64 vcc, 0
    s_cbranch_scc1 L_pok_z1
    s_add_u32 s67, s67, 1
    s_cmp_gt_u32 s67, 200000
    s_cbranch_scc0 L_poll_z1
L_pok_z1:
    v_mov_b32 v225, 0x41d00000
    v_mov_b32 v227, 0x41d00000
    s_lshl_b32 s72, s40, 4
    s_add_u32 s72, s72, s96
    s_mul_i32 s72, s72, 18432
    v_lshlrev_b32 v4, 4, v0
    v_add_u32 v2, s72, v4
    v_add_u32 v1, 147456, v2
    s_mov_b32 s66, 0
    buffer_load_dwordx4 v[8:11], v2, s[28:31], s8 offen sc1
    buffer_load_dwordx4 v[12:15], v1, s[28:31], s8 offen sc1
    buffer_load_dwordx4 v[16:19], v2, s[28:31], s9 offen sc1
    buffer_load_dwordx4 v[20:23], v1, s[28:31], s9 offen sc1
    buffer_load_dwordx4 v[24:27], v2, s[28:31], s10 offen sc1
    buffer_load_dwordx4 v[28:31], v1, s[28:31], s10 offen sc1
    buffer_load_dwordx4 v[32:35], v2, s[28:31], s11 offen sc1
    buffer_load_dwordx4 v[36:39], v1, s[28:31], s11 offen sc1
    buffer_load_dwordx4 v[40:43], v2, s[28:31], s12 offen sc1
    buffer_load_dwordx4 v[44:47], v1, s[28:31], s12 offen sc1
L_qw0:
    s_waitcnt vmcnt(8)
L_qv0:
    v_xor_b32 v8, s52, v8
    v_xor_b32 v9, s53, v9
    v_xor_b32 v10, s54, v10
    v_xor_b32 v11, s55, v11
    v_xor_b32 v12, s52, v12
    v_xor_b32 v13, s53, v13
    v_xor_b32 v14, s54, v14
    v_xor_b32 v15, s55, v15
    v_or3_b32 v5, v8, v9, v10
    v_or3_b32 v6, v11, v12, v13
    v_or3_b32 v5, v5, v14, v15
    v_or_b32 v5, v5, v6
    v_and_b32 v5, 0x80008000, v5
    v_cmp_ne_u32 vcc, 0, v5
    s_cbranch_vccnz L_qrt0
L_qgo0:
    v_mfma_f32_32x32x16_bf16 v[48:63], v[112:115], v[8:11], 0
    v_mfma_f32_32x32x16_bf16 v[64:79], v[112:115], v[12:15], 0
    v_mfma_f32_32x32x16_bf16 v[80:95], v[116:119], v[8:11], 0
    v_mfma_f32_32x32x16_bf16 v[96:111], v[116:119], v[12:15], 0
    buffer_load_dwordx4 v[8:11], v2, s[28:31], s13 offen sc1
    buffer_load_dwordx4 v[12:15], v1, s[28:31], s13 offen sc1
L_qw1:
    s_waitcnt vmcnt(8)
L_qv1:
    v_xor_b32 v16, s52, v16
    v_xor_b32 v17, s53, v17
    v_xor_b32 v18, s54, v18
    v_xor_b32 v19, s55, v19
    v_xor_b32 v20, s52, v20
    v_xor_b32 v21, s53, v21
    v_xor_b32 v22, s54, v22
    v_xor_b32 v23, s55, v23
    v_or3_b32 v5, v16, v17, v18
    v_or3_b32 v6, v19, v20, v21
    v_or3_b32 v5, v5, v22, v23
    v_or_b32 v5, v5, v6
    v_and_b32 v5, 0x80008000, v5
    v_cmp_ne_u32 vcc, 0, v5
    s_cbranch_vccnz L_qrt1
L_qgo1:
    v_mfma_f32_32x32x16_bf16 v[48:63], v[120:123], v[16:19], v[48:63]
    v_mfma_f32_32x32x16_bf16 v[64:79], v[120:123], v[20:23], v[64:79]
    v_mfma_f32_32x32x16_bf16 v[80:95], v[124:127], v[16:19], v[80:95]
    v_mfma_f32_32x32x16_bf16 v[96:111], v[124:127], v[20:23], v[96:111]
    buffer_load_dwordx4 v[16:19], v2, s[28:31], s14 offen sc1
    buffer_load_dwordx4 v[20:23], v1, s[28:31], s14 offen sc1
    buffer_load_dwordx4 v[208:211], v4, s[28:31], s63 offen offset:0 sc1
    buffer_load_dwordx4 v[212:215], v4, s[28:31], s63 offen offset:1024 sc1
    buffer_load_dwordx4 v[216:219], v4, s[28:31], s63 offen offset:2048 sc1
    buffer_load_dwordx4 v[220:223], v4, s[28:31], s63 offen offset:3072 sc1
    s_mov_b64 exec, 0xffff
    buffer_load_dwordx4 v[224:227], v4, s[28:31], s60 offen offset:0 sc1
    s_mov_b64 exec, -1
L_qw2:
    s_waitcnt vmcnt(13)
L_qv2:
    v_xor_b32 v24, s52, v24
    v_xor_b32 v25, s53, v25
    v_xor_b32 v26, s54, v26
    v_xor_b32 v27, s55, v27
    v_xor_b32 v28, s52, v28
    v_xor_b32 v29, s53, v29
    v_xor_b32 v30, s54, v30
    v_xor_b32 v31, s55, v31
    v_or3_b32 v5, v24, v25, v26
    v_or3_b32 v6, v27, v28, v29
    v_or3_b32 v5, v5, v30, v31
    v_or_b32 v5, v5, v6
    v_and_b32 v5, 0x80008000, v5
    v_cmp_ne_u32 vcc, 0, v5
    s_cbranch_vccnz L_qrt2
L_qgo2:
    v_mfma_f32_32x32x16_bf16 v[48:63], v[128:131], v[24:27], v[48:63]
    v_mfma_f32_32x32x16_bf16 v[64:79], v[128:131], v[28:31], v[64:79]
    v_mfma_f32_32x32x16_bf16 v[80:95], v[132:135], v[24:27], v[80:95]
    v_mfma_f32_32x32x16_bf16 v[96:111], v[132:135], v[28:31], v[96:111]
    buffer_load_dwordx4 v[24:27], v2, s[28:31], s15 offen sc1
    buffer_load_dwordx4 v[28:31], v1, s[28:31], s15 offen sc1
L_qw3:
    s_waitcnt vmcnt(13)
L_qv3:
    v_xor_b32 v32, s52, v32
    v_xor_b32 v33, s53, v33
    v_xor_b32 v34, s54, v34
    v_xor_b32 v35, s55, v35
    v_xor_b32 v36, s52, v36
    v_xor_b32 v37, s53, v37
    v_xor_b32 v38, s54, v38
    v_xor_b32 v39, s55, v39
    v_or3_b32 v5, v32, v33, v34
    v_or3_b32 v6, v35, v36, v37
    v_or3_b32 v5, v5, v38, v39
    v_or_b32 v5, v5, v6
    v_and_b32 v5, 0x80008000, v5
    v_cmp_ne_u32 vcc, 0, v5
    s_cbranch_vccnz L_qrt3
L_qgo3:
    v_mfma_f32_32x32x16_bf16 v[48:63], v[136:139], v[32:35], v[48:63]
    v_mfma_f32_32x32x16_bf16 v[64:79], v[136:139], v[36:39], v[64:79]
    v_mfma_f32_32x32x16_bf16 v[80:95], v[140:143], v[32:35], v[80:95]
    v_mfma_f32_32x32x16_bf16 v[96:111], v[140:143], v[36:39], v[96:111]
    buffer_load_dwordx4 v[32:35], v2, s[28:31], s16 offen sc1
    buffer_load_dwordx4 v[36:39], v1, s[28:31], s16 offen sc1
    s_setprio 3
    v_mov_b32 v7, 160256
    s_mov_b32 s74, 0x41cf0000
    s_mov_b32 s67, 0
L_lw_pq1:
    ds_read_b128 v[196:199], v7 offset:32
    s_add_u32 s67, s67, 1
    s_waitcnt lgkmcnt(0)
    v_min_u32 v196, v196, v197
    v_min3_u32 v196, v196, v198, v199
    s_nop 0
    v_readfirstlane_b32 s72, v196
    s_cmp_gt_u32 s67, 1600000
    s_cbranch_scc1 L_lx_pq1
    s_cmp_lt_u32 s72, 1
    s_cbranch_scc1 L_lw_pq1
L_lx_pq1:
    ds_read_b128 v[240:243], v192 offset:0
    ds_read_b128 v[244:247], v192 offset:1024
    ds_read_b128 v[248:251], v192 offset:2048
    ds_read_b128 v[252:255], v192 offset:3072
    ds_read_b32 v196, v194 offset:0
    ds_read_b32 v197, v194 offset:128
    ds_read_b32 v198, v194 offset:256
    ds_read_b32 v199, v194 offset:384
    s_mov_b32 s72, 0
    s_mov_b32 s73, 0xc1d00000
    s_waitcnt vmcnt(4)
    v_min3_i32 v5, v209, v211, v213
    v_min3_i32 v6, v215, v217, v219
    v_min3_i32 v5, v5, v221, v223
    v_min3_i32 v6, v6, v225, v227
    v_min_i32 v5, v5, v6
    v_cmp_gt_i32 vcc, s74, v5
    s_nop 0
    s_cmp_eq_u64 vcc, 0
    s_cbranch_scc1 L_pok_kv1
    s_mov_b32 s67, 0
L_poll_kv1:
    s_sleep 2
    buffer_load_dwordx4 v[208:211], v4, s[28:31], s63 offen offset:0 sc1
    buffer_load_dwordx4 v[212:215], v4, s[28:31], s63 offen offset:1024 sc1
    buffer_load_dwordx4 v[216:219], v4, s[28:31], s63 offen offset:2048 sc1
    buffer_load_dwordx4 v[220:223], v4, s[28:31], s63 offen offset:3072 sc1
    s_mov_b64 exec, 0xffff
    buffer_load_dwordx4 v[224:227], v4, s[28:31], s60 offen offset:0 sc1
    s_mov_b64 exec, -1
    s_waitcnt vmcnt(0)
    v_min3_i32 v5, v209, v211, v213
    v_min3_i32 v6, v215, v217, v219
    v_min3_i32 v5, v5, v221, v223
    v_min3_i32 v6, v6, v225, v227
    v_min_i32 v5, v5, v6
    v_cmp_gt_i32 vcc, s74, v5
    s_nop 0
    s_cmp_eq_u64 vcc, 0
    s_cbranch_scc1 L_pok_kv1
    s_add_u32 s67, s67, 1
    s_cmp_gt_u32 s67, 200000
    s_cbranch_scc0 L_poll_kv1
L_pok_kv1:
    s_waitcnt lgkmcnt(0)
    v_add_f64 v[208:209], v[208:209], s[72:73]
    v_cvt_f32_f64 v208, v[208:209]
    v_add_f64 v[210:211], v[210:211], s[72:73]
    v_cvt_f32_f64 v210, v[210:211]
    v_cvt_pk_bf16_f32 v210, v208, v210
    ds_write_b32 v207, v210 offset:0
    v_add_f64 v[212:213], v[212:213], s[72:73]
    v_cvt_f32_f64 v212, v[212:213]
    v_add_f64 v[214:215], v[214:215], s[72:73]
    v_cvt_f32_f64 v214, v[214:215]
    v_cvt_pk_bf16_f32 v214, v212, v214
    ds_write_b32 v207, v214 offset:256
    v_add_f64 v[216:217], v[216:217], s[72:73]
    v_cvt_f32_f64 v216, v[216:217]
    v_add_f64 v[218:219], v[218:219], s[72:73]
    v_cvt_f32_f64 v218, v[218:219]
    v_cvt_pk_bf16_f32 v218, v216, v218
    ds_write_b32 v207, v218 offset:512
    v_add_f64 v[220:221], v[220:221], s[72:73]
    v_cvt_f32_f64 v220, v[220:221]
    v_add_f64 v[222:223], v[222:223], s[72:73]
    v_cvt_f32_f64 v222, v[222:223]
    v_cvt_pk_bf16_f32 v222, v220, v222
    ds_write_b32 v207, v222 offset:768
    v_add_f64 v[224:225], v[224:225], s[72:73]
    v_cvt_f32_f64 v224, v[224:225]
    v_add_f64 v[226:227], v[226:227], s[72:73]
    v_cvt_f32_f64 v226, v[226:227]
    v_cvt_pk_bf16_f32 v226, v224, v226
    ds_write_b32 v207, v226 offset:1024
    ds_read_b128 v[200:203], v193 offset:0
    ds_read_b128 v[204:207], v193 offset:16
    v_mov_b32 v3, 1
    s_waitcnt lgkmcnt(0)
    v_mfma_f32_32x32x16_bf16 v[208:223], v[200:203], v[240:243], 0
    v_mfma_f32_32x32x16_bf16 v[208:223], v[204:207], v[244:247], v[208:223]
    v_mfma_f32_32x32x16_bf16 v[224:239], v[200:203], v[248:251], 0
    v_mfma_f32_32x32x16_bf16 v[224:239], v[204:207], v[252:255], v[224:239]
    ds_read_b128 v[240:243], v192 offset:4096
    ds_read_b128 v[244:247], v192 offset:5120
    ds_read_b128 v[248:251], v192 offset:6144
    ds_read_b128 v[252:255], v192 offset:7168
    s_nop 5
    v_add_f32 v216, 0x358637bd, v216
    v_mul_f32 v216, v216, v196
    v_rcp_f32 v216, v216
    s_nop 0
    v_mul_f32 v208, v208, v216
    v_mul_f32 v209, v209, v216
    v_mul_f32 v210, v210, v216
    v_mul_f32 v211, v211, v216
    v_mul_f32 v212, v212, v216
    v_mul_f32 v213, v213, v216
    v_mul_f32 v214, v214, v216
    v_mul_f32 v215, v215, v216
    v_cvt_pk_bf16_f32 v220, v208, v209
    v_cvt_pk_bf16_f32 v221, v210, v211
    v_cvt_pk_bf16_f32 v222, v212, v213
    v_cvt_pk_bf16_f32 v223, v214, v215
    buffer_store_dwordx4 v[220:223], v4, s[28:31], s68 offen sc1
    s_add_u32 s68, s68, 147456
    s_waitcnt lgkmcnt(2)
    v_mfma_f32_32x32x16_bf16 v[208:223], v[200:203], v[240:243], 0
    v_mfma_f32_32x32x16_bf16 v[208:223], v[204:207], v[244:247], v[208:223]
    v_add_f32 v232, 0x358637bd, v232
    v_mul_f32 v232, v232, v197
    v_rcp_f32 v232, v232
    s_nop 0
    v_mul_f32 v224, v224, v232
    v_mul_f32 v225, v225, v232
    v_mul_f32 v226, v226, v232
    v_mul_f32 v227, v227, v232
    v_mul_f32 v228, v228, v232
    v_mul_f32 v229, v229, v232
    v_mul_f32 v230, v230, v232
    v_mul_f32 v231, v231, v232
    v_cvt_pk_bf16_f32 v236, v224, v225
    v_cvt_pk_bf16_f32 v237, v226, v227
    v_cvt_pk_bf16_f32 v238, v228, v229
    v_cvt_pk_bf16_f32 v239, v230, v231
    buffer_store_dwordx4 v[236:239], v4, s[28:31], s68 offen sc1
    s_add_u32 s68, s68, 147456
    s_waitcnt lgkmcnt(0)
    v_mfma_f32_32x32x16_bf16 v[224:239], v[200:203], v[248:251], 0
    v_mfma_f32_32x32x16_bf16 v[224:239], v[204:207], v[252:255], v[224:239]
    s_mov_b64 exec, 1
    ds_add_u32 v7, v3 offset:48
    s_mov_b64 exec, -1
    v_mov_b32 v3, v195
    v_add_f32 v216, 0x358637bd, v216
    v_mul_f32 v216, v216, v198
    v_rcp_f32 v216, v216
    s_nop 0
    v_mul_f32 v208, v208, v216
    v_mul_f32 v209, v209, v216
    v_mul_f32 v210, v210, v216
    v_mul_f32 v211, v211, v216
    v_mul_f32 v212, v212, v216
    v_mul_f32 v213, v213, v216
    v_mul_f32 v214, v214, v216
    v_mul_f32 v215, v215, v216
    v_cvt_pk_bf16_f32 v220, v208, v209
    v_cvt_pk_bf16_f32 v221, v210, v211
    v_cvt_pk_bf16_f32 v222, v212, v213
    v_cvt_pk_bf16_f32 v223, v214, v215
    buffer_store_dwordx4 v[220:223], v4, s[28:31], s68 offen sc1
    s_add_u32 s68, s68, 147456
    v_add_f32 v232, 0x358637bd, v232
    v_mul_f32 v232, v232, v199
    v_rcp_f32 v232, v232
    s_nop 0
    v_mul_f32 v224, v224, v232
    v_mul_f32 v225, v225, v232
    v_mul_f32 v226, v226, v232
    v_mul_f32 v227, v227, v232
    v_mul_f32 v228, v228, v232
    v_mul_f32 v229, v229, v232
    v_mul_f32 v230, v230, v232
    v_mul_f32 v231, v231, v232
    v_cvt_pk_bf16_f32 v236, v224, v225
    v_cvt_pk_bf16_f32 v237, v226, v227
    v_cvt_pk_bf16_f32 v238, v228, v229
    v_cvt_pk_bf16_f32 v239, v230, v231
    buffer_store_dwordx4 v[236:239], v4, s[28:31], s68 offen sc1
    s_lshl_b32 s34, s18, 1
    buffer_load_dwordx4 v[192:195], v3, s[28:31], s34 offen offset:0 sc1
    buffer_load_dwordx4 v[196:199], v3, s[28:31], s34 offen offset:1024 sc1
    s_lshl_b32 s34, s19, 1
    buffer_load_dwordx4 v[200:203], v3, s[28:31], s34 offen offset:0 sc1
    buffer_load_dwordx4 v[204:207], v3, s[28:31], s34 offen offset:1024 sc1
    s_lshl_b32 s34, s20, 1
    buffer_load_dwordx4 v[208:211], v3, s[28:31], s34 offen offset:0 sc1
    buffer_load_dwordx4 v[212:215], v3, s[28:31], s34 offen offset:1024 sc1
    s_lshl_b32 s34, s21, 1
    buffer_load_dwordx4 v[216:219], v3, s[28:31], s34 offen offset:0 sc1
    buffer_load_dwordx4 v[220:223], v3, s[28:31], s34 offen offset:1024 sc1
    s_waitcnt vmcnt(8)
    s_mov_b64 exec, 1
    v_mov_b32 v5, s39
    v_mov_b32 v6, 0
    buffer_store_dword v5, v6, s[28:31], s69 offen sc1
    s_mov_b64 exec, -1
    s_setprio 0
    s_lshl_b32 s34, s22, 1
    buffer_load_dwordx4 v[224:227], v3, s[28:31], s34 offen offset:0 sc1
    buffer_load_dwordx4 v[228:231], v3, s[28:31], s34 offen offset:1024 sc1
    s_lshl_b32 s34, s23, 1
    buffer_load_dwordx4 v[232:235], v3, s[28:31], s34 offen offset:0 sc1
    buffer_load_dwordx4 v[236:239], v3, s[28:31], s34 offen offset:1024 sc1
    s_lshl_b32 s34, s32, 1
    buffer_load_dwordx4 v[240:243], v3, s[28:31], s34 offen offset:0 sc1
    buffer_load_dwordx4 v[244:247], v3, s[28:31], s34 offen offset:1024 sc1
    s_lshl_b32 s34, s33, 1
    buffer_load_dwordx4 v[248:251], v3, s[28:31], s34 offen offset:0 sc1
    buffer_load_dwordx4 v[252:255], v3, s[28:31], s34 offen offset:1024 sc1
L_qw4:
L_qv4:
    v_xor_b32 v40, s52, v40
    v_xor_b32 v41, s53, v41
    v_xor_b32 v42, s54, v42
    v_xor_b32 v43, s55, v43
    v_xor_b32 v44, s52, v44
    v_xor_b32 v45, s53, v45
    v_xor_b32 v46, s54, v46
    v_xor_b32 v47, s55, v47
    v_or3_b32 v5, v40, v41, v42
    v_or3_b32 v6, v43, v44, v45
    v_or3_b32 v5, v5, v46, v47
    v_or_b32 v5, v5, v6
    v_and_b32 v5, 0x80008000, v5
    v_cmp_ne_u32 vcc, 0, v5
    s_cbranch_vccnz L_qrt4
L_qgo4:
    v_mfma_f32_32x32x16_bf16 v[48:63], v[144:147], v[40:43], v[48:63]
    v_mfma_f32_32x32x16_bf16 v[64:79], v[144:147], v[44:47], v[64:79]
    v_mfma_f32_32x32x16_bf16 v[80:95], v[148:151], v[40:43], v[80:95]
    v_mfma_f32_32x32x16_bf16 v[96:111], v[148:151], v[44:47], v[96:111]
    buffer_load_dwordx4 v[40:43], v2, s[28:31], s17 offen sc1
    buffer_load_dwordx4 v[44:47], v1, s[28:31], s17 offen sc1
L_qw5:
L_qv5:
    v_xor_b32 v8, s52, v8
    v_xor_b32 v9, s53, v9
    v_xor_b32 v10, s54, v10
    v_xor_b32 v11, s55, v11
    v_xor_b32 v12, s52, v12
    v_xor_b32 v13, s53, v13
    v_xor_b32 v14, s54, v14
    v_xor_b32 v15, s55, v15
    v_or3_b32 v5, v8, v9, v10
    v_or3_b32 v6, v11, v12, v13
    v_or3_b32 v5, v5, v14, v15
    v_or_b32 v5, v5, v6
    v_and_b32 v5, 0x80008000, v5
    v_cmp_ne_u32 vcc, 0, v5
    s_cbranch_vccnz L_qrt5
L_qgo5:
    v_mfma_f32_32x32x16_bf16 v[48:63], v[152:155], v[8:11], v[48:63]
    v_mfma_f32_32x32x16_bf16 v[64:79], v[152:155], v[12:15], v[64:79]
    v_mfma_f32_32x32x16_bf16 v[80:95], v[156:159], v[8:11], v[80:95]
    v_mfma_f32_32x32x16_bf16 v[96:111], v[156:159], v[12:15], v[96:111]
    buffer_load_dwordx4 v[8:11], v2, s[28:31], s18 offen sc1
    buffer_load_dwordx4 v[12:15], v1, s[28:31], s18 offen sc1
L_qw6:
L_qv6:
    v_xor_b32 v16, s52, v16
    v_xor_b32 v17, s53, v17
    v_xor_b32 v18, s54, v18
    v_xor_b32 v19, s55, v19
    v_xor_b32 v20, s52, v20
    v_xor_b32 v21, s53, v21
    v_xor_b32 v22, s54, v22
    v_xor_b32 v23, s55, v23
    v_or3_b32 v5, v16, v17, v18
    v_or3_b32 v6, v19, v20, v21
    v_or3_b32 v5, v5, v22, v23
    v_or_b32 v5, v5, v6
    v_and_b32 v5, 0x80008000, v5
    v_cmp_ne_u32 vcc, 0, v5
    s_cbranch_vccnz L_qrt6
L_qgo6:
    v_mfma_f32_32x32x16_bf16 v[48:63], v[160:163], v[16:19], v[48:63]
    v_mfma_f32_32x32x16_bf16 v[64:79], v[160:163], v[20:23], v[64:79]
    v_mfma_f32_32x32x16_bf16 v[80:95], v[164:167], v[16:19], v[80:95]
    v_mfma_f32_32x32x16_bf16 v[96:111], v[164:167], v[20:23], v[96:111]
    buffer_load_dwordx4 v[16:19], v2, s[28:31], s19 offen sc1
    buffer_load_dwordx4 v[20:23], v1, s[28:31], s19 offen sc1
L_qw7:
L_qv7:
    v_xor_b32 v24, s52, v24
    v_xor_b32 v25, s53, v25
    v_xor_b32 v26, s54, v26
    v_xor_b32 v27, s55, v27
    v_xor_b32 v28, s52, v28
    v_xor_b32 v29, s53, v29
    v_xor_b32 v30, s54, v30
    v_xor_b32 v31, s55, v31
    v_or3_b32 v5, v24, v25, v26
    v_or3_b32 v6, v27, v28, v29
    v_or3_b32 v5, v5, v30, v31
    v_or_b32 v5, v5, v6
    v_and_b32 v5, 0x80008000, v5
    v_cmp_ne_u32 vcc, 0, v5
    s_cbranch_vccnz L_qrt7
L_qgo7:
    v_mfma_f32_32x32x16_bf16 v[48:63], v[168:171], v[24:27], v[48:63]
    v_mfma_f32_32x32x16_bf16 v[64:79], v[168:171], v[28:31], v[64:79]
    v_mfma_f32_32x32x16_bf16 v[80:95], v[172:175], v[24:27], v[80:95]
    v_mfma_f32_32x32x16_bf16 v[96:111], v[172:175], v[28:31], v[96:111]
    buffer_load_dwordx4 v[24:27], v2, s[28:31], s20 offen sc1
    buffer_load_dwordx4 v[28:31], v1, s[28:31], s20 offen sc1
L_qw8:
L_qv8:
    v_xor_b32 v32, s52, v32
    v_xor_b32 v33, s53, v33
    v_xor_b32 v34, s54, v34
    v_xor_b32 v35, s55, v35
    v_xor_b32 v36, s52, v36
    v_xor_b32 v37, s53, v37
    v_xor_b32 v38, s54, v38
    v_xor_b32 v39, s55, v39
    v_or3_b32 v5, v32, v33, v34
    v_or3_b32 v6, v35, v36, v37
    v_or3_b32 v5, v5, v38, v39
    v_or_b32 v5, v5, v6
    v_and_b32 v5, 0x80008000, v5
    v_cmp_ne_u32 vcc, 0, v5
    s_cbranch_vccnz L_qrt8
L_qgo8:
    v_mfma_f32_32x32x16_bf16 v[48:63], v[176:179], v[32:35], v[48:63]
    v_mfma_f32_32x32x16_bf16 v[64:79], v[176:179], v[36:39], v[64:79]
    v_mfma_f32_32x32x16_bf16 v[80:95], v[180:183], v[32:35], v[80:95]
    v_mfma_f32_32x32x16_bf16 v[96:111], v[180:183], v[36:39], v[96:111]
    buffer_load_dwordx4 v[32:35], v2, s[28:31], s21 offen sc1
    buffer_load_dwordx4 v[36:39], v1, s[28:31], s21 offen sc1
L_qw9:
    s_waitcnt vmcnt(8)
L_qv9:
    v_xor_b32 v40, s52, v40
    v_xor_b32 v41, s53, v41
    v_xor_b32 v42, s54, v42
    v_xor_b32 v43, s55, v43
    v_xor_b32 v44, s52, v44
    v_xor_b32 v45, s53, v45
    v_xor_b32 v46, s54, v46
    v_xor_b32 v47, s55, v47
    v_or3_b32 v5, v40, v41, v42
    v_or3_b32 v6, v43, v44, v45
    v_or3_b32 v5, v5, v46, v47
    v_or_b32 v5, v5, v6
    v_and_b32 v5, 0x80008000, v5
    v_cmp_ne_u32 vcc, 0, v5
    s_cbranch_vccnz L_qrt9
L_qgo9:
    v_mfma_f32_32x32x16_bf16 v[48:63], v[184:187], v[40:43], v[48:63]
    v_mfma_f32_32x32x16_bf16 v[64:79], v[184:187], v[44:47], v[64:79]
    v_mfma_f32_32x32x16_bf16 v[80:95], v[188:191], v[40:43], v[80:95]
    v_mfma_f32_32x32x16_bf16 v[96:111], v[188:191], v[44:47], v[96:111]
    s_lshl_b32 s72, s38, 3
    v_lshrrev_b32 v117, 3, v0
    v_add_u32 v117, s72, v117
    v_and_b32 v118, 7, v0
    v_lshlrev_b32 v119, 10, v117
    v_lshl_add_u32 v119, v118, 4, v119
    v_lshlrev_b32 v121, 4, v117
    s_lshl_b32 s64, s40, 16
    s_lshl_b32 s72, s41, 7
    s_add_u32 s64, s64, s72
    s_lshl_b32 s65, s40, 10
    s_add_u32 s65, s65, 18087944
    v_mov_b32 v7, 160304
    v_and_b32 v3, 31, v0
    v_lshlrev_b32 v3, 7, v3
    s_lshr_b32 s61, s40, 1
    s_lshl_b32 s61, s61, 12
    s_add_u32 s61, s61, 19202048
    s_lshl_b32 s62, s96, 2
    s_lshl_b32 s62, 15, s62
    s_branch L_w10
L_mfma:
    s_getpc_b64 s[72:73]
L_pc:
    s_sub_u32 s72, s72, L_pc-parallel_sum__linear_kernel_hedgehog__dense_activation_relu__prompt_kernel
    s_subb_u32 s73, s73, 0
    s_lshl_b32 s74, s42, 2
    s_add_u32 s74, s74, s38
    s_and_b32 s74, s74, 15
    s_lshl_b32 s74, s74, 12
    v_lshlrev_b32 v255, 6, v0
    v_add_u32 v255, s74, v255
    v_min_u32 v255, L_end-parallel_sum__linear_kernel_hedgehog__dense_activation_relu__prompt_kernel, v255
    global_load_dword v255, v255, s[72:73]
    v_lshrrev_b32 v196, 3, v0
    s_lshl_b32 s71, s36, 2
    s_add_u32 s71, s71, s38
    s_lshl_b32 s71, s71, 15
    v_lshl_add_u32 v196, v196, 10, s71
    v_lshrrev_b32 v197, 4, v0
    v_and_b32 v198, 7, v0
    v_mov_b32 v199, v197
    v_xor_b32 v199, v199, v198
    v_lshl_add_u32 v192, v199, 4, v196
    v_add_u32 v199, 4, v197
    v_xor_b32 v199, v199, v198
    v_lshl_add_u32 v193, v199, 4, v196
    v_add_u32 v193, 7168, v193
    v_add_u32 v194, 14336, v192
    v_add_u32 v195, 14336, v193
    s_lshl_b32 s75, s43, 7
    s_lshl_b32 m0, s38, 12
    v_lshrrev_b32 v197, 4, v0
    v_and_b32 v198, 15, v0
    v_lshlrev_b32 v196, 10, v197
    v_lshl_add_u32 v196, v198, 4, v196
    s_lshl_b32 s72, s36, 3
    s_add_u32 s72, s72, s100
    s_lshl_b32 s72, s72, 2
    s_add_u32 s72, s72, s38
    s_lshl_b32 s70, s72, 2
    s_lshl_b32 s72, s72, 12
    s_waitcnt lgkmcnt(0)
    s_mov_b32 s4, s44
    s_and_b32 s5, s45, 0xffff
    s_mov_b32 s6, 2097152
    s_mov_b32 s7, 0x00020000
    buffer_load_dwordx4 v192, s[4:7], s75 offen offset:0 lds
    buffer_load_dwordx4 v193, s[4:7], s75 offen offset:1024 lds
    buffer_load_dwordx4 v194, s[4:7], s75 offen offset:2048 lds
    buffer_load_dwordx4 v195, s[4:7], s75 offen offset:3072 lds
    s_cmp_eq_u32 s101, 1
    s_cbranch_scc1 L_mq
    buffer_load_dwordx4 v[208:211], v196, s[4:7], s72 offen offset:0
    buffer_load_dwordx4 v[212:215], v196, s[4:7], s72 offen offset:256
    buffer_load_dwordx4 v[216:219], v196, s[4:7], s72 offen offset:512
    buffer_load_dwordx4 v[220:223], v196, s[4:7], s72 offen offset:768
    s_add_u32 s74, s58, 19070976
    s_addc_u32 s75, s59, 0
    s_load_dword s99, s[74:75], 0
    s_mov_b32 s28, s58
    s_and_b32 s29, s59, 0xffff
    s_mov_b32 s30, 134217728
    s_mov_b32 s31, 0x00020000
    s_mov_b32 s24, s56
    s_and_b32 s25, s57, 0xffff
    s_mov_b32 s26, 2097152
    s_mov_b32 s27, 0x00020000
    v_lshrrev_b32 v27, 5, v0
    v_lshrrev_b32 v28, 2, v0
    v_and_b32 v28, 3, v28
    v_lshrrev_b32 v29, 4, v0
    v_and_b32 v29, 1, v29
    v_lshlrev_b32 v29, 5, v29
    v_and_b32 v30, 3, v0
    v_lshl_add_u32 v29, v30, 3, v29
    s_lshl_b32 s37, s100, 1
    s_add_u32 s37, s37, s101
    s_and_b32 s40, s42, 3
    s_lshl_b32 s41, s3, 2
    s_add_u32 s40, s40, s41
    s_lshr_b32 s41, s42, 2
    s_and_b32 s72, s42, 3
    s_lshl_b32 s96, s72, 1
    s_add_u32 s96, s96, s38
    s_and_b32 s96, s96, 7
    s_and_b32 s72, s72, 1
    s_lshl_b32 s73, s72, 2
    s_add_u32 s97, s41, s73
    s_and_b32 s97, s97, 7
    s_lshl_b32 s73, s72, 1
    s_add_u32 s98, s41, s73
    s_and_b32 s98, s98, 3
    v_and_b32 v26, 31, v0
    v_lshrrev_b32 v30, 1, v26
    v_and_b32 v30, 7, v30
    s_lshl_b32 s72, s38, 12
    v_lshl_add_u32 v31, v26, 7, s72
    v_add_u32 v1, 0, v27
    v_xor_b32 v1, v1, v30
    v_lshl_add_u32 v10, v1, 4, v31
    v_add_u32 v16, 0x10000, v10
    v_add_u32 v1, 2, v27
    v_xor_b32 v1, v1, v30
    v_lshl_add_u32 v11, v1, 4, v31
    v_add_u32 v17, 0x10000, v11
    v_add_u32 v1, 4, v27
    v_xor_b32 v1, v1, v30
    v_lshl_add_u32 v12, v1, 4, v31
    v_add_u32 v18, 0x10000, v12
    v_add_u32 v1, 6, v27
    v_xor_b32 v1, v1, v30
    v_lshl_add_u32 v13, v1, 4, v31
    v_add_u32 v19, 0x10000, v13
    v_lshl_add_u32 v1, v27, 3, v28
    v_lshl_add_u32 v14, v1, 7, v29
    v_lshrrev_b32 v1, 1, v28
    v_lshl_add_u32 v14, v1, 6, v14
    v_xor_b32 v15, 64, v14
    v_add_u32 v20, 81920, v14
    v_add_u32 v21, 81920, v15
    s_and_b32 s61, s38, 1
    s_lshr_b32 s60, s38, 1
    s_lshl_b32 s72, s61, 6
    v_xor_b32 v22, s72, v14
    s_lshl_b32 s73, s60, 13
    s_add_u32 s73, s73, 16384
    v_add_u32 v22, s73, v22
    s_and_b32 s73, s100, 1
    s_lshl_b32 s73, s73, 6
    s_cmp_eq_u32 s60, 0
    s_cselect_b32 s72, s72, s73
    s_lshl_b32 s73, s60, 13
    s_add_u32 s73, s73, 131072
    v_xor_b32 v24, s72, v14
    v_add_u32 v24, s73, v24
    v_and_b32 v1, 1, v197
    v_sub_u32 v1, v198, v1
    v_mov_b32 v200, 0x3f803f80
    v_cmp_eq_u32 vcc, 0, v1
    s_nop 1
    v_cndmask_b32 v228, 0, v200, vcc
    v_cndmask_b32 v229, 0, v200, vcc
    v_cndmask_b32 v230, 0, v200, vcc
    v_cndmask_b32 v231, 0, v200, vcc
    v_cmp_eq_u32 vcc, 4, v1
    s_nop 1
    v_cndmask_b32 v232, 0, v200, vcc
    v_cndmask_b32 v233, 0, v200, vcc
    v_cndmask_b32 v234, 0, v200, vcc
    v_cndmask_b32 v235, 0, v200, vcc
    v_lshlrev_b32 v1, 3, v26
    v_add_u32 v23, 158208, v1
    v_lshlrev_b32 v2, 4, v0
    s_lshl_b32 s72, s38, 12
    v_mul_u32_u24 v4, 136, v26
    v_lshl_add_u32 v4, v27, 3, v4
    s_mul_i32 s73, s38, 4352
    s_add_u32 s73, s73, 65536
    v_add_u32 v4, s73, v4
    v_lshl_add_u32 v202, v27, 2, v28
    v_lshlrev_b32 v202, 7, v202
    v_lshrrev_b32 v1, 1, v28
    v_lshl_add_u32 v202, v1, 6, v202
    s_lshl_b32 s73, s38, 11
    s_add_u32 s73, s73, 139264
    v_add3_u32 v28, v202, v29, s73
    v_xor_b32 v29, 64, v28
    s_add_u32 s72, s72, 98304
    v_add_u32 v3, s72, v2
    s_lshl_b32 s72, s38, 2
    s_add_u32 s72, s72, 160256
    v_mov_b32 v5, s72
    v_mov_b32 v7, 0
    s_lshl_b32 s72, s36, 2
    s_add_u32 s72, s72, s38
    s_lshl_b32 s72, s72, 3
    s_add_u32 s72, s72, s100
    s_mul_i32 s44, s72, 18432
    s_add_u32 s44, s44, 8192
    s_add_u32 s45, s44, 2048
    s_lshr_b32 s72, s2, 4
    s_bfe_u32 s73, s2, 0x30001
    s_and_b32 s74, s2, 1
    s_lshl_b32 s49, s73, 8
    s_lshl_b32 s75, s72, 5
    s_add_u32 s49, s49, s75
    s_lshl_b32 s75, s74, 2
    s_add_u32 s75, s75, s38
    s_lshl_b32 s75, s75, 2
    s_add_u32 s49, s49, s75
    s_add_u32 s49, s49, 19136512
    s_lshr_b32 s46, s2, 1
    s_mul_i32 s46, s46, 18
    s_mul_i32 s74, s74, 9
    s_add_u32 s46, s46, s74
    s_add_u32 s46, s46, s38
    s_lshl_b32 s46, s46, 11
    s_add_u32 s46, s46, 20971520
    s_add_u32 s47, s46, 8192
    s_add_u32 s48, s46, 16384
    s_mov_b32 s50, 0
    s_lshl_b32 s70, s70, 4
    s_add_u32 s70, s70, 18087936
    s_mov_b32 s66, 0x3f803f80
    v_mov_b32 v224, 0
    v_mov_b32 v225, 0
    v_mov_b32 v226, 0
    v_mov_b32 v227, 0
    v_lshlrev_b32 v196, 4, v197
    s_lshr_b32 s72, s36, 3
    s_lshl_b32 s68, s37, 1
    s_add_u32 s68, s68, s72
    s_lshl_b32 s68, s68, 14
    s_lshl_b32 s72, s38, 9
    s_add_u32 s68, s68, s72
    s_add_u32 s68, s68, 18350080
    s_lshl_b32 s51, s43, 11
    s_add_u32 s51, s51, s68
    s_lshl_b32 s71, s36, 11
    s_add_u32 s71, s71, s72
    s_add_u32 s71, s71, 18087936
    s_waitcnt lgkmcnt(0)
    s_mul_i32 s39, s99, 0x9E3779B1
    s_add_u32 s39, s39, 0x7F4A7C15
    s_and_b32 s52, s99, 3
    s_xor_b32 s53, s52, 1
    s_bfe_u32 s54, s99, 0x20002
    s_bfe_u32 s55, s99, 0x20004
    s_mul_i32 s52, s52, 0x40008000
    s_and_b32 s52, s52, 0x80008000
    s_mul_i32 s53, s53, 0x40008000
    s_and_b32 s53, s53, 0x80008000
    s_mul_i32 s54, s54, 0x40008000
    s_and_b32 s54, s54, 0x80008000
    s_mul_i32 s55, s55, 0x40008000
    s_and_b32 s55, s55, 0x80008000
    v_mov_b32 v6, s39
    s_waitcnt vmcnt(4)
    s_barrier
    ds_read_b128 v[128:131], v10 offset:0
    ds_read_b64_tr_b16 v[32:33], v14 offset:16384
    ds_read_b64_tr_b16 v[34:35], v14 offset:16896
    ds_read_b64_tr_b16 v[36:37], v15 offset:16384
    ds_read_b64_tr_b16 v[38:39], v15 offset:16896
    ds_read_b64_tr_b16 v[40:41], v14 offset:24576
    ds_read_b64_tr_b16 v[42:43], v14 offset:25088
    ds_read_b64_tr_b16 v[44:45], v15 offset:24576
    ds_read_b64_tr_b16 v[46:47], v15 offset:25088
    ds_read_b128 v[132:135], v11 offset:0
    ds_read_b64_tr_b16 v[48:49], v14 offset:18432
    ds_read_b64_tr_b16 v[50:51], v14 offset:18944
    ds_read_b64_tr_b16 v[52:53], v15 offset:18432
    ds_read_b64_tr_b16 v[54:55], v15 offset:18944
    ds_read_b64_tr_b16 v[56:57], v14 offset:26624
    s_waitcnt lgkmcnt(14)
    ds_read_b64_tr_b16 v[58:59], v14 offset:27136
    s_waitcnt lgkmcnt(14)
    ds_read_b64_tr_b16 v[60:61], v15 offset:26624
    s_waitcnt lgkmcnt(14)
    ds_read_b64_tr_b16 v[62:63], v15 offset:27136
    s_waitcnt lgkmcnt(14)
    ds_read_b128 v[136:139], v12 offset:0
    s_waitcnt lgkmcnt(14)
    ds_read_b128 v[140:143], v13 offset:0
    s_waitcnt vmcnt(0)
    v_dot2c_f32_bf16 v224, s66, v208
    v_dot2c_f32_bf16 v226, v208, v208
    v_dot2c_f32_bf16 v225, s66, v209
    v_dot2c_f32_bf16 v227, v209, v209
    v_dot2c_f32_bf16 v224, s66, v210
    v_dot2c_f32_bf16 v226, v210, v210
    v_dot2c_f32_bf16 v225, s66, v211
    v_dot2c_f32_bf16 v227, v211, v211
    v_dot2c_f32_bf16 v224, s66, v212
    v_dot2c_f32_bf16 v226, v212, v212
    v_dot2c_f32_bf16 v225, s66, v213
    v_dot2c_f32_bf16 v227, v213, v213
    v_dot2c_f32_bf16 v224, s66, v214
    v_dot2c_f32_bf16 v226, v214, v214
    v_dot2c_f32_bf16 v225, s66, v215
    v_dot2c_f32_bf16 v227, v215, v215
    v_dot2c_f32_bf16 v224, s66, v216
    v_dot2c_f32_bf16 v226, v216, v216
    v_dot2c_f32_bf16 v225, s66, v217
    v_dot2c_f32_bf16 v227, v217, v217
    v_dot2c_f32_bf16 v224, s66, v218
    v_dot2c_f32_bf16 v226, v218, v218
    v_dot2c_f32_bf16 v225, s66, v219
    v_dot2c_f32_bf16 v227, v219, v219
    v_dot2c_f32_bf16 v224, s66, v220
    v_dot2c_f32_bf16 v226, v220, v220
    v_dot2c_f32_bf16 v225, s66, v221
    v_dot2c_f32_bf16 v227, v221, v221
    v_dot2c_f32_bf16 v224, s66, v222
    v_dot2c_f32_bf16 v226, v222, v222
    v_dot2c_f32_bf16 v225, s66, v223
    v_dot2c_f32_bf16 v227, v223, v223
    s_nop 3
    v_add_f32 v224, v224, v225
    v_add_f32 v226, v226, v227
    s_nop 0
    v_add_f32_dpp v224, v224, v224 quad_perm:[1,0,3,2] row_mask:0xf bank_mask:0xf
    v_add_f32_dpp v226, v226, v226 quad_perm:[1,0,3,2] row_mask:0xf bank_mask:0xf
    s_nop 0
    v_add_f32_dpp v224, v224, v224 quad_perm:[2,3,0,1] row_mask:0xf bank_mask:0xf
    v_add_f32_dpp v226, v226, v226 quad_perm:[2,3,0,1] row_mask:0xf bank_mask:0xf
    s_nop 0
    v_add_f32_dpp v224, v224, v224 row_half_mirror row_mask:0xf bank_mask:0xf
    v_add_f32_dpp v226, v226, v226 row_half_mirror row_mask:0xf bank_mask:0xf
    s_nop 0
    v_add_f32_dpp v224, v224, v224 row_mirror row_mask:0xf bank_mask:0xf
    v_add_f32_dpp v226, v226, v226 row_mirror row_mask:0xf bank_mask:0xf
    v_mul_f32 v224, 0x3b000000, v224
    v_mul_f32 v226, 0x3b000000, v226
    v_fma_f32 v226, -v224, v224, v226
    v_max_f32 v226, 0, v226
    v_add_f32 v226, 0x3727c5ac, v226
    v_rsq_f32 v226, v226
    v_mov_b32 v225, v6
    v_mov_b32 v227, v6
    s_mov_b32 exec_lo, 0x10001
    s_mov_b32 exec_hi, 0x10001
    buffer_store_dwordx4 v[224:227], v196, s[28:31], s70 offen sc1
    s_mov_b64 exec, -1
    v_mfma_f32_32x32x16_bf16 v[64:79], v[32:35], v[128:131], 0
    s_waitcnt lgkmcnt(14)
    ds_read_b64_tr_b16 v[32:33], v14 offset:20480
    s_waitcnt lgkmcnt(14)
    ds_read_b64_tr_b16 v[34:35], v14 offset:20992
    s_waitcnt lgkmcnt(14)
    ds_read_b64_tr_b16 v[192:193], v22 offset:0
    s_waitcnt lgkmcnt(14)
    ds_read_b64_tr_b16 v[194:195], v22 offset:512
    v_mfma_f32_32x32x16_bf16 v[80:95], v[36:39], v[128:131], 0
    s_waitcnt lgkmcnt(14)
    ds_read_b64_tr_b16 v[36:37], v15 offset:20480
    s_waitcnt lgkmcnt(14)
    ds_read_b64_tr_b16 v[38:39], v15 offset:20992
    s_waitcnt lgkmcnt(14)
    ds_read_b64_tr_b16 v[196:197], v22 offset:2048
    s_waitcnt lgkmcnt(14)
    ds_read_b64_tr_b16 v[198:199], v22 offset:2560
    v_mfma_f32_32x32x16_bf16 v[96:111], v[40:43], v[128:131], 0
    s_waitcnt lgkmcnt(14)
    ds_read_b64_tr_b16 v[40:41], v14 offset:28672
    s_waitcnt lgkmcnt(14)
    ds_read_b64_tr_b16 v[42:43], v14 offset:29184
    s_waitcnt lgkmcnt(14)
    ds_read_b64_tr_b16 v[200:201], v22 offset:4096
    s_waitcnt lgkmcnt(14)
    ds_read_b64_tr_b16 v[202:203], v22 offset:4608
    v_mfma_f32_32x32x16_bf16 v[112:127], v[44:47], v[128:131], 0
    s_waitcnt lgkmcnt(14)
    ds_read_b64_tr_b16 v[44:45], v15 offset:28672
    s_waitcnt lgkmcnt(14)
    ds_read_b64_tr_b16 v[46:47], v15 offset:29184
    s_waitcnt lgkmcnt(14)
    ds_read_b64_tr_b16 v[204:205], v22 offset:6144
    s_waitcnt lgkmcnt(14)
    ds_read_b64_tr_b16 v[206:207], v22 offset:6656
    v_mfma_f32_32x32x16_bf16 v[64:79], v[48:51], v[132:135], v[64:79]
    s_waitcnt lgkmcnt(14)
    ds_read_b64_tr_b16 v[48:49], v14 offset:22528
    s_waitcnt lgkmcnt(14)
    ds_read_b64_tr_b16 v[50:51], v14 offset:23040
    v_mfma_f32_32x32x16_bf16 v[80:95], v[52:55], v[132:135], v[80:95]
    s_waitcnt lgkmcnt(14)
    ds_read_b64_tr_b16 v[52:53], v15 offset:22528
    s_waitcnt lgkmcnt(14)
    ds_read_b64_tr_b16 v[54:55], v15 offset:23040
    v_mfma_f32_32x32x16_bf16 v[96:111], v[56:59], v[132:135], v[96:111]
    s_waitcnt lgkmcnt(14)
    ds_read_b64_tr_b16 v[56:57], v14 offset:30720
    s_waitcnt lgkmcnt(14)
    ds_read_b64_tr_b16 v[58:59], v14 offset:31232
    v_mfma_f32_32x32x16_bf16 v[112:127], v[60:63], v[132:135], v[112:127]
    s_waitcnt lgkmcnt(14)
    ds_read_b64_tr_b16 v[60:61], v15 offset:30720
    s_waitcnt lgkmcnt(14)
    ds_read_b64_tr_b16 v[62:63], v15 offset:31232
    s_waitcnt lgkmcnt(8)
    v_mfma_f32_16x16x32_bf16 v[236:239], v[228:231], v[192:195], 0
    v_mfma_f32_16x16x32_bf16 v[236:239], v[228:231], v[196:199], v[236:239]
    v_mfma_f32_32x32x16_bf16 v[64:79], v[32:35], v[136:139], v[64:79]
    v_mfma_f32_16x16x32_bf16 v[236:239], v[228:231], v[200:203], v[236:239]
    v_mfma_f32_16x16x32_bf16 v[236:239], v[228:231], v[204:207], v[236:239]
    v_mfma_f32_32x32x16_bf16 v[80:95], v[36:39], v[136:139], v[80:95]
    v_mfma_f32_32x32x16_bf16 v[96:111], v[40:43], v[136:139], v[96:111]
    v_mfma_f32_32x32x16_bf16 v[112:127], v[44:47], v[136:139], v[112:127]
    s_waitcnt lgkmcnt(6)
    v_mfma_f32_32x32x16_bf16 v[64:79], v[48:51], v[140:143], v[64:79]
    s_waitcnt lgkmcnt(4)
    v_mfma_f32_32x32x16_bf16 v[80:95], v[52:55], v[140:143], v[80:95]
    s_waitcnt lgkmcnt(2)
    v_mfma_f32_32x32x16_bf16 v[96:111], v[56:59], v[140:143], v[96:111]
    s_waitcnt lgkmcnt(0)
    v_mfma_f32_32x32x16_bf16 v[112:127], v[60:63], v[140:143], v[112:127]
    s_waitcnt lgkmcnt(0)
    s_barrier
    ds_read_b128 v[144:147], v10 offset:32768
    ds_read_b64_tr_b16 v[32:33], v14 offset:49152
    ds_read_b64_tr_b16 v[34:35], v14 offset:49664
    ds_read_b64_tr_b16 v[36:37], v15 offset:49152
    ds_read_b64_tr_b16 v[38:39], v15 offset:49664
    ds_read_b64_tr_b16 v[240:241], v28 offset:0
    ds_read_b64_tr_b16 v[242:243], v28 offset:1024
    s_waitcnt lgkmcnt(4)
    v_mfma_f32_32x32x16_bf16 v[64:79], v[32:35], v[144:147], v[64:79]
    ds_read_b64_tr_b16 v[40:41], v14 offset:57344
    ds_read_b64_tr_b16 v[42:43], v14 offset:57856
    ds_read_b64_tr_b16 v[44:45], v15 offset:57344
    ds_read_b64_tr_b16 v[46:47], v15 offset:57856
    ds_read_b128 v[148:151], v11 offset:32768
    ds_read_b64_tr_b16 v[244:245], v29 offset:0
    ds_read_b64_tr_b16 v[246:247], v29 offset:1024
    s_waitcnt lgkmcnt(9)
    v_mfma_f32_32x32x16_bf16 v[80:95], v[36:39], v[144:147], v[80:95]
    ds_read_b64_tr_b16 v[48:49], v14 offset:51200
    ds_read_b64_tr_b16 v[50:51], v14 offset:51712
    ds_read_b64_tr_b16 v[52:53], v15 offset:51200
    ds_read_b64_tr_b16 v[54:55], v15 offset:51712
    ds_read_b64_tr_b16 v[56:57], v14 offset:59392
    ds_read_b64_tr_b16 v[58:59], v14 offset:59904
    s_waitcnt lgkmcnt(14)
    ds_read_b64_tr_b16 v[248:249], v28 offset:8192
    s_waitcnt lgkmcnt(14)
    ds_read_b64_tr_b16 v[250:251], v28 offset:9216
    s_waitcnt lgkmcnt(13)
    v_mfma_f32_32x32x16_bf16 v[96:111], v[40:43], v[144:147], v[96:111]
    ds_read_b64_tr_b16 v[60:61], v15 offset:59392
    ds_read_b64_tr_b16 v[62:63], v15 offset:59904
    s_waitcnt lgkmcnt(14)
    ds_read_b128 v[152:155], v12 offset:32768
    s_waitcnt lgkmcnt(14)
    ds_read_b64_tr_b16 v[32:33], v14 offset:53248
    s_waitcnt lgkmcnt(14)
    ds_read_b64_tr_b16 v[34:35], v14 offset:53760
    s_waitcnt lgkmcnt(14)
    ds_read_b64_tr_b16 v[252:253], v29 offset:8192
    s_waitcnt lgkmcnt(14)
    ds_read_b64_tr_b16 v[254:255], v29 offset:9216
    v_mfma_f32_32x32x16_bf16 v[112:127], v[44:47], v[144:147], v[112:127]
    s_waitcnt lgkmcnt(14)
    ds_read_b64_tr_b16 v[36:37], v15 offset:53248
    s_waitcnt lgkmcnt(14)
    ds_read_b64_tr_b16 v[38:39], v15 offset:53760
    s_waitcnt lgkmcnt(14)
    ds_read_b64_tr_b16 v[40:41], v14 offset:61440
    s_waitcnt lgkmcnt(14)
    ds_read_b64_tr_b16 v[42:43], v14 offset:61952
    s_waitcnt lgkmcnt(14)
    ds_read_b64_tr_b16 v[44:45], v15 offset:61440
    s_waitcnt lgkmcnt(14)
    ds_read_b64_tr_b16 v[46:47], v15 offset:61952
    buffer_store_dwordx4 v[240:243], v2, s[28:31], s46 offen offset:0 sc1
    v_mfma_f32_32x32x16_bf16 v[64:79], v[48:51], v[148:151], v[64:79]
    s_waitcnt lgkmcnt(14)
    ds_read_b128 v[156:159], v13 offset:32768
    s_waitcnt lgkmcnt(14)
    ds_read_b64_tr_b16 v[48:49], v14 offset:55296
    s_waitcnt lgkmcnt(14)
    ds_read_b64_tr_b16 v[50:51], v14 offset:55808
    v_mfma_f32_32x32x16_bf16 v[80:95], v[52:55], v[148:151], v[80:95]
    s_waitcnt lgkmcnt(14)
    ds_read_b64_tr_b16 v[52:53], v15 offset:55296
    s_waitcnt lgkmcnt(14)
    ds_read_b64_tr_b16 v[54:55], v15 offset:55808
    buffer_store_dwordx4 v[244:247], v2, s[28:31], s46 offen offset:1024 sc1
    v_mfma_f32_32x32x16_bf16 v[96:111], v[56:59], v[148:151], v[96:111]
    s_waitcnt lgkmcnt(14)
    ds_read_b64_tr_b16 v[56:57], v14 offset:63488
    s_waitcnt lgkmcnt(14)
    ds_read_b64_tr_b16 v[58:59], v14 offset:64000
    v_mfma_f32_32x32x16_bf16 v[112:127], v[60:63], v[148:151], v[112:127]
    s_waitcnt lgkmcnt(14)
    ds_read_b64_tr_b16 v[60:61], v15 offset:63488
    s_waitcnt lgkmcnt(14)
    ds_read_b64_tr_b16 v[62:63], v15 offset:64000
    buffer_store_dwordx4 v[248:251], v2, s[28:31], s47 offen offset:0 sc1
    v_mfma_f32_32x32x16_bf16 v[64:79], v[32:35], v[152:155], v[64:79]
    s_getreg_b32 s72, hwreg(HW_REG_IB_STS)
    s_and_b32 s72, s72, 12582927
    s_or_b32 s72, s72, s50
    s_cbranch_scc1 L_ft_1
    s_mov_b64 exec, 1
    buffer_store_dword v6, v7, s[28:31], s49 offen sc1
    s_mov_b64 exec, -1
    s_mov_b32 s50, 1
L_ft_1:
    s_waitcnt lgkmcnt(13)
    v_mfma_f32_32x32x16_bf16 v[80:95], v[36:39], v[152:155], v[80:95]
    buffer_store_dwordx4 v[252:255], v2, s[28:31], s47 offen offset:1024 sc1
    s_waitcnt lgkmcnt(11)
    v_mfma_f32_32x32x16_bf16 v[96:111], v[40:43], v[152:155], v[96:111]
    s_waitcnt lgkmcnt(9)
    v_mfma_f32_32x32x16_bf16 v[112:127], v[44:47], v[152:155], v[112:127]
    s_cmp_lg_u32 s38, 0
    s_cbranch_scc1 L_nuc
    ds_read_b64_tr_b16 v[192:193], v28 offset:16384
    ds_read_b64_tr_b16 v[194:195], v28 offset:17408
    ds_read_b64_tr_b16 v[196:197], v29 offset:16384
    ds_read_b64_tr_b16 v[198:199], v29 offset:17408
    s_waitcnt lgkmcnt(0)
    buffer_store_dwordx4 v[192:195], v2, s[28:31], s48 offen offset:0 sc1
    buffer_store_dwordx4 v[196:199], v2, s[28:31], s48 offen offset:1024 sc1
L_nuc:
    s_waitcnt lgkmcnt(6)
    v_mfma_f32_32x32x16_bf16 v[64:79], v[48:51], v[156:159], v[64:79]
    s_getreg_b32 s72, hwreg(HW_REG_IB_STS)
    s_and_b32 s72, s72, 12582927
    s_or_b32 s72, s72, s50
    s_cbranch_scc1 L_ft_2
    s_mov_b64 exec, 1
    buffer_store_dword v6, v7, s[28:31], s49 offen sc1
    s_mov_b64 exec, -1
    s_mov_b32 s50, 1
L_ft_2:
    s_waitcnt lgkmcnt(4)
    v_mfma_f32_32x32x16_bf16 v[80:95], v[52:55], v[156:159], v[80:95]
    s_waitcnt lgkmcnt(2)
    v_mfma_f32_32x32x16_bf16 v[96:111], v[56:59], v[156:159], v[96:111]
    s_waitcnt lgkmcnt(0)
    v_mfma_f32_32x32x16_bf16 v[112:127], v[60:63], v[156:159], v[112:127]
    s_waitcnt lgkmcnt(0)
    s_barrier
    ds_read_b128 v[160:163], v16 offset:0
    ds_read_b64_tr_b16 v[32:33], v20 offset:0
    ds_read_b64_tr_b16 v[34:35], v20 offset:512
    ds_read_b64_tr_b16 v[36:37], v21 offset:0
    ds_read_b64_tr_b16 v[38:39], v21 offset:512
    ds_read_b64_tr_b16 v[208:209], v24 offset:0
    ds_read_b64_tr_b16 v[210:211], v24 offset:512
    s_waitcnt lgkmcnt(4)
    v_mfma_f32_32x32x16_bf16 v[64:79], v[32:35], v[160:163], v[64:79]
    ds_read_b64_tr_b16 v[40:41], v20 offset:8192
    ds_read_b64_tr_b16 v[42:43], v20 offset:8704
    ds_read_b64_tr_b16 v[44:45], v21 offset:8192
    ds_read_b64_tr_b16 v[46:47], v21 offset:8704
    ds_read_b128 v[164:167], v17 offset:0
    ds_read_b64_tr_b16 v[212:213], v24 offset:2048
    ds_read_b64_tr_b16 v[214:215], v24 offset:2560
    s_waitcnt lgkmcnt(9)
    v_mfma_f32_32x32x16_bf16 v[80:95], v[36:39], v[160:163], v[80:95]
    ds_read_b64_tr_b16 v[48:49], v20 offset:2048
    ds_read_b64_tr_b16 v[50:51], v20 offset:2560
    ds_read_b64_tr_b16 v[52:53], v21 offset:2048
    ds_read_b64_tr_b16 v[54:55], v21 offset:2560
    ds_read_b64_tr_b16 v[56:57], v20 offset:10240
    ds_read_b64_tr_b16 v[58:59], v20 offset:10752
    s_waitcnt lgkmcnt(14)
    ds_read_b64_tr_b16 v[216:217], v24 offset:4096
    s_waitcnt lgkmcnt(14)
    ds_read_b64_tr_b16 v[218:219], v24 offset:4608
    s_waitcnt lgkmcnt(13)
    v_mfma_f32_32x32x16_bf16 v[96:111], v[40:43], v[160:163], v[96:111]
    ds_read_b64_tr_b16 v[60:61], v21 offset:10240
    ds_read_b64_tr_b16 v[62:63], v21 offset:10752
    s_waitcnt lgkmcnt(14)
    ds_read_b128 v[168:171], v18 offset:0
    s_waitcnt lgkmcnt(14)
    ds_read_b64_tr_b16 v[32:33], v20 offset:4096
    s_waitcnt lgkmcnt(14)
    ds_read_b64_tr_b16 v[34:35], v20 offset:4608
    s_waitcnt lgkmcnt(14)
    ds_read_b64_tr_b16 v[220:221], v24 offset:6144
    s_waitcnt lgkmcnt(14)
    ds_read_b64_tr_b16 v[222:223], v24 offset:6656
    v_mfma_f32_32x32x16_bf16 v[112:127], v[44:47], v[160:163], v[112:127]
    s_waitcnt lgkmcnt(14)
    ds_read_b64_tr_b16 v[36:37], v21 offset:4096
    s_waitcnt lgkmcnt(14)
    ds_read_b64_tr_b16 v[38:39], v21 offset:4608
    s_waitcnt lgkmcnt(14)
    ds_read_b64_tr_b16 v[40:41], v20 offset:12288
    s_waitcnt lgkmcnt(14)
    ds_read_b64_tr_b16 v[42:43], v20 offset:12800
    s_waitcnt lgkmcnt(14)
    ds_read_b64_tr_b16 v[44:45], v21 offset:12288
    s_waitcnt lgkmcnt(14)
    ds_read_b64_tr_b16 v[46:47], v21 offset:12800
    s_getreg_b32 s72, hwreg(HW_REG_IB_STS)
    s_and_b32 s72, s72, 12582927
    s_or_b32 s72, s72, s50
    s_cbranch_scc1 L_ft_3
    s_mov_b64 exec, 1
    buffer_store_dword v6, v7, s[28:31], s49 offen sc1
    s_mov_b64 exec, -1
    s_mov_b32 s50, 1
L_ft_3:
    v_mfma_f32_32x32x16_bf16 v[64:79], v[48:51], v[164:167], v[64:79]
    s_waitcnt lgkmcnt(14)
    ds_read_b128 v[172:175], v19 offset:0
    s_waitcnt lgkmcnt(14)
    ds_read_b64_tr_b16 v[48:49], v20 offset:6144
    s_waitcnt lgkmcnt(14)
    ds_read_b64_tr_b16 v[50:51], v20 offset:6656
    s_waitcnt lgkmcnt(9)
    v_mfma_f32_16x16x32_bf16 v[224:227], v[232:235], v[208:211], 0
    v_mfma_f32_16x16x32_bf16 v[224:227], v[232:235], v[212:215], v[224:227]
    v_mfma_f32_32x32x16_bf16 v[80:95], v[52:55], v[164:167], v[80:95]
    ds_read_b64_tr_b16 v[52:53], v21 offset:6144
    ds_read_b64_tr_b16 v[54:55], v21 offset:6656
    v_mfma_f32_16x16x32_bf16 v[224:227], v[232:235], v[216:219], v[224:227]
    v_mfma_f32_16x16x32_bf16 v[224:227], v[232:235], v[220:223], v[224:227]
    v_mfma_f32_32x32x16_bf16 v[96:111], v[56:59], v[164:167], v[96:111]
    ds_read_b64_tr_b16 v[56:57], v20 offset:14336
    ds_read_b64_tr_b16 v[58:59], v20 offset:14848
    s_getreg_b32 s72, hwreg(HW_REG_IB_STS)
    s_and_b32 s72, s72, 12582927
    s_or_b32 s72, s72, s50
    s_cbranch_scc1 L_ft_4
    s_mov_b64 exec, 1
    buffer_store_dword v6, v7, s[28:31], s49 offen sc1
    s_mov_b64 exec, -1
    s_mov_b32 s50, 1
L_ft_4:
    v_mfma_f32_32x32x16_bf16 v[112:127], v[60:63], v[164:167], v[112:127]
    ds_read_b64_tr_b16 v[60:61], v21 offset:14336
    ds_read_b64_tr_b16 v[62:63], v21 offset:14848
    v_cmp_gt_u32 vcc, 16, v0
    v_mov_b32 v238, v237
    v_mfma_f32_32x32x16_bf16 v[64:79], v[32:35], v[168:171], v[64:79]
    v_cndmask_b32 v236, v224, v236, vcc
    v_cndmask_b32 v238, v225, v238, vcc
    s_waitcnt lgkmcnt(13)
    v_mfma_f32_32x32x16_bf16 v[80:95], v[36:39], v[168:171], v[80:95]
    v_mov_b32 v237, v6
    v_mov_b32 v239, v6
    s_waitcnt lgkmcnt(11)
    v_mfma_f32_32x32x16_bf16 v[96:111], v[40:43], v[168:171], v[96:111]
    s_mov_b32 exec_hi, 0
    buffer_store_dwordx4 v[236:239], v2, s[28:31], s51 offen sc1
    s_mov_b32 exec_hi, -1
    s_getreg_b32 s72, hwreg(HW_REG_IB_STS)
    s_and_b32 s72, s72, 12582926
    s_or_b32 s72, s72, s50
    s_cbranch_scc1 L_ft_5
    s_mov_b64 exec, 1
    buffer_store_dword v6, v7, s[28:31], s49 offen sc1
    s_mov_b64 exec, -1
    s_mov_b32 s50, 1
L_ft_5:
    s_waitcnt lgkmcnt(9)
    v_mfma_f32_32x32x16_bf16 v[112:127], v[44:47], v[168:171], v[112:127]
    s_waitcnt lgkmcnt(6)
    v_mfma_f32_32x32x16_bf16 v[64:79], v[48:51], v[172:175], v[64:79]
    s_getreg_b32 s72, hwreg(HW_REG_IB_STS)
    s_and_b32 s72, s72, 12582926
    s_or_b32 s72, s72, s50
    s_cbranch_scc1 L_ft_6
    s_mov_b64 exec, 1
    buffer_store_dword v6, v7, s[28:31], s49 offen sc1
    s_mov_b64 exec, -1
    s_mov_b32 s50, 1
L_ft_6:
    s_add_u32 s8, s97, 0
    s_waitcnt lgkmcnt(4)
    v_mfma_f32_32x32x16_bf16 v[80:95], v[52:55], v[172:175], v[80:95]
    s_and_b32 s8, s8, 7
    s_lshl_b32 s8, s8, 10
    s_waitcnt lgkmcnt(2)
    v_mfma_f32_32x32x16_bf16 v[96:111], v[56:59], v[172:175], v[96:111]
    s_add_u32 s9, s97, 1
    s_and_b32 s9, s9, 7
    s_waitcnt lgkmcnt(0)
    v_mfma_f32_32x32x16_bf16 v[112:127], v[60:63], v[172:175], v[112:127]
    s_waitcnt lgkmcnt(0)
    s_barrier
    ds_read_b128 v[176:179], v16 offset:32768
    ds_read_b64_tr_b16 v[32:33], v20 offset:32768
    ds_read_b64_tr_b16 v[34:35], v20 offset:33280
    ds_read_b64_tr_b16 v[36:37], v21 offset:32768
    ds_read_b64_tr_b16 v[38:39], v21 offset:33280
    s_lshl_b32 s9, s9, 10
    s_add_u32 s10, s97, 2
    s_waitcnt lgkmcnt(2)
    v_mfma_f32_32x32x16_bf16 v[64:79], v[32:35], v[176:179], v[64:79]
    ds_read_b64_tr_b16 v[40:41], v20 offset:40960
    ds_read_b64_tr_b16 v[42:43], v20 offset:41472
    ds_read_b64_tr_b16 v[44:45], v21 offset:40960
    ds_read_b64_tr_b16 v[46:47], v21 offset:41472
    ds_read_b128 v[180:183], v17 offset:32768
    s_getreg_b32 s72, hwreg(HW_REG_IB_STS)
    s_and_b32 s72, s72, 12582926
    s_or_b32 s72, s72, s50
    s_cbranch_scc1 L_ft_7
    s_mov_b64 exec, 1
    buffer_store_dword v6, v7, s[28:31], s49 offen sc1
    s_mov_b64 exec, -1
    s_mov_b32 s50, 1
L_ft_7:
    s_and_b32 s10, s10, 7
    s_waitcnt lgkmcnt(5)
    v_mfma_f32_32x32x16_bf16 v[80:95], v[36:39], v[176:179], v[80:95]
    ds_read_b64_tr_b16 v[48:49], v20 offset:34816
    ds_read_b64_tr_b16 v[50:51], v20 offset:35328
    ds_read_b64_tr_b16 v[52:53], v21 offset:34816
    ds_read_b64_tr_b16 v[54:55], v21 offset:35328
    ds_read_b64_tr_b16 v[56:57], v20 offset:43008
    ds_read_b64_tr_b16 v[58:59], v20 offset:43520
    s_lshl_b32 s10, s10, 10
    s_add_u32 s11, s97, 3
    s_waitcnt lgkmcnt(9)
    v_mfma_f32_32x32x16_bf16 v[96:111], v[40:43], v[176:179], v[96:111]
    ds_read_b64_tr_b16 v[60:61], v21 offset:43008
    ds_read_b64_tr_b16 v[62:63], v21 offset:43520
    ds_read_b128 v[184:187], v18 offset:32768
    ds_read_b64_tr_b16 v[32:33], v20 offset:36864
    ds_read_b64_tr_b16 v[34:35], v20 offset:37376
    s_and_b32 s11, s11, 7
    s_lshl_b32 s11, s11, 10
    s_waitcnt lgkmcnt(12)
    v_mfma_f32_32x32x16_bf16 v[112:127], v[44:47], v[176:179], v[112:127]
    ds_read_b64_tr_b16 v[36:37], v21 offset:36864
    ds_read_b64_tr_b16 v[38:39], v21 offset:37376
    ds_read_b64_tr_b16 v[40:41], v20 offset:45056
    s_waitcnt lgkmcnt(14)
    ds_read_b64_tr_b16 v[42:43], v20 offset:45568
    s_waitcnt lgkmcnt(14)
    ds_read_b64_tr_b16 v[44:45], v21 offset:45056
    s_waitcnt lgkmcnt(14)
    ds_read_b64_tr_b16 v[46:47], v21 offset:45568
    s_add_u32 s12, s97, 4
    s_and_b32 s12, s12, 7
    v_mfma_f32_32x32x16_bf16 v[64:79], v[48:51], v[180:183], v[64:79]
    s_waitcnt lgkmcnt(14)
    ds_read_b128 v[188:191], v19 offset:32768
    s_waitcnt lgkmcnt(14)
    ds_read_b64_tr_b16 v[48:49], v20 offset:38912
    s_waitcnt lgkmcnt(14)
    ds_read_b64_tr_b16 v[50:51], v20 offset:39424
    s_lshl_b32 s12, s12, 10
    s_add_u32 s13, s97, 5
    v_mfma_f32_32x32x16_bf16 v[80:95], v[52:55], v[180:183], v[80:95]
    s_waitcnt lgkmcnt(14)
    ds_read_b64_tr_b16 v[52:53], v21 offset:38912
    s_waitcnt lgkmcnt(14)
    ds_read_b64_tr_b16 v[54:55], v21 offset:39424
    s_and_b32 s13, s13, 7
    s_lshl_b32 s13, s13, 10
    v_mfma_f32_32x32x16_bf16 v[96:111], v[56:59], v[180:183], v[96:111]
    s_waitcnt lgkmcnt(14)
    ds_read_b64_tr_b16 v[56:57], v20 offset:47104
    s_waitcnt lgkmcnt(14)
    ds_read_b64_tr_b16 v[58:59], v20 offset:47616
    s_getreg_b32 s72, hwreg(HW_REG_IB_STS)
    s_and_b32 s72, s72, 12582926
    s_or_b32 s72, s72, s50
    s_cbranch_scc1 L_ft_8
    s_mov_b64 exec, 1
    buffer_store_dword v6, v7, s[28:31], s49 offen sc1
    s_mov_b64 exec, -1
    s_mov_b32 s50, 1
L_ft_8:
    s_add_u32 s14, s97, 6
    v_mfma_f32_32x32x16_bf16 v[112:127], v[60:63], v[180:183], v[112:127]
    s_waitcnt lgkmcnt(14)
    ds_read_b64_tr_b16 v[60:61], v21 offset:47104
    s_waitcnt lgkmcnt(14)
    ds_read_b64_tr_b16 v[62:63], v21 offset:47616
    s_and_b32 s14, s14, 7
    s_lshl_b32 s14, s14, 10
    v_mfma_f32_32x32x16_bf16 v[64:79], v[32:35], v[184:187], v[64:79]
    s_add_u32 s15, s97, 7
    s_and_b32 s15, s15, 7
    s_waitcnt lgkmcnt(13)
    v_mfma_f32_32x32x16_bf16 v[80:95], v[36:39], v[184:187], v[80:95]
    s_lshl_b32 s15, s15, 10
    s_add_u32 s16, s98, 0
    s_waitcnt lgkmcnt(11)
    v_mfma_f32_32x32x16_bf16 v[96:111], v[40:43], v[184:187], v[96:111]
    s_and_b32 s16, s16, 3
    s_lshl_b32 s16, s16, 10
    s_waitcnt lgkmcnt(9)
    v_mfma_f32_32x32x16_bf16 v[112:127], v[44:47], v[184:187], v[112:127]
    s_add_u32 s16, s16, 8192
    s_add_u32 s17, s98, 1
    s_waitcnt lgkmcnt(6)
    v_mfma_f32_32x32x16_bf16 v[64:79], v[48:51], v[188:191], v[64:79]
    s_getreg_b32 s72, hwreg(HW_REG_IB_STS)
    s_and_b32 s72, s72, 12582926
    s_or_b32 s72, s72, s50
    s_cbranch_scc1 L_ft_9
    s_mov_b64 exec, 1
    buffer_store_dword v6, v7, s[28:31], s49 offen sc1
    s_mov_b64 exec, -1
    s_mov_b32 s50, 1
L_ft_9:
    s_and_b32 s17, s17, 3
    s_waitcnt lgkmcnt(4)
    v_mfma_f32_32x32x16_bf16 v[80:95], v[52:55], v[188:191], v[80:95]
    s_lshl_b32 s17, s17, 10
    s_add_u32 s17, s17, 8192
    s_waitcnt lgkmcnt(2)
    v_mfma_f32_32x32x16_bf16 v[96:111], v[56:59], v[188:191], v[96:111]
    s_add_u32 s18, s98, 2
    s_and_b32 s18, s18, 3
    s_waitcnt lgkmcnt(0)
    v_mfma_f32_32x32x16_bf16 v[112:127], v[60:63], v[188:191], v[112:127]
    s_waitcnt lgkmcnt(0)
    s_barrier
    ds_read_b128 v[192:195], v10 offset:0
    ds_read_b64_tr_b16 v[32:33], v14 offset:16384
    ds_read_b64_tr_b16 v[34:35], v14 offset:16896
    ds_read_b64_tr_b16 v[36:37], v15 offset:16384
    ds_read_b64_tr_b16 v[38:39], v15 offset:16896
    s_lshl_b32 s18, s18, 10
    s_add_u32 s18, s18, 8192
    s_waitcnt lgkmcnt(2)
    v_mfma_f32_32x32x16_bf16 v[64:79], v[32:35], v[192:195], v[64:79]
    ds_read_b64_tr_b16 v[40:41], v14 offset:24576
    ds_read_b64_tr_b16 v[42:43], v14 offset:25088
    ds_read_b64_tr_b16 v[44:45], v15 offset:24576
    ds_read_b64_tr_b16 v[46:47], v15 offset:25088
    ds_read_b128 v[196:199], v11 offset:0
    s_add_u32 s19, s98, 3
    s_and_b32 s19, s19, 3
    s_waitcnt lgkmcnt(5)
    v_mfma_f32_32x32x16_bf16 v[80:95], v[36:39], v[192:195], v[80:95]
    ds_read_b64_tr_b16 v[48:49], v14 offset:18432
    ds_read_b64_tr_b16 v[50:51], v14 offset:18944
    ds_read_b64_tr_b16 v[52:53], v15 offset:18432
    ds_read_b64_tr_b16 v[54:55], v15 offset:18944
    ds_read_b64_tr_b16 v[56:57], v14 offset:26624
    ds_read_b64_tr_b16 v[58:59], v14 offset:27136
    s_lshl_b32 s19, s19, 10
    s_add_u32 s19, s19, 8192
    s_waitcnt lgkmcnt(9)
    v_mfma_f32_32x32x16_bf16 v[96:111], v[40:43], v[192:195], v[96:111]
    ds_read_b64_tr_b16 v[60:61], v15 offset:26624
    ds_read_b64_tr_b16 v[62:63], v15 offset:27136
    ds_read_b128 v[200:203], v12 offset:0
    ds_read_b64_tr_b16 v[32:33], v14 offset:20480
    ds_read_b64_tr_b16 v[34:35], v14 offset:20992
    s_getreg_b32 s72, hwreg(HW_REG_IB_STS)
    s_and_b32 s72, s72, 12582926
    s_or_b32 s72, s72, s50
    s_cbranch_scc1 L_ft_10
    s_mov_b64 exec, 1
    buffer_store_dword v6, v7, s[28:31], s49 offen sc1
    s_mov_b64 exec, -1
    s_mov_b32 s50, 1
L_ft_10:
    s_mov_b32 s20, 12288
    s_waitcnt lgkmcnt(12)
    v_mfma_f32_32x32x16_bf16 v[112:127], v[44:47], v[192:195], v[112:127]
    ds_read_b64_tr_b16 v[36:37], v15 offset:20480
    ds_read_b64_tr_b16 v[38:39], v15 offset:20992
    ds_read_b64_tr_b16 v[40:41], v14 offset:28672
    s_waitcnt lgkmcnt(14)
    ds_read_b64_tr_b16 v[42:43], v14 offset:29184
    s_waitcnt lgkmcnt(14)
    ds_read_b64_tr_b16 v[44:45], v15 offset:28672
    s_waitcnt lgkmcnt(14)
    ds_read_b64_tr_b16 v[46:47], v15 offset:29184
    s_mov_b32 s21, 13312
    s_add_u32 s22, s16, 6144
    v_mfma_f32_32x32x16_bf16 v[64:79], v[48:51], v[196:199], v[64:79]
    s_waitcnt lgkmcnt(14)
    ds_read_b128 v[204:207], v13 offset:0
    s_waitcnt lgkmcnt(14)
    ds_read_b64_tr_b16 v[48:49], v14 offset:22528
    s_waitcnt lgkmcnt(14)
    ds_read_b64_tr_b16 v[50:51], v14 offset:23040
    s_add_u32 s23, s17, 6144
    s_add_u32 s32, s18, 6144
    v_mfma_f32_32x32x16_bf16 v[80:95], v[52:55], v[196:199], v[80:95]
    s_waitcnt lgkmcnt(14)
    ds_read_b64_tr_b16 v[52:53], v15 offset:22528
    s_waitcnt lgkmcnt(14)
    ds_read_b64_tr_b16 v[54:55], v15 offset:23040
    s_add_u32 s33, s19, 6144
    v_mfma_f32_32x32x16_bf16 v[96:111], v[56:59], v[196:199], v[96:111]
    s_waitcnt lgkmcnt(14)
    ds_read_b64_tr_b16 v[56:57], v14 offset:30720
    s_waitcnt lgkmcnt(14)
    ds_read_b64_tr_b16 v[58:59], v14 offset:31232
    v_mfma_f32_32x32x16_bf16 v[112:127], v[60:63], v[196:199], v[112:127]
    s_waitcnt lgkmcnt(14)
    ds_read_b64_tr_b16 v[60:61], v15 offset:30720
    s_waitcnt lgkmcnt(14)
    ds_read_b64_tr_b16 v[62:63], v15 offset:31232
    v_mfma_f32_32x32x16_bf16 v[64:79], v[32:35], v[200:203], v[64:79]
    s_getreg_b32 s72, hwreg(HW_REG_IB_STS)
    s_and_b32 s72, s72, 12582926
    s_or_b32 s72, s72, s50
    s_cbranch_scc1 L_ft_11
    s_mov_b64 exec, 1
    buffer_store_dword v6, v7, s[28:31], s49 offen sc1
    s_mov_b64 exec, -1
    s_mov_b32 s50, 1
L_ft_11:
    s_waitcnt lgkmcnt(13)
    v_mfma_f32_32x32x16_bf16 v[80:95], v[36:39], v[200:203], v[80:95]
    s_waitcnt lgkmcnt(11)
    v_mfma_f32_32x32x16_bf16 v[96:111], v[40:43], v[200:203], v[96:111]
    s_waitcnt lgkmcnt(9)
    v_mfma_f32_32x32x16_bf16 v[112:127], v[44:47], v[200:203], v[112:127]
    s_waitcnt lgkmcnt(6)
    v_mfma_f32_32x32x16_bf16 v[64:79], v[48:51], v[204:207], v[64:79]
    v_lshrrev_b32 v1, 5, v0
    v_lshlrev_b32 v24, 4, v26
    s_waitcnt lgkmcnt(4)
    v_mfma_f32_32x32x16_bf16 v[80:95], v[52:55], v[204:207], v[80:95]
    v_lshl_add_u32 v22, v1, 11, v24
    s_waitcnt lgkmcnt(2)
    v_mfma_f32_32x32x16_bf16 v[96:111], v[56:59], v[204:207], v[96:111]
    s_waitcnt lgkmcnt(0)
    v_mfma_f32_32x32x16_bf16 v[112:127], v[60:63], v[204:207], v[112:127]
    s_waitcnt lgkmcnt(0)
    s_barrier
    ds_read_b128 v[208:211], v10 offset:32768
    ds_read_b64_tr_b16 v[32:33], v14 offset:49152
    ds_read_b64_tr_b16 v[34:35], v14 offset:49664
    ds_read_b64_tr_b16 v[36:37], v15 offset:49152
    ds_read_b64_tr_b16 v[38:39], v15 offset:49664
    s_waitcnt lgkmcnt(2)
    v_mfma_f32_32x32x16_bf16 v[64:79], v[32:35], v[208:211], v[64:79]
    ds_read_b64_tr_b16 v[40:41], v14 offset:57344
    ds_read_b64_tr_b16 v[42:43], v14 offset:57856
    ds_read_b64_tr_b16 v[44:45], v15 offset:57344
    ds_read_b64_tr_b16 v[46:47], v15 offset:57856
    ds_read_b128 v[212:215], v11 offset:32768
    s_getreg_b32 s72, hwreg(HW_REG_IB_STS)
    s_and_b32 s72, s72, 12582926
    s_or_b32 s72, s72, s50
    s_cbranch_scc1 L_ft_12
    s_mov_b64 exec, 1
    buffer_store_dword v6, v7, s[28:31], s49 offen sc1
    s_mov_b64 exec, -1
    s_mov_b32 s50, 1
L_ft_12:
    s_add_u32 s72, s68, 0
    buffer_load_dwordx4 v[240:243], v22, s[28:31], s72 offen sc1
    s_add_u32 s72, s68, 4096
    buffer_load_dwordx4 v[244:247], v22, s[28:31], s72 offen sc1
    s_add_u32 s72, s68, 8192
    buffer_load_dwordx4 v[248:251], v22, s[28:31], s72 offen sc1
    s_add_u32 s72, s68, 12288
    buffer_load_dwordx4 v[252:255], v22, s[28:31], s72 offen sc1
    buffer_load_dwordx4 v[28:31], v24, s[28:31], s71 offen sc1
    s_waitcnt lgkmcnt(5)
    v_mfma_f32_32x32x16_bf16 v[80:95], v[36:39], v[208:211], v[80:95]
    ds_read_b64_tr_b16 v[48:49], v14 offset:51200
    ds_read_b64_tr_b16 v[50:51], v14 offset:51712
    ds_read_b64_tr_b16 v[52:53], v15 offset:51200
    ds_read_b64_tr_b16 v[54:55], v15 offset:51712
    ds_read_b64_tr_b16 v[56:57], v14 offset:59392
    ds_read_b64_tr_b16 v[58:59], v14 offset:59904
    s_waitcnt lgkmcnt(9)
    v_mfma_f32_32x32x16_bf16 v[96:111], v[40:43], v[208:211], v[96:111]
    ds_read_b64_tr_b16 v[60:61], v15 offset:59392
    ds_read_b64_tr_b16 v[62:63], v15 offset:59904
    ds_read_b128 v[216:219], v12 offset:32768
    ds_read_b64_tr_b16 v[32:33], v14 offset:53248
    ds_read_b64_tr_b16 v[34:35], v14 offset:53760
    s_waitcnt lgkmcnt(12)
    v_mfma_f32_32x32x16_bf16 v[112:127], v[44:47], v[208:211], v[112:127]
    ds_read_b64_tr_b16 v[36:37], v15 offset:53248
    ds_read_b64_tr_b16 v[38:39], v15 offset:53760
    ds_read_b64_tr_b16 v[40:41], v14 offset:61440
    s_waitcnt lgkmcnt(14)
    ds_read_b64_tr_b16 v[42:43], v14 offset:61952
    s_waitcnt lgkmcnt(14)
    ds_read_b64_tr_b16 v[44:45], v15 offset:61440
    s_waitcnt lgkmcnt(14)
    ds_read_b64_tr_b16 v[46:47], v15 offset:61952
    v_mfma_f32_32x32x16_bf16 v[64:79], v[48:51], v[212:215], v[64:79]
    s_waitcnt lgkmcnt(14)
    ds_read_b128 v[220:223], v13 offset:32768
    s_waitcnt lgkmcnt(14)
    ds_read_b64_tr_b16 v[48:49], v14 offset:55296
    s_waitcnt lgkmcnt(14)
    ds_read_b64_tr_b16 v[50:51], v14 offset:55808
    v_mfma_f32_32x32x16_bf16 v[80:95], v[52:55], v[212:215], v[80:95]
    s_waitcnt lgkmcnt(14)
    ds_read_b64_tr_b16 v[52:53], v15 offset:55296
    s_waitcnt lgkmcnt(14)
    ds_read_b64_tr_b16 v[54:55], v15 offset:55808
    v_mfma_f32_32x32x16_bf16 v[96:111], v[56:59], v[212:215], v[96:111]
    s_waitcnt lgkmcnt(14)
    ds_read_b64_tr_b16 v[56:57], v14 offset:63488
    s_waitcnt lgkmcnt(14)
    ds_read_b64_tr_b16 v[58:59], v14 offset:64000
    v_mfma_f32_32x32x16_bf16 v[112:127], v[60:63], v[212:215], v[112:127]
    s_waitcnt lgkmcnt(14)
    ds_read_b64_tr_b16 v[60:61], v15 offset:63488
    s_waitcnt lgkmcnt(14)
    ds_read_b64_tr_b16 v[62:63], v15 offset:64000
    v_mfma_f32_32x32x16_bf16 v[64:79], v[32:35], v[216:219], v[64:79]
    s_waitcnt lgkmcnt(13)
    v_mfma_f32_32x32x16_bf16 v[80:95], v[36:39], v[216:219], v[80:95]
    s_waitcnt lgkmcnt(11)
    v_mfma_f32_32x32x16_bf16 v[96:111], v[40:43], v[216:219], v[96:111]
    s_waitcnt lgkmcnt(9)
    v_mfma_f32_32x32x16_bf16 v[112:127], v[44:47], v[216:219], v[112:127]
    s_waitcnt lgkmcnt(6)
    v_mfma_f32_32x32x16_bf16 v[64:79], v[48:51], v[220:223], v[64:79]
    s_waitcnt lgkmcnt(4)
    v_mfma_f32_32x32x16_bf16 v[80:95], v[52:55], v[220:223], v[80:95]
    s_waitcnt lgkmcnt(2)
    v_mfma_f32_32x32x16_bf16 v[96:111], v[56:59], v[220:223], v[96:111]
    s_waitcnt lgkmcnt(0)
    v_mfma_f32_32x32x16_bf16 v[112:127], v[60:63], v[220:223], v[112:127]
    s_waitcnt lgkmcnt(0)
    s_barrier
    ds_read_b128 v[224:227], v16 offset:0
    ds_read_b64_tr_b16 v[32:33], v20 offset:0
    ds_read_b64_tr_b16 v[34:35], v20 offset:512
    ds_read_b64_tr_b16 v[36:37], v21 offset:0
    ds_read_b64_tr_b16 v[38:39], v21 offset:512
    s_waitcnt lgkmcnt(2)
    v_mfma_f32_32x32x16_bf16 v[64:79], v[32:35], v[224:227], v[64:79]
    ds_read_b64_tr_b16 v[40:41], v20 offset:8192
    ds_read_b64_tr_b16 v[42:43], v20 offset:8704
    ds_read_b64_tr_b16 v[44:45], v21 offset:8192
    ds_read_b64_tr_b16 v[46:47], v21 offset:8704
    ds_read_b128 v[228:231], v17 offset:0
    s_waitcnt lgkmcnt(5)
    v_mfma_f32_32x32x16_bf16 v[80:95], v[36:39], v[224:227], v[80:95]
    ds_read_b64_tr_b16 v[48:49], v20 offset:2048
    ds_read_b64_tr_b16 v[50:51], v20 offset:2560
    ds_read_b64_tr_b16 v[52:53], v21 offset:2048
    ds_read_b64_tr_b16 v[54:55], v21 offset:2560
    ds_read_b64_tr_b16 v[56:57], v20 offset:10240
    ds_read_b64_tr_b16 v[58:59], v20 offset:10752
    s_waitcnt lgkmcnt(9)
    v_mfma_f32_32x32x16_bf16 v[96:111], v[40:43], v[224:227], v[96:111]
    ds_read_b64_tr_b16 v[60:61], v21 offset:10240
    ds_read_b64_tr_b16 v[62:63], v21 offset:10752
    ds_read_b128 v[232:235], v18 offset:0
    ds_read_b64_tr_b16 v[32:33], v20 offset:4096
    ds_read_b64_tr_b16 v[34:35], v20 offset:4608
    s_mov_b32 s67, 0
L_gc0:
    s_waitcnt vmcnt(0)
    v_xor_b32 v1, v6, v29
    v_xor_b32 v27, v6, v31
    v_or_b32 v1, v1, v27
    v_xor_b32 v27, v6, v241
    v_xor_b32 v8, v6, v243
    v_or3_b32 v1, v1, v27, v8
    v_xor_b32 v27, v6, v245
    v_xor_b32 v8, v6, v247
    v_or3_b32 v1, v1, v27, v8
    v_xor_b32 v27, v6, v249
    v_xor_b32 v8, v6, v251
    v_or3_b32 v1, v1, v27, v8
    v_xor_b32 v27, v6, v253
    v_xor_b32 v8, v6, v255
    v_or3_b32 v1, v1, v27, v8
    v_cmp_ne_u32 vcc, 0, v1
    s_cbranch_vccz L_gok0
    s_add_u32 s67, s67, 1
    s_cmp_gt_u32 s67, 200000
    s_cbranch_scc1 L_gok0
    s_add_u32 s72, s68, 0
    buffer_load_dwordx4 v[240:243], v22, s[28:31], s72 offen sc1
    s_add_u32 s72, s68, 4096
    buffer_load_dwordx4 v[244:247], v22, s[28:31], s72 offen sc1
    s_add_u32 s72, s68, 8192
    buffer_load_dwordx4 v[248:251], v22, s[28:31], s72 offen sc1
    s_add_u32 s72, s68, 12288
    buffer_load_dwordx4 v[252:255], v22, s[28:31], s72 offen sc1
    buffer_load_dwordx4 v[28:31], v24, s[28:31], s71 offen sc1
    s_branch L_gc0
L_gok0:
    s_cmp_lg_u32 s50, 0
    s_cbranch_scc1 L_ft_13
    s_waitcnt vmcnt(0)
    s_mov_b64 exec, 1
    buffer_store_dword v6, v7, s[28:31], s49 offen sc1
    s_mov_b64 exec, -1
    s_mov_b32 s50, 1
L_ft_13:
    v_add_f32 v240, v240, v244
    v_add_f32 v242, v242, v246
    v_add_f32 v240, v240, v248
    s_waitcnt lgkmcnt(12)
    v_mfma_f32_32x32x16_bf16 v[112:127], v[44:47], v[224:227], v[112:127]
    ds_read_b64_tr_b16 v[36:37], v21 offset:4096
    ds_read_b64_tr_b16 v[38:39], v21 offset:4608
    ds_read_b64_tr_b16 v[40:41], v20 offset:12288
    s_waitcnt lgkmcnt(14)
    ds_read_b64_tr_b16 v[42:43], v20 offset:12800
    s_waitcnt lgkmcnt(14)
    ds_read_b64_tr_b16 v[44:45], v21 offset:12288
    s_waitcnt lgkmcnt(14)
    ds_read_b64_tr_b16 v[46:47], v21 offset:12800
    v_add_f32 v242, v242, v250
    v_add_f32 v240, v240, v252
    v_add_f32 v242, v242, v254
    v_mov_b32 v244, v240
    v_mfma_f32_32x32x16_bf16 v[64:79], v[48:51], v[228:231], v[64:79]
    s_waitcnt lgkmcnt(14)
    ds_read_b128 v[236:239], v19 offset:0
    s_waitcnt lgkmcnt(14)
    ds_read_b64_tr_b16 v[48:49], v20 offset:6144
    s_waitcnt lgkmcnt(14)
    ds_read_b64_tr_b16 v[50:51], v20 offset:6656
    v_mov_b32 v246, v242
    v_permlane32_swap_b32 v240, v244
    s_nop 0
    v_permlane32_swap_b32 v242, v246
    v_add_f32 v240, v240, v244
    v_mfma_f32_32x32x16_bf16 v[80:95], v[52:55], v[228:231], v[80:95]
    s_waitcnt lgkmcnt(14)
    ds_read_b64_tr_b16 v[52:53], v21 offset:6144
    s_waitcnt lgkmcnt(14)
    ds_read_b64_tr_b16 v[54:55], v21 offset:6656
    v_add_f32 v242, v242, v246
    v_cvt_pk_bf16_f32 v244, v240, v240
    v_and_b32 v248, 0xffff0000, v244
    v_sub_f32 v248, v240, v248
    v_mfma_f32_32x32x16_bf16 v[96:111], v[56:59], v[228:231], v[96:111]
    s_waitcnt lgkmcnt(14)
    ds_read_b64_tr_b16 v[56:57], v20 offset:14336
    s_waitcnt lgkmcnt(14)
    ds_read_b64_tr_b16 v[58:59], v20 offset:14848
    v_cvt_pk_bf16_f32 v245, v248, v248
    v_cvt_pk_bf16_f32 v246, v242, v242
    v_and_b32 v248, 0xffff0000, v246
    v_sub_f32 v248, v242, v248
    v_mfma_f32_32x32x16_bf16 v[112:127], v[60:63], v[228:231], v[112:127]
    s_waitcnt lgkmcnt(14)
    ds_read_b64_tr_b16 v[60:61], v21 offset:14336
    s_waitcnt lgkmcnt(14)
    ds_read_b64_tr_b16 v[62:63], v21 offset:14848
    v_cvt_pk_bf16_f32 v247, v248, v248
    v_bfe_u32 v1, v0, 4, 1
    v_and_b32 v24, 15, v0
    v_lshlrev_b32 v24, 3, v24
    v_mfma_f32_32x32x16_bf16 v[64:79], v[32:35], v[232:235], v[64:79]
    v_lshl_add_u32 v24, v1, 10, v24
    s_lshl_b32 s72, s38, 8
    s_add_u32 s72, s72, 158208
    v_add_u32 v24, s72, v24
    s_waitcnt lgkmcnt(13)
    v_mfma_f32_32x32x16_bf16 v[80:95], v[36:39], v[232:235], v[80:95]
    ds_write2_b64 v24, v[244:245], v[246:247] offset0:0 offset1:16
    s_lshl_b32 s72, s38, 7
    s_add_u32 s72, s72, 157696
    v_lshl_add_u32 v22, v26, 2, s72
    s_waitcnt lgkmcnt(12)
    v_mfma_f32_32x32x16_bf16 v[96:111], v[40:43], v[232:235], v[96:111]
    v_mov_b32 v8, v30
    ds_write_b32 v22, v8
    v_sub_f32 v28, 0, v28
    v_cvt_pk_bf16_f32 v1, v28, v28
    s_waitcnt lgkmcnt(11)
    v_mfma_f32_32x32x16_bf16 v[112:127], v[44:47], v[232:235], v[112:127]
    v_and_b32 v1, 0xffff0000, v1
    v_sub_f32 v1, v28, v1
    v_cvt_pk_bf16_f32 v1, v28, v1
    v_cmp_gt_u32 vcc, 32, v0
    s_waitcnt lgkmcnt(8)
    v_mfma_f32_32x32x16_bf16 v[64:79], v[48:51], v[236:239], v[64:79]
    v_cndmask_b32 v26, 0, v1, vcc
    v_cndmask_b32 v27, 0, v1, vcc
    s_waitcnt lgkmcnt(6)
    v_mfma_f32_32x32x16_bf16 v[80:95], v[52:55], v[236:239], v[80:95]
    s_waitcnt lgkmcnt(4)
    v_mfma_f32_32x32x16_bf16 v[96:111], v[56:59], v[236:239], v[96:111]
    s_waitcnt lgkmcnt(2)
    v_mfma_f32_32x32x16_bf16 v[112:127], v[60:63], v[236:239], v[112:127]
    s_waitcnt lgkmcnt(0)
    s_barrier
    ds_read_b128 v[240:243], v16 offset:32768
    ds_read_b64_tr_b16 v[32:33], v20 offset:32768
    ds_read_b64_tr_b16 v[34:35], v20 offset:33280
    ds_read_b64_tr_b16 v[36:37], v21 offset:32768
    ds_read_b64_tr_b16 v[38:39], v21 offset:33280
    s_waitcnt lgkmcnt(2)
    v_mfma_f32_32x32x16_bf16 v[64:79], v[32:35], v[240:243], v[64:79]
    ds_read_b64_tr_b16 v[40:41], v20 offset:34816
    ds_read_b64_tr_b16 v[42:43], v20 offset:35328
    ds_read_b64_tr_b16 v[44:45], v21 offset:34816
    ds_read_b64_tr_b16 v[46:47], v21 offset:35328
    ds_read_b128 v[244:247], v17 offset:32768
    ds_read_b64 v[10:11], v23 offset:0
    ds_read_b64 v[12:13], v23 offset:256
    v_and_b32 v22, 7, v0
    v_lshlrev_b32 v22, 2, v22
    s_lshl_b32 s61, s41, 3
    s_add_u32 s61, s61, s96
    s_lshl_b32 s61, s61, 5
    s_add_u32 s61, s61, 19136512
    buffer_load_dword v24, v22, s[28:31], s61 offen sc1
    s_waitcnt lgkmcnt(7)
    v_mfma_f32_32x32x16_bf16 v[80:95], v[36:39], v[240:243], v[80:95]
    ds_read_b64_tr_b16 v[48:49], v20 offset:36864
    ds_read_b64_tr_b16 v[50:51], v20 offset:37376
    ds_read_b64_tr_b16 v[52:53], v21 offset:36864
    ds_read_b64_tr_b16 v[54:55], v21 offset:37376
    ds_read_b64_tr_b16 v[56:57], v20 offset:38912
    ds_read_b64_tr_b16 v[58:59], v20 offset:39424
    s_waitcnt lgkmcnt(8)
    v_mfma_f32_32x32x16_bf16 v[64:79], v[40:43], v[244:247], v[64:79]
    ds_read_b64_tr_b16 v[60:61], v21 offset:38912
    ds_read_b64_tr_b16 v[62:63], v21 offset:39424
    ds_read_b128 v[248:251], v18 offset:32768
    ds_read_b64_tr_b16 v[32:33], v20 offset:40960
    ds_read_b64_tr_b16 v[34:35], v20 offset:41472
    s_lshl_b32 s72, s96, 3
    s_add_u32 s72, s72, s41
    s_mul_i32 s72, s72, 36864
    s_add_u32 s72, s72, 20971520
    v_add_u32 v7, s72, v2
    v_mfma_f32_32x32x16_bf16 v[80:95], v[44:47], v[244:247], v[80:95]
    ds_read_b64_tr_b16 v[36:37], v21 offset:40960
    ds_read_b64_tr_b16 v[38:39], v21 offset:41472
    s_waitcnt lgkmcnt(14)
    ds_read_b64_tr_b16 v[40:41], v20 offset:43008
    s_waitcnt lgkmcnt(14)
    ds_read_b64_tr_b16 v[42:43], v20 offset:43520
    s_waitcnt lgkmcnt(14)
    ds_read_b64_tr_b16 v[44:45], v21 offset:43008
    s_waitcnt lgkmcnt(14)
    ds_read_b64_tr_b16 v[46:47], v21 offset:43520
    s_waitcnt lgkmcnt(8)
    v_mfma_f32_32x32x16_bf16 v[64:79], v[48:51], v[248:251], v[64:79]
    ds_read_b128 v[252:255], v19 offset:32768
    ds_read_b64_tr_b16 v[48:49], v20 offset:45056
    ds_read_b64_tr_b16 v[50:51], v20 offset:45568
    v_mfma_f32_32x32x16_bf16 v[80:95], v[52:55], v[248:251], v[80:95]
    ds_read_b64_tr_b16 v[52:53], v21 offset:45056
    ds_read_b64_tr_b16 v[54:55], v21 offset:45568
    s_waitcnt lgkmcnt(4)
    v_mfma_f32_32x32x16_bf16 v[64:79], v[56:59], v[252:255], v[64:79]
    ds_read_b64_tr_b16 v[56:57], v20 offset:47104
    ds_read_b64_tr_b16 v[58:59], v20 offset:47616
    ds_read_b64 v[16:17], v23 offset:512
    ds_read_b64 v[18:19], v23 offset:768
    ds_read_b64 v[28:29], v23 offset:1024
    ds_read_b64 v[30:31], v23 offset:1280
    v_mfma_f32_32x32x16_bf16 v[80:95], v[60:63], v[252:255], v[80:95]
    v_mfma_f32_32x32x8bf16_1k v[64:79], v[10:11], v[26:27], v[64:79]
    v_mfma_f32_32x32x8bf16_1k v[80:95], v[12:13], v[26:27], v[80:95]
    ds_read_b64_tr_b16 v[60:61], v21 offset:47104
    ds_read_b64_tr_b16 v[62:63], v21 offset:47616
    v_mfma_f32_32x32x16_bf16 v[96:111], v[32:35], v[240:243], v[96:111]
    ds_read_b64_tr_b16 v[32:33], v20 offset:49152
    ds_read_b64_tr_b16 v[34:35], v20 offset:49664
    v_mfma_f32_32x32x16_bf16 v[112:127], v[36:39], v[240:243], v[112:127]
    ds_read_b64_tr_b16 v[36:37], v20 offset:51200
    s_waitcnt lgkmcnt(14)
    ds_read_b64_tr_b16 v[38:39], v20 offset:51712
    s_nop 1
    v_cvt_pk_bf16_f32 v64, v64, v65
    v_cvt_pk_bf16_f32 v65, v66, v67
    v_cvt_pk_bf16_f32 v66, v68, v69
    v_cvt_pk_bf16_f32 v67, v70, v71
    v_mfma_f32_32x32x16_bf16 v[96:111], v[40:43], v[244:247], v[96:111]
    s_waitcnt lgkmcnt(14)
    ds_read_b64_tr_b16 v[40:41], v20 offset:53248
    s_waitcnt lgkmcnt(14)
    ds_read_b64_tr_b16 v[42:43], v20 offset:53760
    s_waitcnt lgkmcnt(14)
    ds_write_b128 v3, v[64:67] offset:0
    v_cvt_pk_bf16_f32 v68, v72, v73
    v_cvt_pk_bf16_f32 v69, v74, v75
    v_cvt_pk_bf16_f32 v70, v76, v77
    v_mfma_f32_32x32x16_bf16 v[112:127], v[44:47], v[244:247], v[112:127]
    s_waitcnt lgkmcnt(14)
    ds_read_b64_tr_b16 v[44:45], v20 offset:55296
    s_waitcnt lgkmcnt(14)
    ds_read_b64_tr_b16 v[46:47], v20 offset:55808
    v_cvt_pk_bf16_f32 v71, v78, v79
    s_waitcnt lgkmcnt(14)
    ds_write_b128 v3, v[68:71] offset:1024
    v_cvt_pk_bf16_f32 v80, v80, v81
    v_cvt_pk_bf16_f32 v81, v82, v83
    v_mfma_f32_32x32x16_bf16 v[96:111], v[48:51], v[248:251], v[96:111]
    v_cvt_pk_bf16_f32 v82, v84, v85
    v_cvt_pk_bf16_f32 v83, v86, v87
    s_waitcnt lgkmcnt(14)
    ds_write_b128 v3, v[80:83] offset:2048
    v_cvt_pk_bf16_f32 v84, v88, v89
    v_mfma_f32_32x32x16_bf16 v[112:127], v[52:55], v[248:251], v[112:127]
    v_cvt_pk_bf16_f32 v85, v90, v91
    v_cvt_pk_bf16_f32 v86, v92, v93
    v_cvt_pk_bf16_f32 v87, v94, v95
    s_waitcnt lgkmcnt(14)
    ds_write_b128 v3, v[84:87] offset:3072
    v_mfma_f32_32x32x16_bf16 v[96:111], v[56:59], v[252:255], v[96:111]
    s_waitcnt lgkmcnt(0)
    s_barrier
    v_mfma_f32_32x32x16_bf16 v[112:127], v[60:63], v[252:255], v[112:127]
    v_mfma_f32_32x32x8bf16_1k v[96:111], v[16:17], v[26:27], v[96:111]
    v_mfma_f32_32x32x8bf16_1k v[112:127], v[18:19], v[26:27], v[112:127]
    v_mfma_f32_32x32x16_bf16 v[48:63], v[32:35], v[128:131], 0
    ds_read_b64_tr_b16 v[32:33], v21 offset:49152
    ds_read_b64_tr_b16 v[34:35], v21 offset:49664
    v_mfma_f32_32x32x16_bf16 v[48:63], v[36:39], v[132:135], v[48:63]
    ds_read_b64_tr_b16 v[36:37], v21 offset:51200
    ds_read_b64_tr_b16 v[38:39], v21 offset:51712
    v_mfma_f32_32x32x16_bf16 v[48:63], v[40:43], v[136:139], v[48:63]
    ds_read_b64_tr_b16 v[40:41], v21 offset:53248
    ds_read_b64_tr_b16 v[42:43], v21 offset:53760
    v_mov_b32 v12, 0x3f803f80
    v_mov_b32 v13, 0x3f803f80
    s_mov_b32 exec_hi, 0
    ds_write_b64 v4, v[12:13] offset:128
    s_mov_b32 exec_hi, -1
    v_mul_f32 v96, v96, v8
    v_mul_f32 v97, v97, v8
    v_mfma_f32_32x32x16_bf16 v[48:63], v[44:47], v[140:143], v[48:63]
    ds_read_b64_tr_b16 v[44:45], v21 offset:55296
    ds_read_b64_tr_b16 v[46:47], v21 offset:55808
    v_cvt_pk_bf16_f32 v96, v96, v97
    v_mul_f32 v98, v98, v8
    v_mul_f32 v99, v99, v8
    v_cvt_pk_bf16_f32 v97, v98, v99
    ds_write_b64 v4, v[96:97] offset:0
    s_waitcnt lgkmcnt(8)
    v_mfma_f32_32x32x16_bf16 v[64:79], v[32:35], v[128:131], 0
    ds_read_b64_tr_b16 v[32:33], v14 offset:8192
    ds_read_b64_tr_b16 v[34:35], v14 offset:8704
    v_mul_f32 v100, v100, v8
    v_mul_f32 v101, v101, v8
    v_cvt_pk_bf16_f32 v98, v100, v101
    v_mul_f32 v102, v102, v8
    v_mul_f32 v103, v103, v8
    s_waitcnt lgkmcnt(8)
    v_mfma_f32_32x32x16_bf16 v[64:79], v[36:39], v[132:135], v[64:79]
    ds_read_b64_tr_b16 v[36:37], v14 offset:10240
    ds_read_b64_tr_b16 v[38:39], v14 offset:10752
    v_cvt_pk_bf16_f32 v99, v102, v103
    ds_write_b64 v4, v[98:99] offset:16
    v_mul_f32 v104, v104, v8
    v_mul_f32 v105, v105, v8
    v_cvt_pk_bf16_f32 v100, v104, v105
    s_waitcnt lgkmcnt(9)
    v_mfma_f32_32x32x16_bf16 v[64:79], v[40:43], v[136:139], v[64:79]
    ds_read_b64_tr_b16 v[40:41], v14 offset:12288
    ds_read_b64_tr_b16 v[42:43], v14 offset:12800
    v_mul_f32 v106, v106, v8
    v_mul_f32 v107, v107, v8
    v_cvt_pk_bf16_f32 v101, v106, v107
    ds_write_b64 v4, v[100:101] offset:32
    v_mul_f32 v108, v108, v8
    s_waitcnt vmcnt(0)
    v_cmp_ne_u32 vcc, s39, v24
    s_nop 0
    s_cmp_eq_u64 vcc, 0
    s_cbranch_scc1 L_pok_mb0
    s_mov_b32 s67, 0
L_poll_mb0:
    s_sleep 1
    buffer_load_dword v24, v22, s[28:31], s61 offen sc1
    s_waitcnt vmcnt(0)
    v_cmp_ne_u32 vcc, s39, v24
    s_nop 0
    s_cmp_eq_u64 vcc, 0
    s_cbranch_scc1 L_pok_mb0
    s_add_u32 s67, s67, 1
    s_cmp_gt_u32 s67, 200000
    s_cbranch_scc0 L_poll_mb0
L_pok_mb0:
    s_waitcnt lgkmcnt(9)
    v_mfma_f32_32x32x16_bf16 v[64:79], v[44:47], v[140:143], v[64:79]
    ds_read_b64_tr_b16 v[44:45], v14 offset:14336
    ds_read_b64_tr_b16 v[46:47], v14 offset:14848
    v_mul_f32 v109, v109, v8
    v_cvt_pk_bf16_f32 v102, v108, v109
    v_mul_f32 v110, v110, v8
    v_mul_f32 v111, v111, v8
    v_cvt_pk_bf16_f32 v103, v110, v111
    s_lshl_b32 s34, s10, 1
    buffer_load_dwordx4 v[128:131], v7, s[28:31], s34 offen offset:0 sc1
    s_waitcnt lgkmcnt(8)
    v_mfma_f32_32x32x16_bf16 v[48:63], v[32:35], v[144:147], v[48:63]
    ds_read_b64_tr_b16 v[32:33], v15 offset:8192
    ds_read_b64_tr_b16 v[34:35], v15 offset:8704
    ds_write_b64 v4, v[102:103] offset:48
    v_mov_b32 v1, 2
    ds_write_b32 v5, v1
    v_mul_f32 v112, v112, v8
    v_mul_f32 v113, v113, v8
    buffer_load_dwordx4 v[132:135], v7, s[28:31], s34 offen offset:1024 sc1
    s_waitcnt lgkmcnt(10)
    v_mfma_f32_32x32x16_bf16 v[48:63], v[36:39], v[148:151], v[48:63]
    ds_read_b64_tr_b16 v[36:37], v15 offset:10240
    ds_read_b64_tr_b16 v[38:39], v15 offset:10752
    v_cvt_pk_bf16_f32 v112, v112, v113
    v_mul_f32 v114, v114, v8
    v_mul_f32 v115, v115, v8
    v_cvt_pk_bf16_f32 v113, v114, v115
    ds_write_b64 v4, v[112:113] offset:64
    s_lshl_b32 s34, s11, 1
    buffer_load_dwordx4 v[136:139], v7, s[28:31], s34 offen offset:0 sc1
    s_waitcnt lgkmcnt(10)
    v_mfma_f32_32x32x16_bf16 v[48:63], v[40:43], v[152:155], v[48:63]
    ds_read_b64_tr_b16 v[40:41], v15 offset:12288
    ds_read_b64_tr_b16 v[42:43], v15 offset:12800
    v_mul_f32 v116, v116, v8
    v_mul_f32 v117, v117, v8
    v_cvt_pk_bf16_f32 v114, v116, v117
    v_mul_f32 v118, v118, v8
    v_mul_f32 v119, v119, v8
    buffer_load_dwordx4 v[140:143], v7, s[28:31], s34 offen offset:1024 sc1
    s_waitcnt lgkmcnt(9)
    v_mfma_f32_32x32x16_bf16 v[48:63], v[44:47], v[156:159], v[48:63]
    ds_read_b64_tr_b16 v[44:45], v15 offset:14336
    ds_read_b64_tr_b16 v[46:47], v15 offset:14848
    v_cvt_pk_bf16_f32 v115, v118, v119
    ds_write_b64 v4, v[114:115] offset:80
    v_mul_f32 v120, v120, v8
    v_mul_f32 v121, v121, v8
    v_cvt_pk_bf16_f32 v116, v120, v121
    s_waitcnt lgkmcnt(10)
    v_mfma_f32_32x32x16_bf16 v[64:79], v[32:35], v[144:147], v[64:79]
    ds_read_b64_tr_b16 v[32:33], v14 offset:16384
    ds_read_b64_tr_b16 v[34:35], v14 offset:16896
    v_mul_f32 v122, v122, v8
    v_mul_f32 v123, v123, v8
    v_cvt_pk_bf16_f32 v117, v122, v123
    ds_write_b64 v4, v[116:117] offset:96
    v_mul_f32 v124, v124, v8
    s_waitcnt lgkmcnt(9)
    v_mfma_f32_32x32x16_bf16 v[64:79], v[36:39], v[148:151], v[64:79]
    ds_read_b64_tr_b16 v[36:37], v14 offset:18432
    ds_read_b64_tr_b16 v[38:39], v14 offset:18944
    v_mul_f32 v125, v125, v8
    v_cvt_pk_bf16_f32 v118, v124, v125
    v_mul_f32 v126, v126, v8
    v_mul_f32 v127, v127, v8
    v_cvt_pk_bf16_f32 v119, v126, v127
    s_waitcnt lgkmcnt(8)
    v_mfma_f32_32x32x16_bf16 v[64:79], v[40:43], v[152:155], v[64:79]
    ds_read_b64_tr_b16 v[40:41], v14 offset:20480
    ds_read_b64_tr_b16 v[42:43], v14 offset:20992
    ds_write_b64 v4, v[118:119] offset:112
    v_mov_b32 v1, 3
    ds_write_b32 v5, v1
    s_lshl_b32 s34, s8, 1
    buffer_load_dwordx4 v[112:115], v7, s[28:31], s34 offen offset:0 sc1
    s_waitcnt lgkmcnt(10)
    v_mfma_f32_32x32x16_bf16 v[64:79], v[44:47], v[156:159], v[64:79]
    ds_read_b64_tr_b16 v[44:45], v14 offset:22528
    ds_read_b64_tr_b16 v[46:47], v14 offset:23040
    buffer_load_dwordx4 v[116:119], v7, s[28:31], s34 offen offset:1024 sc1
    s_waitcnt lgkmcnt(9)
    v_mfma_f32_32x32x16_bf16 v[48:63], v[32:35], v[160:163], v[48:63]
    ds_read_b64_tr_b16 v[32:33], v15 offset:16384
    ds_read_b64_tr_b16 v[34:35], v15 offset:16896
    s_lshl_b32 s34, s9, 1
    buffer_load_dwordx4 v[120:123], v7, s[28:31], s34 offen offset:0 sc1
    s_waitcnt lgkmcnt(8)
    v_mfma_f32_32x32x16_bf16 v[48:63], v[36:39], v[164:167], v[48:63]
    ds_read_b64_tr_b16 v[36:37], v15 offset:18432
    ds_read_b64_tr_b16 v[38:39], v15 offset:18944
    buffer_load_dwordx4 v[124:127], v7, s[28:31], s34 offen offset:1024 sc1
    s_waitcnt lgkmcnt(8)
    v_mfma_f32_32x32x16_bf16 v[48:63], v[40:43], v[168:171], v[48:63]
    ds_read_b64_tr_b16 v[40:41], v15 offset:20480
    ds_read_b64_tr_b16 v[42:43], v15 offset:20992
    s_lshl_b32 s34, s12, 1
    s_waitcnt vmcnt(7)
    buffer_load_dwordx4 v[144:147], v7, s[28:31], s34 offen offset:0 sc1
    s_waitcnt lgkmcnt(6)
    v_mfma_f32_32x32x16_bf16 v[48:63], v[44:47], v[172:175], v[48:63]
    ds_read_b64_tr_b16 v[44:45], v15 offset:22528
    ds_read_b64_tr_b16 v[46:47], v15 offset:23040
    s_waitcnt vmcnt(7)
    buffer_load_dwordx4 v[148:151], v7, s[28:31], s34 offen offset:1024 sc1
    s_waitcnt lgkmcnt(6)
    v_mfma_f32_32x32x16_bf16 v[64:79], v[32:35], v[160:163], v[64:79]
    ds_read_b64_tr_b16 v[32:33], v14 offset:24576
    ds_read_b64_tr_b16 v[34:35], v14 offset:25088
    s_lshl_b32 s34, s13, 1
    s_waitcnt vmcnt(7)
    buffer_load_dwordx4 v[152:155], v7, s[28:31], s34 offen offset:0 sc1
    s_waitcnt lgkmcnt(6)
    v_mfma_f32_32x32x16_bf16 v[64:79], v[36:39], v[164:167], v[64:79]
    ds_read_b64_tr_b16 v[36:37], v14 offset:26624
    ds_read_b64_tr_b16 v[38:39], v14 offset:27136
    s_waitcnt vmcnt(7)
    buffer_load_dwordx4 v[156:159], v7, s[28:31], s34 offen offset:1024 sc1
    s_waitcnt lgkmcnt(6)
    v_mfma_f32_32x32x16_bf16 v[64:79], v[40:43], v[168:171], v[64:79]
    ds_read_b64_tr_b16 v[40:41], v14 offset:28672
    ds_read_b64_tr_b16 v[42:43], v14 offset:29184
    s_waitcnt lgkmcnt(6)
    v_mfma_f32_32x32x16_bf16 v[64:79], v[44:47], v[172:175], v[64:79]
    ds_read_b64_tr_b16 v[44:45], v14 offset:30720
    ds_read_b64_tr_b16 v[46:47], v14 offset:31232
    s_lshl_b32 s34, s14, 1
    s_waitcnt vmcnt(7)
    buffer_load_dwordx4 v[160:163], v7, s[28:31], s34 offen offset:0 sc1
    s_waitcnt lgkmcnt(6)
    v_mfma_f32_32x32x16_bf16 v[48:63], v[32:35], v[176:179], v[48:63]
    ds_read_b64_tr_b16 v[32:33], v15 offset:24576
    ds_read_b64_tr_b16 v[34:35], v15 offset:25088
    s_waitcnt vmcnt(7)
    buffer_load_dwordx4 v[164:167], v7, s[28:31], s34 offen offset:1024 sc1
    s_waitcnt lgkmcnt(6)
    v_mfma_f32_32x32x16_bf16 v[48:63], v[36:39], v[180:183], v[48:63]
    ds_read_b64_tr_b16 v[36:37], v15 offset:26624
    ds_read_b64_tr_b16 v[38:39], v15 offset:27136
    s_lshl_b32 s34, s15, 1
    s_waitcnt vmcnt(7)
    buffer_load_dwordx4 v[168:171], v7, s[28:31], s34 offen offset:0 sc1
    s_waitcnt lgkmcnt(6)
    v_mfma_f32_32x32x16_bf16 v[48:63], v[40:43], v[184:187], v[48:63]
    ds_read_b64_tr_b16 v[40:41], v15 offset:28672
    ds_read_b64_tr_b16 v[42:43], v15 offset:29184
    s_waitcnt vmcnt(7)
    buffer_load_dwordx4 v[172:175], v7, s[28:31], s34 offen offset:1024 sc1
    s_waitcnt lgkmcnt(6)
    v_mfma_f32_32x32x16_bf16 v[48:63], v[44:47], v[188:191], v[48:63]
    ds_read_b64_tr_b16 v[44:45], v15 offset:30720
    ds_read_b64_tr_b16 v[46:47], v15 offset:31232
    s_waitcnt lgkmcnt(6)
    v_mfma_f32_32x32x16_bf16 v[64:79], v[32:35], v[176:179], v[64:79]
    ds_read_b64_tr_b16 v[32:33], v14 offset:32768
    ds_read_b64_tr_b16 v[34:35], v14 offset:33280
    s_waitcnt lgkmcnt(6)
    v_mfma_f32_32x32x16_bf16 v[64:79], v[36:39], v[180:183], v[64:79]
    ds_read_b64_tr_b16 v[36:37], v14 offset:34816
    ds_read_b64_tr_b16 v[38:39], v14 offset:35328
    s_waitcnt lgkmcnt(6)
    v_mfma_f32_32x32x16_bf16 v[64:79], v[40:43], v[184:187], v[64:79]
    ds_read_b64_tr_b16 v[40:41], v14 offset:36864
    ds_read_b64_tr_b16 v[42:43], v14 offset:37376
    s_waitcnt lgkmcnt(6)
    v_mfma_f32_32x32x16_bf16 v[64:79], v[44:47], v[188:191], v[64:79]
    ds_read_b64_tr_b16 v[44:45], v14 offset:38912
    ds_read_b64_tr_b16 v[46:47], v14 offset:39424
    s_lshl_b32 s34, s16, 1
    s_waitcnt vmcnt(7)
    buffer_load_dwordx4 v[176:179], v7, s[28:31], s34 offen offset:0 sc1
    s_waitcnt lgkmcnt(6)
    v_mfma_f32_32x32x16_bf16 v[48:63], v[32:35], v[192:195], v[48:63]
    ds_read_b64_tr_b16 v[32:33], v15 offset:32768
    ds_read_b64_tr_b16 v[34:35], v15 offset:33280
    s_waitcnt vmcnt(7)
    buffer_load_dwordx4 v[180:183], v7, s[28:31], s34 offen offset:1024 sc1
    s_waitcnt lgkmcnt(6)
    v_mfma_f32_32x32x16_bf16 v[48:63], v[36:39], v[196:199], v[48:63]
    ds_read_b64_tr_b16 v[36:37], v15 offset:34816
    ds_read_b64_tr_b16 v[38:39], v15 offset:35328
    s_lshl_b32 s34, s17, 1
    s_waitcnt vmcnt(7)
    buffer_load_dwordx4 v[184:187], v7, s[28:31], s34 offen offset:0 sc1
    s_waitcnt lgkmcnt(6)
    v_mfma_f32_32x32x16_bf16 v[48:63], v[40:43], v[200:203], v[48:63]
    ds_read_b64_tr_b16 v[40:41], v15 offset:36864
    ds_read_b64_tr_b16 v[42:43], v15 offset:37376
    s_waitcnt vmcnt(7)
    buffer_load_dwordx4 v[188:191], v7, s[28:31], s34 offen offset:1024 sc1
    s_waitcnt lgkmcnt(6)
    v_mfma_f32_32x32x16_bf16 v[48:63], v[44:47], v[204:207], v[48:63]
    ds_read_b64_tr_b16 v[44:45], v15 offset:38912
    ds_read_b64_tr_b16 v[46:47], v15 offset:39424
    s_waitcnt lgkmcnt(6)
    v_mfma_f32_32x32x16_bf16 v[64:79], v[32:35], v[192:195], v[64:79]
    ds_read_b64_tr_b16 v[32:33], v14 offset:40960
    ds_read_b64_tr_b16 v[34:35], v14 offset:41472
    s_waitcnt lgkmcnt(6)
    v_mfma_f32_32x32x16_bf16 v[64:79], v[36:39], v[196:199], v[64:79]
    ds_read_b64_tr_b16 v[36:37], v14 offset:43008
    ds_read_b64_tr_b16 v[38:39], v14 offset:43520
    s_waitcnt lgkmcnt(6)
    v_mfma_f32_32x32x16_bf16 v[64:79], v[40:43], v[200:203], v[64:79]
    ds_read_b64_tr_b16 v[40:41], v14 offset:45056
    ds_read_b64_tr_b16 v[42:43], v14 offset:45568
    s_waitcnt lgkmcnt(6)
    v_mfma_f32_32x32x16_bf16 v[64:79], v[44:47], v[204:207], v[64:79]
    ds_read_b64_tr_b16 v[44:45], v14 offset:47104
    ds_read_b64_tr_b16 v[46:47], v14 offset:47616
    s_lshl_b32 s34, s18, 1
    s_waitcnt vmcnt(7)
    buffer_load_dwordx4 v[192:195], v7, s[28:31], s34 offen offset:0 sc1
    s_waitcnt lgkmcnt(6)
    v_mfma_f32_32x32x16_bf16 v[48:63], v[32:35], v[208:211], v[48:63]
    ds_read_b64_tr_b16 v[32:33], v15 offset:40960
    ds_read_b64_tr_b16 v[34:35], v15 offset:41472
    s_waitcnt vmcnt(7)
    buffer_load_dwordx4 v[196:199], v7, s[28:31], s34 offen offset:1024 sc1
    s_waitcnt lgkmcnt(6)
    v_mfma_f32_32x32x16_bf16 v[48:63], v[36:39], v[212:215], v[48:63]
    ds_read_b64_tr_b16 v[36:37], v15 offset:43008
    ds_read_b64_tr_b16 v[38:39], v15 offset:43520
    s_lshl_b32 s34, s19, 1
    s_waitcnt vmcnt(7)
    buffer_load_dwordx4 v[200:203], v7, s[28:31], s34 offen offset:0 sc1
    s_waitcnt lgkmcnt(6)
    v_mfma_f32_32x32x16_bf16 v[48:63], v[40:43], v[216:219], v[48:63]
    ds_read_b64_tr_b16 v[40:41], v15 offset:45056
    ds_read_b64_tr_b16 v[42:43], v15 offset:45568
    s_waitcnt vmcnt(7)
    buffer_load_dwordx4 v[204:207], v7, s[28:31], s34 offen offset:1024 sc1
    s_waitcnt lgkmcnt(6)
    v_mfma_f32_32x32x16_bf16 v[48:63], v[44:47], v[220:223], v[48:63]
    ds_read_b64_tr_b16 v[44:45], v15 offset:47104
    ds_read_b64_tr_b16 v[46:47], v15 offset:47616
    s_waitcnt lgkmcnt(6)
    v_mfma_f32_32x32x16_bf16 v[64:79], v[32:35], v[208:211], v[64:79]
    ds_read_b64_tr_b16 v[32:33], v14 offset:49152
    ds_read_b64_tr_b16 v[34:35], v14 offset:49664
    s_waitcnt lgkmcnt(6)
    v_mfma_f32_32x32x16_bf16 v[64:79], v[36:39], v[212:215], v[64:79]
    ds_read_b64_tr_b16 v[36:37], v14 offset:51200
    ds_read_b64_tr_b16 v[38:39], v14 offset:51712
    s_waitcnt lgkmcnt(6)
    v_mfma_f32_32x32x16_bf16 v[64:79], v[40:43], v[216:219], v[64:79]
    ds_read_b64_tr_b16 v[40:41], v14 offset:53248
    ds_read_b64_tr_b16 v[42:43], v14 offset:53760
    s_waitcnt lgkmcnt(6)
    v_mfma_f32_32x32x16_bf16 v[64:79], v[44:47], v[220:223], v[64:79]
    ds_read_b64_tr_b16 v[44:45], v14 offset:55296
    ds_read_b64_tr_b16 v[46:47], v14 offset:55808
    s_lshl_b32 s34, s20, 1
    s_waitcnt vmcnt(7)
    buffer_load_dwordx4 v[208:211], v7, s[28:31], s34 offen offset:0 sc1
    s_waitcnt lgkmcnt(6)
    v_mfma_f32_32x32x16_bf16 v[48:63], v[32:35], v[224:227], v[48:63]
    ds_read_b64_tr_b16 v[32:33], v15 offset:49152
    ds_read_b64_tr_b16 v[34:35], v15 offset:49664
    s_waitcnt vmcnt(7)
    buffer_load_dwordx4 v[212:215], v7, s[28:31], s34 offen offset:1024 sc1
    s_waitcnt lgkmcnt(6)
    v_mfma_f32_32x32x16_bf16 v[48:63], v[36:39], v[228:231], v[48:63]
    ds_read_b64_tr_b16 v[36:37], v15 offset:51200
    ds_read_b64_tr_b16 v[38:39], v15 offset:51712
    s_lshl_b32 s34, s21, 1
    s_waitcnt vmcnt(7)
    buffer_load_dwordx4 v[216:219], v7, s[28:31], s34 offen offset:0 sc1
    s_waitcnt lgkmcnt(6)
    v_mfma_f32_32x32x16_bf16 v[48:63], v[40:43], v[232:235], v[48:63]
    ds_read_b64_tr_b16 v[40:41], v15 offset:53248
    ds_read_b64_tr_b16 v[42:43], v15 offset:53760
    s_waitcnt vmcnt(7)
    buffer_load_dwordx4 v[220:223], v7, s[28:31], s34 offen offset:1024 sc1
    s_waitcnt lgkmcnt(6)
    v_mfma_f32_32x32x16_bf16 v[48:63], v[44:47], v[236:239], v[48:63]
    ds_read_b64_tr_b16 v[44:45], v15 offset:55296
    ds_read_b64_tr_b16 v[46:47], v15 offset:55808
    s_waitcnt lgkmcnt(6)
    v_mfma_f32_32x32x16_bf16 v[64:79], v[32:35], v[224:227], v[64:79]
    ds_read_b64_tr_b16 v[32:33], v14 offset:57344
    ds_read_b64_tr_b16 v[34:35], v14 offset:57856
    s_waitcnt lgkmcnt(6)
    v_mfma_f32_32x32x16_bf16 v[64:79], v[36:39], v[228:231], v[64:79]
    ds_read_b64_tr_b16 v[36:37], v14 offset:59392
    ds_read_b64_tr_b16 v[38:39], v14 offset:59904
    s_waitcnt lgkmcnt(6)
    v_mfma_f32_32x32x16_bf16 v[64:79], v[40:43], v[232:235], v[64:79]
    ds_read_b64_tr_b16 v[40:41], v14 offset:61440
    ds_read_b64_tr_b16 v[42:43], v14 offset:61952
    s_waitcnt lgkmcnt(6)
    v_mfma_f32_32x32x16_bf16 v[64:79], v[44:47], v[236:239], v[64:79]
    ds_read_b64_tr_b16 v[44:45], v14 offset:63488
    ds_read_b64_tr_b16 v[46:47], v14 offset:64000
    s_lshl_b32 s34, s22, 1
    s_waitcnt vmcnt(7)
    buffer_load_dwordx4 v[224:227], v7, s[28:31], s34 offen offset:0 sc1
    s_waitcnt lgkmcnt(6)
    v_mfma_f32_32x32x16_bf16 v[48:63], v[32:35], v[240:243], v[48:63]
    ds_read_b64_tr_b16 v[32:33], v15 offset:57344
    ds_read_b64_tr_b16 v[34:35], v15 offset:57856
    s_waitcnt vmcnt(7)
    buffer_load_dwordx4 v[228:231], v7, s[28:31], s34 offen offset:1024 sc1
    s_waitcnt lgkmcnt(6)
    v_mfma_f32_32x32x16_bf16 v[48:63], v[36:39], v[244:247], v[48:63]
    ds_read_b64_tr_b16 v[36:37], v15 offset:59392
    ds_read_b64_tr_b16 v[38:39], v15 offset:59904
    s_lshl_b32 s34, s23, 1
    s_waitcnt vmcnt(7)
    buffer_load_dwordx4 v[232:235], v7, s[28:31], s34 offen offset:0 sc1
    s_waitcnt lgkmcnt(6)
    v_mfma_f32_32x32x16_bf16 v[48:63], v[40:43], v[248:251], v[48:63]
    ds_read_b64_tr_b16 v[40:41], v15 offset:61440
    ds_read_b64_tr_b16 v[42:43], v15 offset:61952
    s_waitcnt vmcnt(7)
    buffer_load_dwordx4 v[236:239], v7, s[28:31], s34 offen offset:1024 sc1
    s_waitcnt lgkmcnt(6)
    v_mfma_f32_32x32x16_bf16 v[48:63], v[44:47], v[252:255], v[48:63]
    v_mfma_f32_32x32x8bf16_1k v[48:63], v[28:29], v[26:27], v[48:63]
    ds_read_b64_tr_b16 v[44:45], v15 offset:63488
    ds_read_b64_tr_b16 v[46:47], v15 offset:64000
    s_waitcnt lgkmcnt(6)
    v_mfma_f32_32x32x16_bf16 v[64:79], v[32:35], v[240:243], v[64:79]
    s_waitcnt lgkmcnt(4)
    v_mfma_f32_32x32x16_bf16 v[64:79], v[36:39], v[244:247], v[64:79]
    s_waitcnt lgkmcnt(2)
    v_mfma_f32_32x32x16_bf16 v[64:79], v[40:43], v[248:251], v[64:79]
    s_nop 3
    v_cvt_pk_bf16_f32 v48, v48, v49
    v_cvt_pk_bf16_f32 v49, v50, v51
    v_cvt_pk_bf16_f32 v50, v52, v53
    v_cvt_pk_bf16_f32 v51, v54, v55
    v_pk_max_i16 v48, v48, 0
    s_waitcnt lgkmcnt(0)
    v_mfma_f32_32x32x16_bf16 v[64:79], v[44:47], v[252:255], v[64:79]
    v_mfma_f32_32x32x8bf16_1k v[64:79], v[30:31], v[26:27], v[64:79]
    v_pk_max_i16 v49, v49, 0
    v_pk_max_i16 v50, v50, 0
    v_pk_max_i16 v51, v51, 0
    v_or_b32 v48, s52, v48
    v_or_b32 v49, s53, v49
    s_lshl_b32 s34, s32, 1
    s_waitcnt vmcnt(7)
    buffer_load_dwordx4 v[240:243], v7, s[28:31], s34 offen offset:0 sc1
    v_or_b32 v50, s54, v50
    v_or_b32 v51, s55, v51
    buffer_store_dwordx4 v[48:51], v2, s[28:31], s44 offen offset:0 sc1
    v_cvt_pk_bf16_f32 v52, v56, v57
    v_cvt_pk_bf16_f32 v53, v58, v59
    v_cvt_pk_bf16_f32 v54, v60, v61
    v_cvt_pk_bf16_f32 v55, v62, v63
    v_pk_max_i16 v52, v52, 0
    v_pk_max_i16 v53, v53, 0
    v_pk_max_i16 v54, v54, 0
    v_pk_max_i16 v55, v55, 0
    v_or_b32 v52, s52, v52
    v_or_b32 v53, s53, v53
    v_or_b32 v54, s54, v54
    v_or_b32 v55, s55, v55
    buffer_store_dwordx4 v[52:55], v2, s[28:31], s44 offen offset:1024 sc1
    v_cvt_pk_bf16_f32 v64, v64, v65
    v_cvt_pk_bf16_f32 v65, v66, v67
    v_cvt_pk_bf16_f32 v66, v68, v69
    v_cvt_pk_bf16_f32 v67, v70, v71
    v_pk_max_i16 v64, v64, 0
    v_pk_max_i16 v65, v65, 0
    v_pk_max_i16 v66, v66, 0
    v_pk_max_i16 v67, v67, 0
    v_or_b32 v64, s52, v64
    v_or_b32 v65, s53, v65
    v_or_b32 v66, s54, v66
    v_or_b32 v67, s55, v67
    buffer_store_dwordx4 v[64:67], v2, s[28:31], s45 offen offset:0 sc1
    v_cvt_pk_bf16_f32 v68, v72, v73
    v_cvt_pk_bf16_f32 v69, v74, v75
    v_cvt_pk_bf16_f32 v70, v76, v77
    v_cvt_pk_bf16_f32 v71, v78, v79
    v_pk_max_i16 v68, v68, 0
    v_pk_max_i16 v69, v69, 0
    v_pk_max_i16 v70, v70, 0
    v_pk_max_i16 v71, v71, 0
    v_or_b32 v68, s52, v68
    v_or_b32 v69, s53, v69
    v_or_b32 v70, s54, v70
    v_or_b32 v71, s55, v71
    buffer_store_dwordx4 v[68:71], v2, s[28:31], s45 offen offset:1024 sc1
    v_mov_b32 v5, 160304
    v_mov_b32 v1, 1
    s_mov_b64 exec, 1
    ds_add_u32 v5, v1
    s_mov_b64 exec, -1
    s_waitcnt vmcnt(7)
    buffer_load_dwordx4 v[244:247], v7, s[28:31], s34 offen offset:1024 sc1
    s_lshl_b32 s34, s33, 1
    s_waitcnt vmcnt(7)
    buffer_load_dwordx4 v[248:251], v7, s[28:31], s34 offen offset:0 sc1
    s_waitcnt vmcnt(7)
    buffer_load_dwordx4 v[252:255], v7, s[28:31], s34 offen offset:1024 sc1
    s_branch L_p2
L_mq:
    s_add_u32 s74, s58, 19070976
    s_addc_u32 s75, s59, 0
    s_load_dword s99, s[74:75], 0
    s_mov_b32 s28, s58
    s_and_b32 s29, s59, 0xffff
    s_mov_b32 s30, 134217728
    s_mov_b32 s31, 0x00020000
    s_mov_b32 s24, s56
    s_and_b32 s25, s57, 0xffff
    s_mov_b32 s26, 2097152
    s_mov_b32 s27, 0x00020000
    v_lshrrev_b32 v27, 5, v0
    v_lshrrev_b32 v28, 2, v0
    v_and_b32 v28, 3, v28
    v_lshrrev_b32 v29, 4, v0
    v_and_b32 v29, 1, v29
    v_lshlrev_b32 v29, 5, v29
    v_and_b32 v30, 3, v0
    v_lshl_add_u32 v29, v30, 3, v29
    s_lshl_b32 s37, s100, 1
    s_add_u32 s37, s37, s101
    s_and_b32 s40, s42, 3
    s_lshl_b32 s41, s3, 2
    s_add_u32 s40, s40, s41
    s_lshr_b32 s41, s42, 2
    s_and_b32 s72, s42, 3
    s_lshl_b32 s96, s72, 1
    s_add_u32 s96, s96, s38
    s_and_b32 s96, s96, 7
    s_and_b32 s72, s72, 1
    s_lshl_b32 s73, s72, 2
    s_add_u32 s97, s41, s73
    s_and_b32 s97, s97, 7
    s_lshl_b32 s73, s72, 1
    s_add_u32 s98, s41, s73
    s_and_b32 s98, s98, 3
    v_and_b32 v26, 31, v0
    v_lshrrev_b32 v30, 1, v26
    v_and_b32 v30, 7, v30
    s_lshl_b32 s72, s38, 12
    v_lshl_add_u32 v31, v26, 7, s72
    v_add_u32 v1, 0, v27
    v_xor_b32 v1, v1, v30
    v_lshl_add_u32 v10, v1, 4, v31
    v_add_u32 v16, 0x10000, v10
    v_add_u32 v1, 2, v27
    v_xor_b32 v1, v1, v30
    v_lshl_add_u32 v11, v1, 4, v31
    v_add_u32 v17, 0x10000, v11
    v_add_u32 v1, 4, v27
    v_xor_b32 v1, v1, v30
    v_lshl_add_u32 v12, v1, 4, v31
    v_add_u32 v18, 0x10000, v12
    v_add_u32 v1, 6, v27
    v_xor_b32 v1, v1, v30
    v_lshl_add_u32 v13, v1, 4, v31
    v_add_u32 v19, 0x10000, v13
    v_lshl_add_u32 v1, v27, 3, v28
    v_lshl_add_u32 v25, v1, 6, v29
    v_add_u32 v25, 65536, v25
    v_lshl_add_u32 v14, v1, 7, v29
    v_lshrrev_b32 v1, 1, v28
    v_lshl_add_u32 v14, v1, 6, v14
    v_xor_b32 v15, 64, v14
    v_add_u32 v20, 81920, v14
    v_add_u32 v21, 81920, v15
    s_and_b32 s61, s38, 1
    s_lshr_b32 s60, s38, 1
    s_lshl_b32 s72, s61, 6
    v_xor_b32 v22, s72, v14
    s_lshl_b32 s73, s60, 13
    s_add_u32 s73, s73, 16384
    v_add_u32 v22, s73, v22
    s_and_b32 s73, s100, 1
    s_lshl_b32 s73, s73, 6
    v_xor_b32 v9, s73, v14
    v_add_u32 v9, 139264, v9
    s_cmp_eq_u32 s60, 0
    s_cselect_b32 s72, s72, s73
    s_lshl_b32 s73, s60, 13
    s_add_u32 s73, s73, 131072
    v_xor_b32 v24, s72, v14
    v_add_u32 v24, s73, v24
    v_and_b32 v1, 1, v197
    v_sub_u32 v1, v198, v1
    v_mov_b32 v200, 0x3f803f80
    v_cmp_eq_u32 vcc, 0, v1
    s_nop 1
    v_cndmask_b32 v228, 0, v200, vcc
    v_cndmask_b32 v229, 0, v200, vcc
    v_cndmask_b32 v230, 0, v200, vcc
    v_cndmask_b32 v231, 0, v200, vcc
    v_cmp_eq_u32 vcc, 4, v1
    s_nop 1
    v_cndmask_b32 v232, 0, v200, vcc
    v_cndmask_b32 v233, 0, v200, vcc
    v_cndmask_b32 v234, 0, v200, vcc
    v_cndmask_b32 v235, 0, v200, vcc
    v_lshlrev_b32 v1, 3, v26
    v_add_u32 v23, 158208, v1
    v_lshlrev_b32 v2, 4, v0
    s_lshl_b32 s72, s38, 11
    s_add_u32 s72, s72, 98304
    v_add_u32 v3, s72, v2
    s_lshl_b32 s72, s38, 2
    s_add_u32 s72, s72, 160256
    v_mov_b32 v5, s72
    v_mov_b32 v7, 0
    s_lshl_b32 s72, s36, 2
    s_add_u32 s72, s72, s38
    s_lshl_b32 s72, s72, 3
    s_add_u32 s72, s72, s100
    s_mul_i32 s44, s72, 18432
    s_add_u32 s45, s44, 2048
    s_add_u32 s46, s44, 4096
    s_add_u32 s47, s44, 6144
    s_add_u32 s48, s44, 12288
    s_lshl_b32 s72, s100, 2
    s_add_u32 s72, s72, s38
    s_lshl_b32 s49, s72, 2
    s_add_u32 s49, s49, 19005440
    s_mul_i32 s69, s72, 4352
    s_add_u32 s69, s69, 17825792
    s_cmp_lg_u32 s36, s100
    s_cselect_b32 s50, 1, 0
    v_mov_b32 v244, 0
    v_mov_b32 v245, 0
    v_mov_b32 v246, 0
    v_mov_b32 v247, 0
    s_lshr_b32 s72, s36, 3
    s_lshl_b32 s68, s37, 1
    s_add_u32 s68, s68, s72
    s_lshl_b32 s68, s68, 14
    s_lshl_b32 s72, s38, 9
    s_add_u32 s68, s68, s72
    s_add_u32 s68, s68, 18350080
    s_lshl_b32 s51, s43, 11
    s_add_u32 s51, s51, s68
    s_lshl_b32 s71, s36, 11
    s_add_u32 s71, s71, s72
    s_add_u32 s71, s71, 18087936
    s_waitcnt lgkmcnt(0)
    s_mul_i32 s39, s99, 0x9E3779B1
    s_add_u32 s39, s39, 0x7F4A7C15
    s_and_b32 s52, s99, 3
    s_xor_b32 s53, s52, 1
    s_bfe_u32 s54, s99, 0x20002
    s_bfe_u32 s55, s99, 0x20004
    s_mul_i32 s52, s52, 0x40008000
    s_and_b32 s52, s52, 0x80008000
    s_mul_i32 s53, s53, 0x40008000
    s_and_b32 s53, s53, 0x80008000
    s_mul_i32 s54, s54, 0x40008000
    s_and_b32 s54, s54, 0x80008000
    s_mul_i32 s55, s55, 0x40008000
    s_and_b32 s55, s55, 0x80008000
    v_mov_b32 v6, s39
    s_waitcnt vmcnt(0)
    s_barrier
    ds_read_b128 v[128:131], v10 offset:0
    ds_read_b64_tr_b16 v[32:33], v14 offset:16384
    ds_read_b64_tr_b16 v[34:35], v14 offset:16896
    ds_read_b64_tr_b16 v[36:37], v15 offset:16384
    ds_read_b64_tr_b16 v[38:39], v15 offset:16896
    ds_read_b64_tr_b16 v[40:41], v14 offset:24576
    ds_read_b64_tr_b16 v[42:43], v14 offset:25088
    ds_read_b64_tr_b16 v[44:45], v15 offset:24576
    ds_read_b64_tr_b16 v[46:47], v15 offset:25088
    ds_read_b128 v[132:135], v11 offset:0
    ds_read_b64_tr_b16 v[48:49], v14 offset:18432
    ds_read_b64_tr_b16 v[50:51], v14 offset:18944
    ds_read_b64_tr_b16 v[52:53], v15 offset:18432
    ds_read_b64_tr_b16 v[54:55], v15 offset:18944
    ds_read_b64_tr_b16 v[56:57], v14 offset:26624
    s_waitcnt lgkmcnt(14)
    ds_read_b64_tr_b16 v[58:59], v14 offset:27136
    s_waitcnt lgkmcnt(14)
    ds_read_b64_tr_b16 v[60:61], v15 offset:26624
    s_waitcnt lgkmcnt(14)
    ds_read_b64_tr_b16 v[62:63], v15 offset:27136
    s_waitcnt lgkmcnt(14)
    ds_read_b128 v[136:139], v12 offset:0
    s_waitcnt lgkmcnt(14)
    ds_read_b128 v[140:143], v13 offset:0
    v_mfma_f32_32x32x16_bf16 v[64:79], v[32:35], v[128:131], 0
    s_waitcnt lgkmcnt(14)
    ds_read_b64_tr_b16 v[32:33], v14 offset:20480
    s_waitcnt lgkmcnt(14)
    ds_read_b64_tr_b16 v[34:35], v14 offset:20992
    s_waitcnt lgkmcnt(14)
    ds_read_b64_tr_b16 v[192:193], v22 offset:0
    s_waitcnt lgkmcnt(14)
    ds_read_b64_tr_b16 v[194:195], v22 offset:512
    v_mfma_f32_32x32x16_bf16 v[80:95], v[36:39], v[128:131], 0
    s_waitcnt lgkmcnt(14)
    ds_read_b64_tr_b16 v[36:37], v15 offset:20480
    s_waitcnt lgkmcnt(14)
    ds_read_b64_tr_b16 v[38:39], v15 offset:20992
    s_waitcnt lgkmcnt(14)
    ds_read_b64_tr_b16 v[196:197], v22 offset:2048
    s_waitcnt lgkmcnt(14)
    ds_read_b64_tr_b16 v[198:199], v22 offset:2560
    v_mfma_f32_32x32x16_bf16 v[96:111], v[40:43], v[128:131], 0
    s_waitcnt lgkmcnt(14)
    ds_read_b64_tr_b16 v[40:41], v14 offset:28672
    s_waitcnt lgkmcnt(14)
    ds_read_b64_tr_b16 v[42:43], v14 offset:29184
    s_waitcnt lgkmcnt(14)
    ds_read_b64_tr_b16 v[200:201], v22 offset:4096
    s_waitcnt lgkmcnt(14)
    ds_read_b64_tr_b16 v[202:203], v22 offset:4608
    v_mfma_f32_32x32x16_bf16 v[112:127], v[44:47], v[128:131], 0
    s_waitcnt lgkmcnt(14)
    ds_read_b64_tr_b16 v[44:45], v15 offset:28672
    s_waitcnt lgkmcnt(14)
    ds_read_b64_tr_b16 v[46:47], v15 offset:29184
    s_waitcnt lgkmcnt(14)
    ds_read_b64_tr_b16 v[204:205], v22 offset:6144
    s_waitcnt lgkmcnt(14)
    ds_read_b64_tr_b16 v[206:207], v22 offset:6656
    v_mfma_f32_32x32x16_bf16 v[64:79], v[48:51], v[132:135], v[64:79]
    s_waitcnt lgkmcnt(14)
    ds_read_b64_tr_b16 v[48:49], v14 offset:22528
    s_waitcnt lgkmcnt(14)
    ds_read_b64_tr_b16 v[50:51], v14 offset:23040
    v_mfma_f32_32x32x16_bf16 v[80:95], v[52:55], v[132:135], v[80:95]
    s_waitcnt lgkmcnt(14)
    ds_read_b64_tr_b16 v[52:53], v15 offset:22528
    s_waitcnt lgkmcnt(14)
    ds_read_b64_tr_b16 v[54:55], v15 offset:23040
    v_mfma_f32_32x32x16_bf16 v[96:111], v[56:59], v[132:135], v[96:111]
    s_waitcnt lgkmcnt(14)
    ds_read_b64_tr_b16 v[56:57], v14 offset:30720
    s_waitcnt lgkmcnt(14)
    ds_read_b64_tr_b16 v[58:59], v14 offset:31232
    v_mfma_f32_32x32x16_bf16 v[112:127], v[60:63], v[132:135], v[112:127]
    s_waitcnt lgkmcnt(14)
    ds_read_b64_tr_b16 v[60:61], v15 offset:30720
    s_waitcnt lgkmcnt(14)
    ds_read_b64_tr_b16 v[62:63], v15 offset:31232
    s_waitcnt lgkmcnt(8)
    v_mfma_f32_16x16x32_bf16 v[236:239], v[228:231], v[192:195], 0
    v_mfma_f32_16x16x32_bf16 v[236:239], v[228:231], v[196:199], v[236:239]
    v_mfma_f32_32x32x16_bf16 v[64:79], v[32:35], v[136:139], v[64:79]
    v_mfma_f32_16x16x32_bf16 v[236:239], v[228:231], v[200:203], v[236:239]
    v_mfma_f32_16x16x32_bf16 v[236:239], v[228:231], v[204:207], v[236:239]
    v_mfma_f32_32x32x16_bf16 v[80:95], v[36:39], v[136:139], v[80:95]
    v_mfma_f32_32x32x16_bf16 v[96:111], v[40:43], v[136:139], v[96:111]
    v_mfma_f32_32x32x16_bf16 v[112:127], v[44:47], v[136:139], v[112:127]
    s_waitcnt lgkmcnt(6)
    v_mfma_f32_32x32x16_bf16 v[64:79], v[48:51], v[140:143], v[64:79]
    s_waitcnt lgkmcnt(4)
    v_mfma_f32_32x32x16_bf16 v[80:95], v[52:55], v[140:143], v[80:95]
    s_waitcnt lgkmcnt(2)
    v_mfma_f32_32x32x16_bf16 v[96:111], v[56:59], v[140:143], v[96:111]
    s_waitcnt lgkmcnt(0)
    v_mfma_f32_32x32x16_bf16 v[112:127], v[60:63], v[140:143], v[112:127]
    s_waitcnt lgkmcnt(0)
    s_barrier
    ds_read_b128 v[144:147], v10 offset:32768
    ds_read_b64_tr_b16 v[32:33], v14 offset:49152
    ds_read_b64_tr_b16 v[34:35], v14 offset:49664
    ds_read_b64_tr_b16 v[36:37], v15 offset:49152
    ds_read_b64_tr_b16 v[38:39], v15 offset:49664
    s_waitcnt lgkmcnt(2)
    v_mfma_f32_32x32x16_bf16 v[64:79], v[32:35], v[144:147], v[64:79]
    ds_read_b64_tr_b16 v[40:41], v14 offset:57344
    ds_read_b64_tr_b16 v[42:43], v14 offset:57856
    ds_read_b64_tr_b16 v[44:45], v15 offset:57344
    ds_read_b64_tr_b16 v[46:47], v15 offset:57856
    ds_read_b128 v[148:151], v11 offset:32768
    s_cmp_lg_u32 s50, 0
    s_cbranch_scc1 L_nz
    buffer_store_dwordx4 v[244:247], v2, s[28:31], s69 offen sc1
    buffer_store_dwordx4 v[244:247], v2, s[28:31], s69 offen offset:1024 sc1
    buffer_store_dwordx4 v[244:247], v2, s[28:31], s69 offen offset:2048 sc1
    buffer_store_dwordx4 v[244:247], v2, s[28:31], s69 offen offset:3072 sc1
    s_add_u32 s69, s69, 4096
    s_mov_b64 exec, 0xffff
    buffer_store_dwordx4 v[244:247], v2, s[28:31], s69 offen sc1
    s_mov_b64 exec, -1
L_nz:
    s_waitcnt lgkmcnt(5)
    v_mfma_f32_32x32x16_bf16 v[80:95], v[36:39], v[144:147], v[80:95]
    ds_read_b64_tr_b16 v[48:49], v14 offset:51200
    ds_read_b64_tr_b16 v[50:51], v14 offset:51712
    ds_read_b64_tr_b16 v[52:53], v15 offset:51200
    ds_read_b64_tr_b16 v[54:55], v15 offset:51712
    ds_read_b64_tr_b16 v[56:57], v14 offset:59392
    ds_read_b64_tr_b16 v[58:59], v14 offset:59904
    s_waitcnt lgkmcnt(9)
    v_mfma_f32_32x32x16_bf16 v[96:111], v[40:43], v[144:147], v[96:111]
    ds_read_b64_tr_b16 v[60:61], v15 offset:59392
    ds_read_b64_tr_b16 v[62:63], v15 offset:59904
    ds_read_b128 v[152:155], v12 offset:32768
    ds_read_b64_tr_b16 v[32:33], v14 offset:53248
    ds_read_b64_tr_b16 v[34:35], v14 offset:53760
    s_waitcnt lgkmcnt(12)
    v_mfma_f32_32x32x16_bf16 v[112:127], v[44:47], v[144:147], v[112:127]
    ds_read_b64_tr_b16 v[36:37], v15 offset:53248
    ds_read_b64_tr_b16 v[38:39], v15 offset:53760
    ds_read_b64_tr_b16 v[40:41], v14 offset:61440
    s_waitcnt lgkmcnt(14)
    ds_read_b64_tr_b16 v[42:43], v14 offset:61952
    s_waitcnt lgkmcnt(14)
    ds_read_b64_tr_b16 v[44:45], v15 offset:61440
    s_waitcnt lgkmcnt(14)
    ds_read_b64_tr_b16 v[46:47], v15 offset:61952
    v_mfma_f32_32x32x16_bf16 v[64:79], v[48:51], v[148:151], v[64:79]
    s_waitcnt lgkmcnt(14)
    ds_read_b128 v[156:159], v13 offset:32768
    s_waitcnt lgkmcnt(14)
    ds_read_b64_tr_b16 v[48:49], v14 offset:55296
    s_waitcnt lgkmcnt(14)
    ds_read_b64_tr_b16 v[50:51], v14 offset:55808
    v_mfma_f32_32x32x16_bf16 v[80:95], v[52:55], v[148:151], v[80:95]
    s_waitcnt lgkmcnt(14)
    ds_read_b64_tr_b16 v[52:53], v15 offset:55296
    s_waitcnt lgkmcnt(14)
    ds_read_b64_tr_b16 v[54:55], v15 offset:55808
    v_mfma_f32_32x32x16_bf16 v[96:111], v[56:59], v[148:151], v[96:111]
    s_waitcnt lgkmcnt(14)
    ds_read_b64_tr_b16 v[56:57], v14 offset:63488
    s_waitcnt lgkmcnt(14)
    ds_read_b64_tr_b16 v[58:59], v14 offset:64000
    v_mfma_f32_32x32x16_bf16 v[112:127], v[60:63], v[148:151], v[112:127]
    s_waitcnt lgkmcnt(14)
    ds_read_b64_tr_b16 v[60:61], v15 offset:63488
    s_waitcnt lgkmcnt(14)
    ds_read_b64_tr_b16 v[62:63], v15 offset:64000
    v_mfma_f32_32x32x16_bf16 v[64:79], v[32:35], v[152:155], v[64:79]
    s_getreg_b32 s72, hwreg(HW_REG_IB_STS)
    s_and_b32 s72, s72, 12582927
    s_or_b32 s72, s72, s50
    s_cbranch_scc1 L_ft_14
    s_mov_b64 exec, 1
    buffer_store_dword v6, v7, s[28:31], s49 offen sc1
    s_mov_b64 exec, -1
    s_mov_b32 s50, 1
L_ft_14:
    s_waitcnt lgkmcnt(13)
    v_mfma_f32_32x32x16_bf16 v[80:95], v[36:39], v[152:155], v[80:95]
    s_waitcnt lgkmcnt(11)
    v_mfma_f32_32x32x16_bf16 v[96:111], v[40:43], v[152:155], v[96:111]
    s_waitcnt lgkmcnt(9)
    v_mfma_f32_32x32x16_bf16 v[112:127], v[44:47], v[152:155], v[112:127]
    s_waitcnt lgkmcnt(6)
    v_mfma_f32_32x32x16_bf16 v[64:79], v[48:51], v[156:159], v[64:79]
    s_getreg_b32 s72, hwreg(HW_REG_IB_STS)
    s_and_b32 s72, s72, 12582927
    s_or_b32 s72, s72, s50
    s_cbranch_scc1 L_ft_15
    s_mov_b64 exec, 1
    buffer_store_dword v6, v7, s[28:31], s49 offen sc1
    s_mov_b64 exec, -1
    s_mov_b32 s50, 1
L_ft_15:
    s_waitcnt lgkmcnt(4)
    v_mfma_f32_32x32x16_bf16 v[80:95], v[52:55], v[156:159], v[80:95]
    s_waitcnt lgkmcnt(2)
    v_mfma_f32_32x32x16_bf16 v[96:111], v[56:59], v[156:159], v[96:111]
    s_waitcnt lgkmcnt(0)
    v_mfma_f32_32x32x16_bf16 v[112:127], v[60:63], v[156:159], v[112:127]
    s_waitcnt lgkmcnt(0)
    s_barrier
    ds_read_b128 v[160:163], v16 offset:0
    ds_read_b64_tr_b16 v[32:33], v20 offset:0
    ds_read_b64_tr_b16 v[34:35], v20 offset:512
    ds_read_b64_tr_b16 v[36:37], v21 offset:0
    ds_read_b64_tr_b16 v[38:39], v21 offset:512
    ds_read_b64_tr_b16 v[208:209], v24 offset:0
    ds_read_b64_tr_b16 v[210:211], v24 offset:512
    s_waitcnt lgkmcnt(4)
    v_mfma_f32_32x32x16_bf16 v[64:79], v[32:35], v[160:163], v[64:79]
    ds_read_b64_tr_b16 v[40:41], v20 offset:8192
    ds_read_b64_tr_b16 v[42:43], v20 offset:8704
    ds_read_b64_tr_b16 v[44:45], v21 offset:8192
    ds_read_b64_tr_b16 v[46:47], v21 offset:8704
    ds_read_b128 v[164:167], v17 offset:0
    ds_read_b64_tr_b16 v[212:213], v24 offset:2048
    ds_read_b64_tr_b16 v[214:215], v24 offset:2560
    s_waitcnt lgkmcnt(9)
    v_mfma_f32_32x32x16_bf16 v[80:95], v[36:39], v[160:163], v[80:95]
    ds_read_b64_tr_b16 v[48:49], v20 offset:2048
    ds_read_b64_tr_b16 v[50:51], v20 offset:2560
    ds_read_b64_tr_b16 v[52:53], v21 offset:2048
    ds_read_b64_tr_b16 v[54:55], v21 offset:2560
    ds_read_b64_tr_b16 v[56:57], v20 offset:10240
    ds_read_b64_tr_b16 v[58:59], v20 offset:10752
    s_waitcnt lgkmcnt(14)
    ds_read_b64_tr_b16 v[216:217], v24 offset:4096
    s_waitcnt lgkmcnt(14)
    ds_read_b64_tr_b16 v[218:219], v24 offset:4608
    s_waitcnt lgkmcnt(13)
    v_mfma_f32_32x32x16_bf16 v[96:111], v[40:43], v[160:163], v[96:111]
    ds_read_b64_tr_b16 v[60:61], v21 offset:10240
    ds_read_b64_tr_b16 v[62:63], v21 offset:10752
    s_waitcnt lgkmcnt(14)
    ds_read_b128 v[168:171], v18 offset:0
    s_waitcnt lgkmcnt(14)
    ds_read_b64_tr_b16 v[32:33], v20 offset:4096
    s_waitcnt lgkmcnt(14)
    ds_read_b64_tr_b16 v[34:35], v20 offset:4608
    s_waitcnt lgkmcnt(14)
    ds_read_b64_tr_b16 v[220:221], v24 offset:6144
    s_waitcnt lgkmcnt(14)
    ds_read_b64_tr_b16 v[222:223], v24 offset:6656
    v_mfma_f32_32x32x16_bf16 v[112:127], v[44:47], v[160:163], v[112:127]
    s_waitcnt lgkmcnt(14)
    ds_read_b64_tr_b16 v[36:37], v21 offset:4096
    s_waitcnt lgkmcnt(14)
    ds_read_b64_tr_b16 v[38:39], v21 offset:4608
    s_waitcnt lgkmcnt(14)
    ds_read_b64_tr_b16 v[40:41], v20 offset:12288
    s_waitcnt lgkmcnt(14)
    ds_read_b64_tr_b16 v[42:43], v20 offset:12800
    s_waitcnt lgkmcnt(14)
    ds_read_b64_tr_b16 v[44:45], v21 offset:12288
    s_waitcnt lgkmcnt(14)
    ds_read_b64_tr_b16 v[46:47], v21 offset:12800
    s_getreg_b32 s72, hwreg(HW_REG_IB_STS)
    s_and_b32 s72, s72, 12582927
    s_or_b32 s72, s72, s50
    s_cbranch_scc1 L_ft_16
    s_mov_b64 exec, 1
    buffer_store_dword v6, v7, s[28:31], s49 offen sc1
    s_mov_b64 exec, -1
    s_mov_b32 s50, 1
L_ft_16:
    v_mfma_f32_32x32x16_bf16 v[64:79], v[48:51], v[164:167], v[64:79]
    s_waitcnt lgkmcnt(14)
    ds_read_b128 v[172:175], v19 offset:0
    s_waitcnt lgkmcnt(14)
    ds_read_b64_tr_b16 v[48:49], v20 offset:6144
    s_waitcnt lgkmcnt(14)
    ds_read_b64_tr_b16 v[50:51], v20 offset:6656
    s_waitcnt lgkmcnt(9)
    v_mfma_f32_16x16x32_bf16 v[224:227], v[232:235], v[208:211], 0
    v_mfma_f32_16x16x32_bf16 v[224:227], v[232:235], v[212:215], v[224:227]
    v_mfma_f32_32x32x16_bf16 v[80:95], v[52:55], v[164:167], v[80:95]
    ds_read_b64_tr_b16 v[52:53], v21 offset:6144
    ds_read_b64_tr_b16 v[54:55], v21 offset:6656
    v_mfma_f32_16x16x32_bf16 v[224:227], v[232:235], v[216:219], v[224:227]
    v_mfma_f32_16x16x32_bf16 v[224:227], v[232:235], v[220:223], v[224:227]
    v_mfma_f32_32x32x16_bf16 v[96:111], v[56:59], v[164:167], v[96:111]
    ds_read_b64_tr_b16 v[56:57], v20 offset:14336
    ds_read_b64_tr_b16 v[58:59], v20 offset:14848
    s_getreg_b32 s72, hwreg(HW_REG_IB_STS)
    s_and_b32 s72, s72, 12582927
    s_or_b32 s72, s72, s50
    s_cbranch_scc1 L_ft_17
    s_mov_b64 exec, 1
    buffer_store_dword v6, v7, s[28:31], s49 offen sc1
    s_mov_b64 exec, -1
    s_mov_b32 s50, 1
L_ft_17:
    v_mfma_f32_32x32x16_bf16 v[112:127], v[60:63], v[164:167], v[112:127]
    ds_read_b64_tr_b16 v[60:61], v21 offset:14336
    ds_read_b64_tr_b16 v[62:63], v21 offset:14848
    v_cmp_gt_u32 vcc, 16, v0
    v_mov_b32 v238, v237
    v_mfma_f32_32x32x16_bf16 v[64:79], v[32:35], v[168:171], v[64:79]
    v_cndmask_b32 v236, v224, v236, vcc
    v_cndmask_b32 v238, v225, v238, vcc
    s_waitcnt lgkmcnt(13)
    v_mfma_f32_32x32x16_bf16 v[80:95], v[36:39], v[168:171], v[80:95]
    v_mov_b32 v237, v6
    v_mov_b32 v239, v6
    s_waitcnt lgkmcnt(11)
    v_mfma_f32_32x32x16_bf16 v[96:111], v[40:43], v[168:171], v[96:111]
    s_mov_b32 exec_hi, 0
    buffer_store_dwordx4 v[236:239], v2, s[28:31], s51 offen sc1
    s_mov_b32 exec_hi, -1
    s_getreg_b32 s72, hwreg(HW_REG_IB_STS)
    s_and_b32 s72, s72, 12582926
    s_or_b32 s72, s72, s50
    s_cbranch_scc1 L_ft_18
    s_mov_b64 exec, 1
    buffer_store_dword v6, v7, s[28:31], s49 offen sc1
    s_mov_b64 exec, -1
    s_mov_b32 s50, 1
L_ft_18:
    s_waitcnt lgkmcnt(9)
    v_mfma_f32_32x32x16_bf16 v[112:127], v[44:47], v[168:171], v[112:127]
    s_waitcnt lgkmcnt(6)
    v_mfma_f32_32x32x16_bf16 v[64:79], v[48:51], v[172:175], v[64:79]
    s_getreg_b32 s72, hwreg(HW_REG_IB_STS)
    s_and_b32 s72, s72, 12582926
    s_or_b32 s72, s72, s50
    s_cbranch_scc1 L_ft_19
    s_mov_b64 exec, 1
    buffer_store_dword v6, v7, s[28:31], s49 offen sc1
    s_mov_b64 exec, -1
    s_mov_b32 s50, 1
L_ft_19:
    s_add_u32 s8, s97, 0
    s_waitcnt lgkmcnt(4)
    v_mfma_f32_32x32x16_bf16 v[80:95], v[52:55], v[172:175], v[80:95]
    s_and_b32 s8, s8, 7
    s_lshl_b32 s8, s8, 10
    s_waitcnt lgkmcnt(2)
    v_mfma_f32_32x32x16_bf16 v[96:111], v[56:59], v[172:175], v[96:111]
    s_add_u32 s9, s97, 1
    s_and_b32 s9, s9, 7
    s_waitcnt lgkmcnt(0)
    v_mfma_f32_32x32x16_bf16 v[112:127], v[60:63], v[172:175], v[112:127]
    s_waitcnt lgkmcnt(0)
    s_barrier
    ds_read_b128 v[176:179], v16 offset:32768
    ds_read_b64_tr_b16 v[32:33], v20 offset:32768
    ds_read_b64_tr_b16 v[34:35], v20 offset:33280
    ds_read_b64_tr_b16 v[36:37], v21 offset:32768
    ds_read_b64_tr_b16 v[38:39], v21 offset:33280
    s_lshl_b32 s9, s9, 10
    s_add_u32 s10, s97, 2
    s_waitcnt lgkmcnt(2)
    v_mfma_f32_32x32x16_bf16 v[64:79], v[32:35], v[176:179], v[64:79]
    ds_read_b64_tr_b16 v[40:41], v20 offset:40960
    ds_read_b64_tr_b16 v[42:43], v20 offset:41472
    ds_read_b64_tr_b16 v[44:45], v21 offset:40960
    ds_read_b64_tr_b16 v[46:47], v21 offset:41472
    ds_read_b128 v[180:183], v17 offset:32768
    s_getreg_b32 s72, hwreg(HW_REG_IB_STS)
    s_and_b32 s72, s72, 12582926
    s_or_b32 s72, s72, s50
    s_cbranch_scc1 L_ft_20
    s_mov_b64 exec, 1
    buffer_store_dword v6, v7, s[28:31], s49 offen sc1
    s_mov_b64 exec, -1
    s_mov_b32 s50, 1
L_ft_20:
    s_and_b32 s10, s10, 7
    s_waitcnt lgkmcnt(5)
    v_mfma_f32_32x32x16_bf16 v[80:95], v[36:39], v[176:179], v[80:95]
    ds_read_b64_tr_b16 v[48:49], v20 offset:34816
    ds_read_b64_tr_b16 v[50:51], v20 offset:35328
    ds_read_b64_tr_b16 v[52:53], v21 offset:34816
    ds_read_b64_tr_b16 v[54:55], v21 offset:35328
    ds_read_b64_tr_b16 v[56:57], v20 offset:43008
    ds_read_b64_tr_b16 v[58:59], v20 offset:43520
    s_lshl_b32 s10, s10, 10
    s_add_u32 s11, s97, 3
    s_waitcnt lgkmcnt(9)
    v_mfma_f32_32x32x16_bf16 v[96:111], v[40:43], v[176:179], v[96:111]
    ds_read_b64_tr_b16 v[60:61], v21 offset:43008
    ds_read_b64_tr_b16 v[62:63], v21 offset:43520
    ds_read_b128 v[184:187], v18 offset:32768
    ds_read_b64_tr_b16 v[32:33], v20 offset:36864
    ds_read_b64_tr_b16 v[34:35], v20 offset:37376
    s_and_b32 s11, s11, 7
    s_lshl_b32 s11, s11, 10
    s_waitcnt lgkmcnt(12)
    v_mfma_f32_32x32x16_bf16 v[112:127], v[44:47], v[176:179], v[112:127]
    ds_read_b64_tr_b16 v[36:37], v21 offset:36864
    ds_read_b64_tr_b16 v[38:39], v21 offset:37376
    ds_read_b64_tr_b16 v[40:41], v20 offset:45056
    s_waitcnt lgkmcnt(14)
    ds_read_b64_tr_b16 v[42:43], v20 offset:45568
    s_waitcnt lgkmcnt(14)
    ds_read_b64_tr_b16 v[44:45], v21 offset:45056
    s_waitcnt lgkmcnt(14)
    ds_read_b64_tr_b16 v[46:47], v21 offset:45568
    s_add_u32 s12, s97, 4
    s_and_b32 s12, s12, 7
    v_mfma_f32_32x32x16_bf16 v[64:79], v[48:51], v[180:183], v[64:79]
    s_waitcnt lgkmcnt(14)
    ds_read_b128 v[188:191], v19 offset:32768
    s_waitcnt lgkmcnt(14)
    ds_read_b64_tr_b16 v[48:49], v20 offset:38912
    s_waitcnt lgkmcnt(14)
    ds_read_b64_tr_b16 v[50:51], v20 offset:39424
    s_lshl_b32 s12, s12, 10
    s_add_u32 s13, s97, 5
    v_mfma_f32_32x32x16_bf16 v[80:95], v[52:55], v[180:183], v[80:95]
    s_waitcnt lgkmcnt(14)
    ds_read_b64_tr_b16 v[52:53], v21 offset:38912
    s_waitcnt lgkmcnt(14)
    ds_read_b64_tr_b16 v[54:55], v21 offset:39424
    s_and_b32 s13, s13, 7
    s_lshl_b32 s13, s13, 10
    v_mfma_f32_32x32x16_bf16 v[96:111], v[56:59], v[180:183], v[96:111]
    s_waitcnt lgkmcnt(14)
    ds_read_b64_tr_b16 v[56:57], v20 offset:47104
    s_waitcnt lgkmcnt(14)
    ds_read_b64_tr_b16 v[58:59], v20 offset:47616
    s_getreg_b32 s72, hwreg(HW_REG_IB_STS)
    s_and_b32 s72, s72, 12582926
    s_or_b32 s72, s72, s50
    s_cbranch_scc1 L_ft_21
    s_mov_b64 exec, 1
    buffer_store_dword v6, v7, s[28:31], s49 offen sc1
    s_mov_b64 exec, -1
    s_mov_b32 s50, 1
L_ft_21:
    s_add_u32 s14, s97, 6
    v_mfma_f32_32x32x16_bf16 v[112:127], v[60:63], v[180:183], v[112:127]
    s_waitcnt lgkmcnt(14)
    ds_read_b64_tr_b16 v[60:61], v21 offset:47104
    s_waitcnt lgkmcnt(14)
    ds_read_b64_tr_b16 v[62:63], v21 offset:47616
    s_and_b32 s14, s14, 7
    s_lshl_b32 s14, s14, 10
    v_mfma_f32_32x32x16_bf16 v[64:79], v[32:35], v[184:187], v[64:79]
    s_add_u32 s15, s97, 7
    s_and_b32 s15, s15, 7
    s_waitcnt lgkmcnt(13)
    v_mfma_f32_32x32x16_bf16 v[80:95], v[36:39], v[184:187], v[80:95]
    s_lshl_b32 s15, s15, 10
    s_add_u32 s16, s98, 0
    s_waitcnt lgkmcnt(11)
    v_mfma_f32_32x32x16_bf16 v[96:111], v[40:43], v[184:187], v[96:111]
    s_and_b32 s16, s16, 3
    s_lshl_b32 s16, s16, 10
    s_waitcnt lgkmcnt(9)
    v_mfma_f32_32x32x16_bf16 v[112:127], v[44:47], v[184:187], v[112:127]
    s_add_u32 s16, s16, 8192
    s_add_u32 s17, s98, 1
    s_waitcnt lgkmcnt(6)
    v_mfma_f32_32x32x16_bf16 v[64:79], v[48:51], v[188:191], v[64:79]
    s_getreg_b32 s72, hwreg(HW_REG_IB_STS)
    s_and_b32 s72, s72, 12582926
    s_or_b32 s72, s72, s50
    s_cbranch_scc1 L_ft_22
    s_mov_b64 exec, 1
    buffer_store_dword v6, v7, s[28:31], s49 offen sc1
    s_mov_b64 exec, -1
    s_mov_b32 s50, 1
L_ft_22:
    s_and_b32 s17, s17, 3
    s_waitcnt lgkmcnt(4)
    v_mfma_f32_32x32x16_bf16 v[80:95], v[52:55], v[188:191], v[80:95]
    s_lshl_b32 s17, s17, 10
    s_add_u32 s17, s17, 8192
    s_waitcnt lgkmcnt(2)
    v_mfma_f32_32x32x16_bf16 v[96:111], v[56:59], v[188:191], v[96:111]
    s_add_u32 s18, s98, 2
    s_and_b32 s18, s18, 3
    s_waitcnt lgkmcnt(0)
    v_mfma_f32_32x32x16_bf16 v[112:127], v[60:63], v[188:191], v[112:127]
    s_waitcnt lgkmcnt(0)
    s_barrier
    ds_read_b128 v[192:195], v10 offset:0
    ds_read_b64_tr_b16 v[32:33], v14 offset:16384
    ds_read_b64_tr_b16 v[34:35], v14 offset:16896
    ds_read_b64_tr_b16 v[36:37], v15 offset:16384
    ds_read_b64_tr_b16 v[38:39], v15 offset:16896
    s_lshl_b32 s18, s18, 10
    s_add_u32 s18, s18, 8192
    s_waitcnt lgkmcnt(2)
    v_mfma_f32_32x32x16_bf16 v[64:79], v[32:35], v[192:195], v[64:79]
    ds_read_b64_tr_b16 v[40:41], v14 offset:24576
    ds_read_b64_tr_b16 v[42:43], v14 offset:25088
    ds_read_b64_tr_b16 v[44:45], v15 offset:24576
    ds_read_b64_tr_b16 v[46:47], v15 offset:25088
    ds_read_b128 v[196:199], v11 offset:0
    s_add_u32 s19, s98, 3
    s_and_b32 s19, s19, 3
    s_waitcnt lgkmcnt(5)
    v_mfma_f32_32x32x16_bf16 v[80:95], v[36:39], v[192:195], v[80:95]
    ds_read_b64_tr_b16 v[48:49], v14 offset:18432
    ds_read_b64_tr_b16 v[50:51], v14 offset:18944
    ds_read_b64_tr_b16 v[52:53], v15 offset:18432
    ds_read_b64_tr_b16 v[54:55], v15 offset:18944
    ds_read_b64_tr_b16 v[56:57], v14 offset:26624
    ds_read_b64_tr_b16 v[58:59], v14 offset:27136
    s_lshl_b32 s19, s19, 10
    s_add_u32 s19, s19, 8192
    s_waitcnt lgkmcnt(9)
    v_mfma_f32_32x32x16_bf16 v[96:111], v[40:43], v[192:195], v[96:111]
    ds_read_b64_tr_b16 v[60:61], v15 offset:26624
    ds_read_b64_tr_b16 v[62:63], v15 offset:27136
    ds_read_b128 v[200:203], v12 offset:0
    ds_read_b64_tr_b16 v[32:33], v14 offset:20480
    ds_read_b64_tr_b16 v[34:35], v14 offset:20992
    s_getreg_b32 s72, hwreg(HW_REG_IB_STS)
    s_and_b32 s72, s72, 12582926
    s_or_b32 s72, s72, s50
    s_cbranch_scc1 L_ft_23
    s_mov_b64 exec, 1
    buffer_store_dword v6, v7, s[28:31], s49 offen sc1
    s_mov_b64 exec, -1
    s_mov_b32 s50, 1
L_ft_23:
    s_mov_b32 s20, 12288
    s_waitcnt lgkmcnt(12)
    v_mfma_f32_32x32x16_bf16 v[112:127], v[44:47], v[192:195], v[112:127]
    ds_read_b64_tr_b16 v[36:37], v15 offset:20480
    ds_read_b64_tr_b16 v[38:39], v15 offset:20992
    ds_read_b64_tr_b16 v[40:41], v14 offset:28672
    s_waitcnt lgkmcnt(14)
    ds_read_b64_tr_b16 v[42:43], v14 offset:29184
    s_waitcnt lgkmcnt(14)
    ds_read_b64_tr_b16 v[44:45], v15 offset:28672
    s_waitcnt lgkmcnt(14)
    ds_read_b64_tr_b16 v[46:47], v15 offset:29184
    s_mov_b32 s21, 13312
    s_add_u32 s22, s16, 6144
    v_mfma_f32_32x32x16_bf16 v[64:79], v[48:51], v[196:199], v[64:79]
    s_waitcnt lgkmcnt(14)
    ds_read_b128 v[204:207], v13 offset:0
    s_waitcnt lgkmcnt(14)
    ds_read_b64_tr_b16 v[48:49], v14 offset:22528
    s_waitcnt lgkmcnt(14)
    ds_read_b64_tr_b16 v[50:51], v14 offset:23040
    s_add_u32 s23, s17, 6144
    s_add_u32 s32, s18, 6144
    v_mfma_f32_32x32x16_bf16 v[80:95], v[52:55], v[196:199], v[80:95]
    s_waitcnt lgkmcnt(14)
    ds_read_b64_tr_b16 v[52:53], v15 offset:22528
    s_waitcnt lgkmcnt(14)
    ds_read_b64_tr_b16 v[54:55], v15 offset:23040
    s_add_u32 s33, s19, 6144
    v_mfma_f32_32x32x16_bf16 v[96:111], v[56:59], v[196:199], v[96:111]
    s_waitcnt lgkmcnt(14)
    ds_read_b64_tr_b16 v[56:57], v14 offset:30720
    s_waitcnt lgkmcnt(14)
    ds_read_b64_tr_b16 v[58:59], v14 offset:31232
    v_mfma_f32_32x32x16_bf16 v[112:127], v[60:63], v[196:199], v[112:127]
    s_waitcnt lgkmcnt(14)
    ds_read_b64_tr_b16 v[60:61], v15 offset:30720
    s_waitcnt lgkmcnt(14)
    ds_read_b64_tr_b16 v[62:63], v15 offset:31232
    v_mfma_f32_32x32x16_bf16 v[64:79], v[32:35], v[200:203], v[64:79]
    s_getreg_b32 s72, hwreg(HW_REG_IB_STS)
    s_and_b32 s72, s72, 12582926
    s_or_b32 s72, s72, s50
    s_cbranch_scc1 L_ft_24
    s_mov_b64 exec, 1
    buffer_store_dword v6, v7, s[28:31], s49 offen sc1
    s_mov_b64 exec, -1
    s_mov_b32 s50, 1
L_ft_24:
    s_waitcnt lgkmcnt(13)
    v_mfma_f32_32x32x16_bf16 v[80:95], v[36:39], v[200:203], v[80:95]
    s_waitcnt lgkmcnt(11)
    v_mfma_f32_32x32x16_bf16 v[96:111], v[40:43], v[200:203], v[96:111]
    s_waitcnt lgkmcnt(9)
    v_mfma_f32_32x32x16_bf16 v[112:127], v[44:47], v[200:203], v[112:127]
    s_waitcnt lgkmcnt(6)
    v_mfma_f32_32x32x16_bf16 v[64:79], v[48:51], v[204:207], v[64:79]
    s_waitcnt lgkmcnt(4)
    v_mfma_f32_32x32x16_bf16 v[80:95], v[52:55], v[204:207], v[80:95]
    s_waitcnt lgkmcnt(2)
    v_mfma_f32_32x32x16_bf16 v[96:111], v[56:59], v[204:207], v[96:111]
    v_lshrrev_b32 v1, 5, v0
    v_lshlrev_b32 v24, 4, v26
    s_waitcnt lgkmcnt(0)
    v_mfma_f32_32x32x16_bf16 v[112:127], v[60:63], v[204:207], v[112:127]
    s_waitcnt lgkmcnt(0)
    s_barrier
    ds_read_b128 v[208:211], v10 offset:32768
    ds_read_b64_tr_b16 v[32:33], v14 offset:49152
    ds_read_b64_tr_b16 v[34:35], v14 offset:49664
    ds_read_b64_tr_b16 v[36:37], v15 offset:49152
    ds_read_b64_tr_b16 v[38:39], v15 offset:49664
    v_lshl_add_u32 v22, v1, 11, v24
    s_waitcnt lgkmcnt(2)
    v_mfma_f32_32x32x16_bf16 v[64:79], v[32:35], v[208:211], v[64:79]
    ds_read_b64_tr_b16 v[40:41], v14 offset:57344
    ds_read_b64_tr_b16 v[42:43], v14 offset:57856
    ds_read_b64_tr_b16 v[44:45], v15 offset:57344
    ds_read_b64_tr_b16 v[46:47], v15 offset:57856
    ds_read_b128 v[212:215], v11 offset:32768
    s_getreg_b32 s72, hwreg(HW_REG_IB_STS)
    s_and_b32 s72, s72, 12582926
    s_or_b32 s72, s72, s50
    s_cbranch_scc1 L_ft_25
    s_mov_b64 exec, 1
    buffer_store_dword v6, v7, s[28:31], s49 offen sc1
    s_mov_b64 exec, -1
    s_mov_b32 s50, 1
L_ft_25:
    s_waitcnt lgkmcnt(5)
    v_mfma_f32_32x32x16_bf16 v[80:95], v[36:39], v[208:211], v[80:95]
    ds_read_b64_tr_b16 v[48:49], v14 offset:51200
    ds_read_b64_tr_b16 v[50:51], v14 offset:51712
    ds_read_b64_tr_b16 v[52:53], v15 offset:51200
    ds_read_b64_tr_b16 v[54:55], v15 offset:51712
    ds_read_b64_tr_b16 v[56:57], v14 offset:59392
    ds_read_b64_tr_b16 v[58:59], v14 offset:59904
    s_waitcnt lgkmcnt(9)
    v_mfma_f32_32x32x16_bf16 v[96:111], v[40:43], v[208:211], v[96:111]
    ds_read_b64_tr_b16 v[60:61], v15 offset:59392
    ds_read_b64_tr_b16 v[62:63], v15 offset:59904
    ds_read_b128 v[216:219], v12 offset:32768
    ds_read_b64_tr_b16 v[32:33], v14 offset:53248
    ds_read_b64_tr_b16 v[34:35], v14 offset:53760
    s_add_u32 s72, s68, 0
    buffer_load_dwordx4 v[240:243], v22, s[28:31], s72 offen sc1
    s_add_u32 s72, s68, 4096
    buffer_load_dwordx4 v[244:247], v22, s[28:31], s72 offen sc1
    s_add_u32 s72, s68, 8192
    buffer_load_dwordx4 v[248:251], v22, s[28:31], s72 offen sc1
    s_add_u32 s72, s68, 12288
    buffer_load_dwordx4 v[252:255], v22, s[28:31], s72 offen sc1
    buffer_load_dwordx4 v[28:31], v24, s[28:31], s71 offen sc1
    s_waitcnt lgkmcnt(12)
    v_mfma_f32_32x32x16_bf16 v[112:127], v[44:47], v[208:211], v[112:127]
    ds_read_b64_tr_b16 v[36:37], v15 offset:53248
    ds_read_b64_tr_b16 v[38:39], v15 offset:53760
    ds_read_b64_tr_b16 v[40:41], v14 offset:61440
    s_waitcnt lgkmcnt(14)
    ds_read_b64_tr_b16 v[42:43], v14 offset:61952
    s_waitcnt lgkmcnt(14)
    ds_read_b64_tr_b16 v[44:45], v15 offset:61440
    s_waitcnt lgkmcnt(14)
    ds_read_b64_tr_b16 v[46:47], v15 offset:61952
    v_mfma_f32_32x32x16_bf16 v[64:79], v[48:51], v[212:215], v[64:79]
    s_waitcnt lgkmcnt(14)
    ds_read_b128 v[220:223], v13 offset:32768
    s_waitcnt lgkmcnt(14)
    ds_read_b64_tr_b16 v[48:49], v14 offset:55296
    s_waitcnt lgkmcnt(14)
    ds_read_b64_tr_b16 v[50:51], v14 offset:55808
    v_mfma_f32_32x32x16_bf16 v[80:95], v[52:55], v[212:215], v[80:95]
    s_waitcnt lgkmcnt(14)
    ds_read_b64_tr_b16 v[52:53], v15 offset:55296
    s_waitcnt lgkmcnt(14)
    ds_read_b64_tr_b16 v[54:55], v15 offset:55808
    v_mfma_f32_32x32x16_bf16 v[96:111], v[56:59], v[212:215], v[96:111]
    s_waitcnt lgkmcnt(14)
    ds_read_b64_tr_b16 v[56:57], v14 offset:63488
    s_waitcnt lgkmcnt(14)
    ds_read_b64_tr_b16 v[58:59], v14 offset:64000
    v_mfma_f32_32x32x16_bf16 v[112:127], v[60:63], v[212:215], v[112:127]
    s_waitcnt lgkmcnt(14)
    ds_read_b64_tr_b16 v[60:61], v15 offset:63488
    s_waitcnt lgkmcnt(14)
    ds_read_b64_tr_b16 v[62:63], v15 offset:64000
    v_mfma_f32_32x32x16_bf16 v[64:79], v[32:35], v[216:219], v[64:79]
    s_waitcnt lgkmcnt(13)
    v_mfma_f32_32x32x16_bf16 v[80:95], v[36:39], v[216:219], v[80:95]
    s_waitcnt lgkmcnt(11)
    v_mfma_f32_32x32x16_bf16 v[96:111], v[40:43], v[216:219], v[96:111]
    s_waitcnt lgkmcnt(9)
    v_mfma_f32_32x32x16_bf16 v[112:127], v[44:47], v[216:219], v[112:127]
    s_waitcnt lgkmcnt(6)
    v_mfma_f32_32x32x16_bf16 v[64:79], v[48:51], v[220:223], v[64:79]
    s_waitcnt lgkmcnt(4)
    v_mfma_f32_32x32x16_bf16 v[80:95], v[52:55], v[220:223], v[80:95]
    s_waitcnt lgkmcnt(2)
    v_mfma_f32_32x32x16_bf16 v[96:111], v[56:59], v[220:223], v[96:111]
    s_waitcnt lgkmcnt(0)
    v_mfma_f32_32x32x16_bf16 v[112:127], v[60:63], v[220:223], v[112:127]
    s_waitcnt lgkmcnt(0)
    s_barrier
    ds_read_b128 v[224:227], v16 offset:0
    ds_read_b64_tr_b16 v[32:33], v20 offset:0
    ds_read_b64_tr_b16 v[34:35], v20 offset:512
    ds_read_b64_tr_b16 v[36:37], v21 offset:0
    ds_read_b64_tr_b16 v[38:39], v21 offset:512
    s_waitcnt lgkmcnt(2)
    v_mfma_f32_32x32x16_bf16 v[64:79], v[32:35], v[224:227], v[64:79]
    ds_read_b64_tr_b16 v[40:41], v20 offset:8192
    ds_read_b64_tr_b16 v[42:43], v20 offset:8704
    ds_read_b64_tr_b16 v[44:45], v21 offset:8192
    ds_read_b64_tr_b16 v[46:47], v21 offset:8704
    ds_read_b128 v[228:231], v17 offset:0
    s_waitcnt lgkmcnt(5)
    v_mfma_f32_32x32x16_bf16 v[80:95], v[36:39], v[224:227], v[80:95]
    ds_read_b64_tr_b16 v[48:49], v20 offset:2048
    ds_read_b64_tr_b16 v[50:51], v20 offset:2560
    ds_read_b64_tr_b16 v[52:53], v21 offset:2048
    ds_read_b64_tr_b16 v[54:55], v21 offset:2560
    ds_read_b64_tr_b16 v[56:57], v20 offset:10240
    ds_read_b64_tr_b16 v[58:59], v20 offset:10752
    s_waitcnt lgkmcnt(9)
    v_mfma_f32_32x32x16_bf16 v[96:111], v[40:43], v[224:227], v[96:111]
    ds_read_b64_tr_b16 v[60:61], v21 offset:10240
    ds_read_b64_tr_b16 v[62:63], v21 offset:10752
    ds_read_b128 v[232:235], v18 offset:0
    ds_read_b64_tr_b16 v[32:33], v20 offset:4096
    ds_read_b64_tr_b16 v[34:35], v20 offset:4608
    s_mov_b32 s67, 0
L_gc1:
    s_waitcnt vmcnt(0)
    v_xor_b32 v1, v6, v29
    v_xor_b32 v27, v6, v31
    v_or_b32 v1, v1, v27
    v_xor_b32 v27, v6, v241
    v_xor_b32 v8, v6, v243
    v_or3_b32 v1, v1, v27, v8
    v_xor_b32 v27, v6, v245
    v_xor_b32 v8, v6, v247
    v_or3_b32 v1, v1, v27, v8
    v_xor_b32 v27, v6, v249
    v_xor_b32 v8, v6, v251
    v_or3_b32 v1, v1, v27, v8
    v_xor_b32 v27, v6, v253
    v_xor_b32 v8, v6, v255
    v_or3_b32 v1, v1, v27, v8
    v_cmp_ne_u32 vcc, 0, v1
    s_cbranch_vccz L_gok1
    s_add_u32 s67, s67, 1
    s_cmp_gt_u32 s67, 200000
    s_cbranch_scc1 L_gok1
    s_add_u32 s72, s68, 0
    buffer_load_dwordx4 v[240:243], v22, s[28:31], s72 offen sc1
    s_add_u32 s72, s68, 4096
    buffer_load_dwordx4 v[244:247], v22, s[28:31], s72 offen sc1
    s_add_u32 s72, s68, 8192
    buffer_load_dwordx4 v[248:251], v22, s[28:31], s72 offen sc1
    s_add_u32 s72, s68, 12288
    buffer_load_dwordx4 v[252:255], v22, s[28:31], s72 offen sc1
    buffer_load_dwordx4 v[28:31], v24, s[28:31], s71 offen sc1
    s_branch L_gc1
L_gok1:
    s_cmp_lg_u32 s50, 0
    s_cbranch_scc1 L_ft_26
    s_waitcnt vmcnt(0)
    s_mov_b64 exec, 1
    buffer_store_dword v6, v7, s[28:31], s49 offen sc1
    s_mov_b64 exec, -1
    s_mov_b32 s50, 1
L_ft_26:
    v_add_f32 v240, v240, v244
    v_add_f32 v242, v242, v246
    v_add_f32 v240, v240, v248
    s_waitcnt lgkmcnt(12)
    v_mfma_f32_32x32x16_bf16 v[112:127], v[44:47], v[224:227], v[112:127]
    ds_read_b64_tr_b16 v[36:37], v21 offset:4096
    ds_read_b64_tr_b16 v[38:39], v21 offset:4608
    ds_read_b64_tr_b16 v[40:41], v20 offset:12288
    s_waitcnt lgkmcnt(14)
    ds_read_b64_tr_b16 v[42:43], v20 offset:12800
    s_waitcnt lgkmcnt(14)
    ds_read_b64_tr_b16 v[44:45], v21 offset:12288
    s_waitcnt lgkmcnt(14)
    ds_read_b64_tr_b16 v[46:47], v21 offset:12800
    v_add_f32 v242, v242, v250
    v_add_f32 v240, v240, v252
    v_add_f32 v242, v242, v254
    v_mov_b32 v244, v240
    v_mfma_f32_32x32x16_bf16 v[64:79], v[48:51], v[228:231], v[64:79]
    s_waitcnt lgkmcnt(14)
    ds_read_b128 v[236:239], v19 offset:0
    s_waitcnt lgkmcnt(14)
    ds_read_b64_tr_b16 v[48:49], v20 offset:6144
    s_waitcnt lgkmcnt(14)
    ds_read_b64_tr_b16 v[50:51], v20 offset:6656
    v_mov_b32 v246, v242
    v_permlane32_swap_b32 v240, v244
    s_nop 0
    v_permlane32_swap_b32 v242, v246
    v_add_f32 v240, v240, v244
    v_mfma_f32_32x32x16_bf16 v[80:95], v[52:55], v[228:231], v[80:95]
    s_waitcnt lgkmcnt(14)
    ds_read_b64_tr_b16 v[52:53], v21 offset:6144
    s_waitcnt lgkmcnt(14)
    ds_read_b64_tr_b16 v[54:55], v21 offset:6656
    v_add_f32 v242, v242, v246
    v_cvt_pk_bf16_f32 v244, v240, v240
    v_and_b32 v248, 0xffff0000, v244
    v_sub_f32 v248, v240, v248
    v_mfma_f32_32x32x16_bf16 v[96:111], v[56:59], v[228:231], v[96:111]
    s_waitcnt lgkmcnt(14)
    ds_read_b64_tr_b16 v[56:57], v20 offset:14336
    s_waitcnt lgkmcnt(14)
    ds_read_b64_tr_b16 v[58:59], v20 offset:14848
    v_cvt_pk_bf16_f32 v245, v248, v248
    v_cvt_pk_bf16_f32 v246, v242, v242
    v_and_b32 v248, 0xffff0000, v246
    v_sub_f32 v248, v242, v248
    v_mfma_f32_32x32x16_bf16 v[112:127], v[60:63], v[228:231], v[112:127]
    s_waitcnt lgkmcnt(14)
    ds_read_b64_tr_b16 v[60:61], v21 offset:14336
    s_waitcnt lgkmcnt(14)
    ds_read_b64_tr_b16 v[62:63], v21 offset:14848
    v_cvt_pk_bf16_f32 v247, v248, v248
    v_bfe_u32 v1, v0, 4, 1
    v_and_b32 v24, 15, v0
    v_lshlrev_b32 v24, 3, v24
    v_mfma_f32_32x32x16_bf16 v[64:79], v[32:35], v[232:235], v[64:79]
    v_lshl_add_u32 v24, v1, 10, v24
    s_lshl_b32 s72, s38, 8
    s_add_u32 s72, s72, 158208
    v_add_u32 v24, s72, v24
    s_waitcnt lgkmcnt(13)
    v_mfma_f32_32x32x16_bf16 v[80:95], v[36:39], v[232:235], v[80:95]
    ds_write2_b64 v24, v[244:245], v[246:247] offset0:0 offset1:16
    s_lshl_b32 s72, s38, 7
    s_add_u32 s72, s72, 157696
    v_lshl_add_u32 v22, v26, 2, s72
    s_waitcnt lgkmcnt(12)
    v_mfma_f32_32x32x16_bf16 v[96:111], v[40:43], v[232:235], v[96:111]
    v_mov_b32 v8, v30
    ds_write_b32 v22, v8
    v_sub_f32 v28, 0, v28
    v_cvt_pk_bf16_f32 v1, v28, v28
    s_waitcnt lgkmcnt(11)
    v_mfma_f32_32x32x16_bf16 v[112:127], v[44:47], v[232:235], v[112:127]
    v_and_b32 v1, 0xffff0000, v1
    v_sub_f32 v1, v28, v1
    v_cvt_pk_bf16_f32 v1, v28, v1
    v_cmp_gt_u32 vcc, 32, v0
    s_waitcnt lgkmcnt(8)
    v_mfma_f32_32x32x16_bf16 v[64:79], v[48:51], v[236:239], v[64:79]
    v_cndmask_b32 v26, 0, v1, vcc
    v_cndmask_b32 v27, 0, v1, vcc
    s_waitcnt lgkmcnt(6)
    v_mfma_f32_32x32x16_bf16 v[80:95], v[52:55], v[236:239], v[80:95]
    s_waitcnt lgkmcnt(4)
    v_mfma_f32_32x32x16_bf16 v[96:111], v[56:59], v[236:239], v[96:111]
    s_waitcnt lgkmcnt(2)
    v_mfma_f32_32x32x16_bf16 v[112:127], v[60:63], v[236:239], v[112:127]
    s_waitcnt lgkmcnt(0)
    s_barrier
    ds_read_b128 v[240:243], v16 offset:32768
    ds_read_b64_tr_b16 v[32:33], v20 offset:32768
    ds_read_b64_tr_b16 v[34:35], v20 offset:33280
    ds_read_b64_tr_b16 v[36:37], v21 offset:32768
    ds_read_b64_tr_b16 v[38:39], v21 offset:33280
    s_waitcnt lgkmcnt(2)
    v_mfma_f32_32x32x16_bf16 v[64:79], v[32:35], v[240:243], v[64:79]
    ds_read_b64_tr_b16 v[40:41], v20 offset:40960
    ds_read_b64_tr_b16 v[42:43], v20 offset:41472
    ds_read_b64_tr_b16 v[44:45], v21 offset:40960
    ds_read_b64_tr_b16 v[46:47], v21 offset:41472
    ds_read_b128 v[244:247], v17 offset:32768
    s_waitcnt lgkmcnt(5)
    v_mfma_f32_32x32x16_bf16 v[80:95], v[36:39], v[240:243], v[80:95]
    ds_read_b64_tr_b16 v[48:49], v20 offset:34816
    ds_read_b64_tr_b16 v[50:51], v20 offset:35328
    ds_read_b64_tr_b16 v[52:53], v21 offset:34816
    ds_read_b64_tr_b16 v[54:55], v21 offset:35328
    ds_read_b64_tr_b16 v[56:57], v20 offset:43008
    ds_read_b64_tr_b16 v[58:59], v20 offset:43520
    s_waitcnt lgkmcnt(9)
    v_mfma_f32_32x32x16_bf16 v[96:111], v[40:43], v[240:243], v[96:111]
    ds_read_b64_tr_b16 v[60:61], v21 offset:43008
    ds_read_b64_tr_b16 v[62:63], v21 offset:43520
    ds_read_b128 v[248:251], v18 offset:32768
    ds_read_b64_tr_b16 v[32:33], v20 offset:36864
    ds_read_b64_tr_b16 v[34:35], v20 offset:37376
    s_waitcnt lgkmcnt(12)
    v_mfma_f32_32x32x16_bf16 v[112:127], v[44:47], v[240:243], v[112:127]
    ds_read_b64_tr_b16 v[36:37], v21 offset:36864
    ds_read_b64_tr_b16 v[38:39], v21 offset:37376
    ds_read_b64_tr_b16 v[40:41], v20 offset:45056
    s_waitcnt lgkmcnt(14)
    ds_read_b64_tr_b16 v[42:43], v20 offset:45568
    s_waitcnt lgkmcnt(14)
    ds_read_b64_tr_b16 v[44:45], v21 offset:45056
    s_waitcnt lgkmcnt(14)
    ds_read_b64_tr_b16 v[46:47], v21 offset:45568
    v_mfma_f32_32x32x16_bf16 v[64:79], v[48:51], v[244:247], v[64:79]
    s_waitcnt lgkmcnt(14)
    ds_read_b128 v[252:255], v19 offset:32768
    s_waitcnt lgkmcnt(14)
    ds_read_b64_tr_b16 v[48:49], v20 offset:38912
    s_waitcnt lgkmcnt(14)
    ds_read_b64_tr_b16 v[50:51], v20 offset:39424
    v_mfma_f32_32x32x16_bf16 v[80:95], v[52:55], v[244:247], v[80:95]
    s_waitcnt lgkmcnt(14)
    ds_read_b64_tr_b16 v[52:53], v21 offset:38912
    s_waitcnt lgkmcnt(14)
    ds_read_b64_tr_b16 v[54:55], v21 offset:39424
    v_mfma_f32_32x32x16_bf16 v[96:111], v[56:59], v[244:247], v[96:111]
    s_waitcnt lgkmcnt(14)
    ds_read_b64_tr_b16 v[56:57], v20 offset:47104
    s_waitcnt lgkmcnt(14)
    ds_read_b64_tr_b16 v[58:59], v20 offset:47616
    s_waitcnt lgkmcnt(14)
    ds_read_b64 v[10:11], v23 offset:0
    s_waitcnt lgkmcnt(14)
    ds_read_b64 v[12:13], v23 offset:256
    s_waitcnt lgkmcnt(14)
    ds_read_b64 v[16:17], v23 offset:512
    s_waitcnt lgkmcnt(14)
    ds_read_b64 v[18:19], v23 offset:768
    s_waitcnt lgkmcnt(14)
    ds_read_b64 v[28:29], v23 offset:1024
    s_waitcnt lgkmcnt(14)
    ds_read_b64 v[30:31], v23 offset:1280
    v_mfma_f32_32x32x16_bf16 v[112:127], v[60:63], v[244:247], v[112:127]
    s_waitcnt lgkmcnt(14)
    ds_read_b64_tr_b16 v[60:61], v21 offset:47104
    s_waitcnt lgkmcnt(14)
    ds_read_b64_tr_b16 v[62:63], v21 offset:47616
    v_mfma_f32_32x32x16_bf16 v[64:79], v[32:35], v[248:251], v[64:79]
    s_waitcnt lgkmcnt(14)
    ds_read_b64_tr_b16 v[32:33], v20 offset:49152
    s_waitcnt lgkmcnt(14)
    ds_read_b64_tr_b16 v[34:35], v20 offset:49664
    v_mfma_f32_32x32x16_bf16 v[80:95], v[36:39], v[248:251], v[80:95]
    s_waitcnt lgkmcnt(14)
    ds_read_b64_tr_b16 v[36:37], v20 offset:51200
    s_waitcnt lgkmcnt(14)
    ds_read_b64_tr_b16 v[38:39], v20 offset:51712
    v_mfma_f32_32x32x16_bf16 v[96:111], v[40:43], v[248:251], v[96:111]
    s_waitcnt lgkmcnt(14)
    ds_read_b64_tr_b16 v[40:41], v20 offset:53248
    s_waitcnt lgkmcnt(14)
    ds_read_b64_tr_b16 v[42:43], v20 offset:53760
    v_mfma_f32_32x32x16_bf16 v[112:127], v[44:47], v[248:251], v[112:127]
    s_waitcnt lgkmcnt(14)
    ds_read_b64_tr_b16 v[44:45], v20 offset:55296
    s_waitcnt lgkmcnt(14)
    ds_read_b64_tr_b16 v[46:47], v20 offset:55808
    v_mfma_f32_32x32x16_bf16 v[64:79], v[48:51], v[252:255], v[64:79]
    s_waitcnt lgkmcnt(0)
    s_barrier
    v_mfma_f32_32x32x16_bf16 v[80:95], v[52:55], v[252:255], v[80:95]
    v_mfma_f32_32x32x16_bf16 v[96:111], v[56:59], v[252:255], v[96:111]
    v_mfma_f32_32x32x16_bf16 v[112:127], v[60:63], v[252:255], v[112:127]
    v_mfma_f32_32x32x8bf16_1k v[64:79], v[10:11], v[26:27], v[64:79]
    v_mfma_f32_32x32x8bf16_1k v[80:95], v[12:13], v[26:27], v[80:95]
    v_mfma_f32_32x32x8bf16_1k v[96:111], v[16:17], v[26:27], v[96:111]
    v_mfma_f32_32x32x8bf16_1k v[112:127], v[18:19], v[26:27], v[112:127]
    v_and_b32 v22, 7, v0
    v_lshlrev_b32 v22, 2, v22
    s_lshl_b32 s61, s41, 3
    s_add_u32 s61, s61, s96
    s_lshl_b32 s61, s61, 5
    s_add_u32 s61, s61, 19136512
    buffer_load_dword v24, v22, s[28:31], s61 offen sc1
    v_mfma_f32_32x32x16_bf16 v[48:63], v[32:35], v[128:131], 0
    ds_read_b64_tr_b16 v[32:33], v14 offset:8192
    ds_read_b64_tr_b16 v[34:35], v14 offset:8704
    v_cvt_pk_bf16_f32 v64, v64, v65
    v_cvt_pk_bf16_f32 v65, v66, v67
    v_cvt_pk_bf16_f32 v66, v68, v69
    v_cvt_pk_bf16_f32 v67, v70, v71
    v_pk_max_i16 v64, v64, 0
    v_mfma_f32_32x32x16_bf16 v[48:63], v[36:39], v[132:135], v[48:63]
    ds_read_b64_tr_b16 v[36:37], v14 offset:10240
    ds_read_b64_tr_b16 v[38:39], v14 offset:10752
    v_pk_max_i16 v65, v65, 0
    v_pk_max_i16 v66, v66, 0
    v_pk_max_i16 v67, v67, 0
    v_or_b32 v64, s52, v64
    v_or_b32 v65, s53, v65
    v_mfma_f32_32x32x16_bf16 v[48:63], v[40:43], v[136:139], v[48:63]
    ds_read_b64_tr_b16 v[40:41], v14 offset:12288
    ds_read_b64_tr_b16 v[42:43], v14 offset:12800
    v_or_b32 v66, s54, v66
    v_or_b32 v67, s55, v67
    buffer_store_dwordx4 v[64:67], v2, s[28:31], s44 offen offset:0 sc1
    v_mfma_f32_32x32x16_bf16 v[48:63], v[44:47], v[140:143], v[48:63]
    ds_read_b64_tr_b16 v[44:45], v14 offset:14336
    ds_read_b64_tr_b16 v[46:47], v14 offset:14848
    s_waitcnt lgkmcnt(6)
    v_mfma_f32_32x32x16_bf16 v[48:63], v[32:35], v[144:147], v[48:63]
    ds_read_b64_tr_b16 v[32:33], v14 offset:16384
    ds_read_b64_tr_b16 v[34:35], v14 offset:16896
    s_waitcnt lgkmcnt(6)
    v_mfma_f32_32x32x16_bf16 v[48:63], v[36:39], v[148:151], v[48:63]
    ds_read_b64_tr_b16 v[36:37], v14 offset:18432
    ds_read_b64_tr_b16 v[38:39], v14 offset:18944
    s_waitcnt lgkmcnt(6)
    v_mfma_f32_32x32x16_bf16 v[48:63], v[40:43], v[152:155], v[48:63]
    ds_read_b64_tr_b16 v[40:41], v14 offset:20480
    ds_read_b64_tr_b16 v[42:43], v14 offset:20992
    v_cvt_pk_bf16_f32 v68, v72, v73
    v_cvt_pk_bf16_f32 v69, v74, v75
    v_cvt_pk_bf16_f32 v70, v76, v77
    v_cvt_pk_bf16_f32 v71, v78, v79
    v_pk_max_i16 v68, v68, 0
    s_waitcnt lgkmcnt(6)
    v_mfma_f32_32x32x16_bf16 v[48:63], v[44:47], v[156:159], v[48:63]
    ds_read_b64_tr_b16 v[44:45], v14 offset:22528
    ds_read_b64_tr_b16 v[46:47], v14 offset:23040
    v_pk_max_i16 v69, v69, 0
    v_pk_max_i16 v70, v70, 0
    v_pk_max_i16 v71, v71, 0
    v_or_b32 v68, s52, v68
    v_or_b32 v69, s53, v69
    s_waitcnt lgkmcnt(6)
    v_mfma_f32_32x32x16_bf16 v[48:63], v[32:35], v[160:163], v[48:63]
    ds_read_b64_tr_b16 v[32:33], v14 offset:24576
    ds_read_b64_tr_b16 v[34:35], v14 offset:25088
    v_or_b32 v70, s54, v70
    v_or_b32 v71, s55, v71
    buffer_store_dwordx4 v[68:71], v2, s[28:31], s44 offen offset:1024 sc1
    s_waitcnt lgkmcnt(6)
    v_mfma_f32_32x32x16_bf16 v[48:63], v[36:39], v[164:167], v[48:63]
    ds_read_b64_tr_b16 v[36:37], v14 offset:26624
    ds_read_b64_tr_b16 v[38:39], v14 offset:27136
    s_waitcnt lgkmcnt(6)
    v_mfma_f32_32x32x16_bf16 v[48:63], v[40:43], v[168:171], v[48:63]
    ds_read_b64_tr_b16 v[40:41], v14 offset:28672
    ds_read_b64_tr_b16 v[42:43], v14 offset:29184
    s_waitcnt lgkmcnt(6)
    v_mfma_f32_32x32x16_bf16 v[48:63], v[44:47], v[172:175], v[48:63]
    ds_read_b64_tr_b16 v[44:45], v14 offset:30720
    ds_read_b64_tr_b16 v[46:47], v14 offset:31232
    s_waitcnt lgkmcnt(6)
    v_mfma_f32_32x32x16_bf16 v[48:63], v[32:35], v[176:179], v[48:63]
    s_waitcnt lgkmcnt(0)
    s_barrier
    ds_read_b64_tr_b16 v[32:33], v14 offset:32768
    ds_read_b64_tr_b16 v[34:35], v14 offset:33280
    v_mfma_f32_32x32x16_bf16 v[48:63], v[36:39], v[180:183], v[48:63]
    ds_read_b64_tr_b16 v[36:37], v14 offset:34816
    ds_read_b64_tr_b16 v[38:39], v14 offset:35328
    v_mfma_f32_32x32x16_bf16 v[48:63], v[40:43], v[184:187], v[48:63]
    ds_read_b64_tr_b16 v[40:41], v14 offset:36864
    ds_read_b64_tr_b16 v[42:43], v14 offset:37376
    v_mfma_f32_32x32x16_bf16 v[48:63], v[44:47], v[188:191], v[48:63]
    ds_read_b64_tr_b16 v[44:45], v14 offset:38912
    ds_read_b64_tr_b16 v[46:47], v14 offset:39424
    v_cvt_pk_bf16_f32 v80, v80, v81
    v_cvt_pk_bf16_f32 v81, v82, v83
    v_cvt_pk_bf16_f32 v82, v84, v85
    v_cvt_pk_bf16_f32 v83, v86, v87
    v_pk_max_i16 v80, v80, 0
    s_waitcnt lgkmcnt(6)
    v_mfma_f32_32x32x16_bf16 v[48:63], v[32:35], v[192:195], v[48:63]
    ds_read_b64_tr_b16 v[32:33], v14 offset:40960
    ds_read_b64_tr_b16 v[34:35], v14 offset:41472
    v_pk_max_i16 v81, v81, 0
    v_pk_max_i16 v82, v82, 0
    v_pk_max_i16 v83, v83, 0
    v_or_b32 v80, s52, v80
    v_or_b32 v81, s53, v81
    s_waitcnt lgkmcnt(6)
    v_mfma_f32_32x32x16_bf16 v[48:63], v[36:39], v[196:199], v[48:63]
    ds_read_b64_tr_b16 v[36:37], v14 offset:43008
    ds_read_b64_tr_b16 v[38:39], v14 offset:43520
    v_or_b32 v82, s54, v82
    v_or_b32 v83, s55, v83
    buffer_store_dwordx4 v[80:83], v2, s[28:31], s45 offen offset:0 sc1
    s_waitcnt lgkmcnt(6)
    v_mfma_f32_32x32x16_bf16 v[48:63], v[40:43], v[200:203], v[48:63]
    ds_read_b64_tr_b16 v[40:41], v14 offset:45056
    ds_read_b64_tr_b16 v[42:43], v14 offset:45568
    s_waitcnt lgkmcnt(6)
    v_mfma_f32_32x32x16_bf16 v[48:63], v[44:47], v[204:207], v[48:63]
    ds_read_b64_tr_b16 v[44:45], v14 offset:47104
    ds_read_b64_tr_b16 v[46:47], v14 offset:47616
    s_waitcnt lgkmcnt(6)
    v_mfma_f32_32x32x16_bf16 v[48:63], v[32:35], v[208:211], v[48:63]
    ds_read_b64_tr_b16 v[32:33], v14 offset:49152
    ds_read_b64_tr_b16 v[34:35], v14 offset:49664
    ds_read_b64 v[10:11], v23 offset:1536
    s_waitcnt lgkmcnt(7)
    v_mfma_f32_32x32x16_bf16 v[48:63], v[36:39], v[212:215], v[48:63]
    ds_read_b64_tr_b16 v[36:37], v14 offset:51200
    ds_read_b64_tr_b16 v[38:39], v14 offset:51712
    s_waitcnt lgkmcnt(7)
    v_mfma_f32_32x32x16_bf16 v[48:63], v[40:43], v[216:219], v[48:63]
    ds_read_b64_tr_b16 v[40:41], v14 offset:53248
    ds_read_b64_tr_b16 v[42:43], v14 offset:53760
    s_waitcnt lgkmcnt(7)
    v_mfma_f32_32x32x16_bf16 v[48:63], v[44:47], v[220:223], v[48:63]
    ds_read_b64_tr_b16 v[44:45], v14 offset:55296
    ds_read_b64_tr_b16 v[46:47], v14 offset:55808
    s_waitcnt lgkmcnt(7)
    v_mfma_f32_32x32x16_bf16 v[48:63], v[32:35], v[224:227], v[48:63]
    ds_read_b64_tr_b16 v[32:33], v14 offset:57344
    ds_read_b64_tr_b16 v[34:35], v14 offset:57856
    v_cvt_pk_bf16_f32 v84, v88, v89
    v_cvt_pk_bf16_f32 v85, v90, v91
    v_cvt_pk_bf16_f32 v86, v92, v93
    v_cvt_pk_bf16_f32 v87, v94, v95
    v_pk_max_i16 v84, v84, 0
    s_waitcnt lgkmcnt(6)
    v_mfma_f32_32x32x16_bf16 v[48:63], v[36:39], v[228:231], v[48:63]
    ds_read_b64_tr_b16 v[36:37], v14 offset:59392
    ds_read_b64_tr_b16 v[38:39], v14 offset:59904
    v_pk_max_i16 v85, v85, 0
    v_pk_max_i16 v86, v86, 0
    v_pk_max_i16 v87, v87, 0
    v_or_b32 v84, s52, v84
    v_or_b32 v85, s53, v85
    s_waitcnt lgkmcnt(6)
    v_mfma_f32_32x32x16_bf16 v[48:63], v[40:43], v[232:235], v[48:63]
    ds_read_b64_tr_b16 v[40:41], v14 offset:61440
    ds_read_b64_tr_b16 v[42:43], v14 offset:61952
    v_or_b32 v86, s54, v86
    v_or_b32 v87, s55, v87
    buffer_store_dwordx4 v[84:87], v2, s[28:31], s45 offen offset:1024 sc1
    s_waitcnt lgkmcnt(6)
    v_mfma_f32_32x32x16_bf16 v[48:63], v[44:47], v[236:239], v[48:63]
    ds_read_b64_tr_b16 v[44:45], v14 offset:63488
    ds_read_b64_tr_b16 v[46:47], v14 offset:64000
    s_waitcnt lgkmcnt(6)
    v_mfma_f32_32x32x16_bf16 v[48:63], v[32:35], v[240:243], v[48:63]
    ds_read_b64_tr_b16 v[32:33], v21 offset:49152
    ds_read_b64_tr_b16 v[34:35], v21 offset:49664
    s_waitcnt lgkmcnt(6)
    v_mfma_f32_32x32x16_bf16 v[48:63], v[36:39], v[244:247], v[48:63]
    ds_read_b64_tr_b16 v[36:37], v21 offset:51200
    ds_read_b64_tr_b16 v[38:39], v21 offset:51712
    s_waitcnt lgkmcnt(6)
    v_mfma_f32_32x32x16_bf16 v[48:63], v[40:43], v[248:251], v[48:63]
    ds_read_b64_tr_b16 v[40:41], v21 offset:53248
    ds_read_b64_tr_b16 v[42:43], v21 offset:53760
    s_waitcnt lgkmcnt(6)
    v_mfma_f32_32x32x16_bf16 v[48:63], v[44:47], v[252:255], v[48:63]
    v_mfma_f32_32x32x8bf16_1k v[48:63], v[28:29], v[26:27], v[48:63]
    ds_read_b64_tr_b16 v[44:45], v21 offset:55296
    ds_read_b64_tr_b16 v[46:47], v21 offset:55808
    s_waitcnt lgkmcnt(6)
    v_mfma_f32_32x32x16_bf16 v[64:79], v[32:35], v[128:131], 0
    ds_read_b64_tr_b16 v[32:33], v15 offset:8192
    ds_read_b64_tr_b16 v[34:35], v15 offset:8704
    s_waitcnt lgkmcnt(6)
    v_mfma_f32_32x32x16_bf16 v[64:79], v[36:39], v[132:135], v[64:79]
    ds_read_b64_tr_b16 v[36:37], v15 offset:10240
    ds_read_b64_tr_b16 v[38:39], v15 offset:10752
    v_cvt_pk_bf16_f32 v96, v96, v97
    v_cvt_pk_bf16_f32 v97, v98, v99
    v_cvt_pk_bf16_f32 v98, v100, v101
    v_cvt_pk_bf16_f32 v99, v102, v103
    v_pk_max_i16 v96, v96, 0
    s_waitcnt lgkmcnt(6)
    v_mfma_f32_32x32x16_bf16 v[64:79], v[40:43], v[136:139], v[64:79]
    ds_read_b64_tr_b16 v[40:41], v15 offset:12288
    ds_read_b64_tr_b16 v[42:43], v15 offset:12800
    v_pk_max_i16 v97, v97, 0
    v_pk_max_i16 v98, v98, 0
    v_pk_max_i16 v99, v99, 0
    v_or_b32 v96, s52, v96
    v_or_b32 v97, s53, v97
    s_waitcnt lgkmcnt(6)
    v_mfma_f32_32x32x16_bf16 v[64:79], v[44:47], v[140:143], v[64:79]
    ds_read_b64_tr_b16 v[44:45], v15 offset:14336
    ds_read_b64_tr_b16 v[46:47], v15 offset:14848
    v_cvt_pk_bf16_f32 v48, v48, v49
    v_cvt_pk_bf16_f32 v49, v50, v51
    v_cvt_pk_bf16_f32 v50, v52, v53
    v_cvt_pk_bf16_f32 v51, v54, v55
    ds_write_b128 v3, v[48:51] offset:0
    s_waitcnt lgkmcnt(7)
    v_mfma_f32_32x32x16_bf16 v[64:79], v[32:35], v[144:147], v[64:79]
    ds_read_b64_tr_b16 v[32:33], v15 offset:16384
    ds_read_b64_tr_b16 v[34:35], v15 offset:16896
    v_cvt_pk_bf16_f32 v52, v56, v57
    v_cvt_pk_bf16_f32 v53, v58, v59
    v_cvt_pk_bf16_f32 v54, v60, v61
    v_cvt_pk_bf16_f32 v55, v62, v63
    ds_write_b128 v3, v[52:55] offset:1024
    s_waitcnt lgkmcnt(8)
    v_mfma_f32_32x32x16_bf16 v[64:79], v[36:39], v[148:151], v[64:79]
    ds_read_b64_tr_b16 v[36:37], v15 offset:18432
    ds_read_b64_tr_b16 v[38:39], v15 offset:18944
    v_mov_b32 v1, 1
    ds_write_b32 v5, v1
    v_or_b32 v98, s54, v98
    v_or_b32 v99, s55, v99
    buffer_store_dwordx4 v[96:99], v2, s[28:31], s46 offen offset:0 sc1
    s_waitcnt lgkmcnt(9)
    v_mfma_f32_32x32x16_bf16 v[64:79], v[40:43], v[152:155], v[64:79]
    ds_read_b64_tr_b16 v[40:41], v15 offset:20480
    ds_read_b64_tr_b16 v[42:43], v15 offset:20992
    s_waitcnt lgkmcnt(9)
    v_mfma_f32_32x32x16_bf16 v[64:79], v[44:47], v[156:159], v[64:79]
    ds_read_b64_tr_b16 v[44:45], v15 offset:22528
    ds_read_b64_tr_b16 v[46:47], v15 offset:23040
    s_waitcnt lgkmcnt(8)
    v_mfma_f32_32x32x16_bf16 v[64:79], v[32:35], v[160:163], v[64:79]
    ds_read_b64_tr_b16 v[32:33], v15 offset:24576
    ds_read_b64_tr_b16 v[34:35], v15 offset:25088
    s_waitcnt lgkmcnt(7)
    v_mfma_f32_32x32x16_bf16 v[64:79], v[36:39], v[164:167], v[64:79]
    ds_read_b64_tr_b16 v[36:37], v15 offset:26624
    ds_read_b64_tr_b16 v[38:39], v15 offset:27136
    s_waitcnt lgkmcnt(6)
    v_mfma_f32_32x32x16_bf16 v[64:79], v[40:43], v[168:171], v[64:79]
    ds_read_b64_tr_b16 v[40:41], v15 offset:28672
    ds_read_b64_tr_b16 v[42:43], v15 offset:29184
    v_cvt_pk_bf16_f32 v100, v104, v105
    v_cvt_pk_bf16_f32 v101, v106, v107
    v_cvt_pk_bf16_f32 v102, v108, v109
    v_cvt_pk_bf16_f32 v103, v110, v111
    v_pk_max_i16 v100, v100, 0
    s_waitcnt lgkmcnt(6)
    v_mfma_f32_32x32x16_bf16 v[64:79], v[44:47], v[172:175], v[64:79]
    ds_read_b64_tr_b16 v[44:45], v15 offset:30720
    ds_read_b64_tr_b16 v[46:47], v15 offset:31232
    v_pk_max_i16 v101, v101, 0
    v_pk_max_i16 v102, v102, 0
    v_pk_max_i16 v103, v103, 0
    v_or_b32 v100, s52, v100
    v_or_b32 v101, s53, v101
    s_waitcnt lgkmcnt(6)
    v_mfma_f32_32x32x16_bf16 v[64:79], v[32:35], v[176:179], v[64:79]
    ds_read_b64_tr_b16 v[32:33], v15 offset:32768
    ds_read_b64_tr_b16 v[34:35], v15 offset:33280
    v_or_b32 v102, s54, v102
    v_or_b32 v103, s55, v103
    buffer_store_dwordx4 v[100:103], v2, s[28:31], s46 offen offset:1024 sc1
    s_waitcnt lgkmcnt(6)
    v_mfma_f32_32x32x16_bf16 v[64:79], v[36:39], v[180:183], v[64:79]
    ds_read_b64_tr_b16 v[36:37], v15 offset:34816
    ds_read_b64_tr_b16 v[38:39], v15 offset:35328
    s_waitcnt lgkmcnt(6)
    v_mfma_f32_32x32x16_bf16 v[64:79], v[40:43], v[184:187], v[64:79]
    ds_read_b64_tr_b16 v[40:41], v15 offset:36864
    ds_read_b64_tr_b16 v[42:43], v15 offset:37376
    s_waitcnt lgkmcnt(6)
    v_mfma_f32_32x32x16_bf16 v[64:79], v[44:47], v[188:191], v[64:79]
    ds_read_b64_tr_b16 v[44:45], v15 offset:38912
    ds_read_b64_tr_b16 v[46:47], v15 offset:39424
    s_waitcnt lgkmcnt(6)
    v_mfma_f32_32x32x16_bf16 v[64:79], v[32:35], v[192:195], v[64:79]
    ds_read_b64_tr_b16 v[32:33], v15 offset:40960
    ds_read_b64_tr_b16 v[34:35], v15 offset:41472
    s_waitcnt lgkmcnt(6)
    v_mfma_f32_32x32x16_bf16 v[64:79], v[36:39], v[196:199], v[64:79]
    ds_read_b64_tr_b16 v[36:37], v15 offset:43008
    ds_read_b64_tr_b16 v[38:39], v15 offset:43520
    s_waitcnt lgkmcnt(6)
    v_mfma_f32_32x32x16_bf16 v[64:79], v[40:43], v[200:203], v[64:79]
    ds_read_b64_tr_b16 v[40:41], v15 offset:45056
    ds_read_b64_tr_b16 v[42:43], v15 offset:45568
    s_waitcnt lgkmcnt(6)
    v_mfma_f32_32x32x16_bf16 v[64:79], v[44:47], v[204:207], v[64:79]
    ds_read_b64_tr_b16 v[44:45], v15 offset:47104
    ds_read_b64_tr_b16 v[46:47], v15 offset:47616
    v_cvt_pk_bf16_f32 v112, v112, v113
    v_cvt_pk_bf16_f32 v113, v114, v115
    v_cvt_pk_bf16_f32 v114, v116, v117
    v_cvt_pk_bf16_f32 v115, v118, v119
    v_pk_max_i16 v112, v112, 0
    s_waitcnt lgkmcnt(6)
    v_mfma_f32_32x32x16_bf16 v[64:79], v[32:35], v[208:211], v[64:79]
    ds_read_b64_tr_b16 v[32:33], v15 offset:49152
    ds_read_b64_tr_b16 v[34:35], v15 offset:49664
    v_pk_max_i16 v113, v113, 0
    v_pk_max_i16 v114, v114, 0
    v_pk_max_i16 v115, v115, 0
    v_or_b32 v112, s52, v112
    v_or_b32 v113, s53, v113
    s_waitcnt lgkmcnt(6)
    v_mfma_f32_32x32x16_bf16 v[64:79], v[36:39], v[212:215], v[64:79]
    ds_read_b64_tr_b16 v[36:37], v15 offset:51200
    ds_read_b64_tr_b16 v[38:39], v15 offset:51712
    v_or_b32 v114, s54, v114
    v_or_b32 v115, s55, v115
    buffer_store_dwordx4 v[112:115], v2, s[28:31], s47 offen offset:0 sc1
    s_waitcnt lgkmcnt(6)
    v_mfma_f32_32x32x16_bf16 v[64:79], v[40:43], v[216:219], v[64:79]
    ds_read_b64_tr_b16 v[40:41], v15 offset:53248
    ds_read_b64_tr_b16 v[42:43], v15 offset:53760
    s_waitcnt lgkmcnt(6)
    v_mfma_f32_32x32x16_bf16 v[64:79], v[44:47], v[220:223], v[64:79]
    ds_read_b64_tr_b16 v[44:45], v15 offset:55296
    ds_read_b64_tr_b16 v[46:47], v15 offset:55808
    s_waitcnt lgkmcnt(6)
    v_mfma_f32_32x32x16_bf16 v[64:79], v[32:35], v[224:227], v[64:79]
    ds_read_b64_tr_b16 v[32:33], v15 offset:57344
    ds_read_b64_tr_b16 v[34:35], v15 offset:57856
    v_mov_b32 v16, 160256
    ds_read_b128 v[16:19], v16 offset:16
    s_waitcnt lgkmcnt(7)
    v_mfma_f32_32x32x16_bf16 v[64:79], v[36:39], v[228:231], v[64:79]
    ds_read_b64_tr_b16 v[36:37], v15 offset:59392
    ds_read_b64_tr_b16 v[38:39], v15 offset:59904
    s_waitcnt lgkmcnt(7)
    v_mfma_f32_32x32x16_bf16 v[64:79], v[40:43], v[232:235], v[64:79]
    ds_read_b64_tr_b16 v[40:41], v15 offset:61440
    ds_read_b64_tr_b16 v[42:43], v15 offset:61952
    s_waitcnt lgkmcnt(7)
    v_mfma_f32_32x32x16_bf16 v[64:79], v[44:47], v[236:239], v[64:79]
    ds_read_b64_tr_b16 v[44:45], v15 offset:63488
    ds_read_b64_tr_b16 v[46:47], v15 offset:64000
    s_waitcnt lgkmcnt(7)
    v_mfma_f32_32x32x16_bf16 v[64:79], v[32:35], v[240:243], v[64:79]
    ds_read_b64_tr_b16 v[32:33], v9 offset:0
    ds_read_b64_tr_b16 v[34:35], v9 offset:512
    v_cvt_pk_bf16_f32 v116, v120, v121
    v_cvt_pk_bf16_f32 v117, v122, v123
    v_cvt_pk_bf16_f32 v118, v124, v125
    v_cvt_pk_bf16_f32 v119, v126, v127
    v_pk_max_i16 v116, v116, 0
    s_lshl_b32 s72, s96, 3
    s_add_u32 s72, s72, s41
    s_mul_i32 s72, s72, 36864
    s_add_u32 s72, s72, 20971520
    v_add_u32 v7, s72, v2
    s_waitcnt lgkmcnt(6)
    v_mfma_f32_32x32x16_bf16 v[64:79], v[36:39], v[244:247], v[64:79]
    ds_read_b64_tr_b16 v[36:37], v9 offset:2048
    ds_read_b64_tr_b16 v[38:39], v9 offset:2560
    v_min_u32 v16, v16, v17
    v_min3_u32 v16, v16, v18, v19
    s_nop 0
    v_readfirstlane_b32 s72, v16
    s_nop 0
    s_cmp_ge_u32 s72, 1
    s_cbranch_scc1 L_lx_sg
    v_mov_b32 v12, 160256
    s_mov_b32 s67, 0
L_lw_sg:
    ds_read_b128 v[16:19], v12 offset:16
    s_add_u32 s67, s67, 1
    s_waitcnt lgkmcnt(0)
    v_min_u32 v16, v16, v17
    v_min3_u32 v16, v16, v18, v19
    s_nop 0
    v_readfirstlane_b32 s74, v16
    s_cmp_gt_u32 s67, 1600000
    s_cbranch_scc1 L_lx_sg
    s_cmp_lt_u32 s74, 1
    s_cbranch_scc1 L_lw_sg
L_lx_sg:
    v_pk_max_i16 v117, v117, 0
    v_pk_max_i16 v118, v118, 0
    v_pk_max_i16 v119, v119, 0
    v_or_b32 v116, s52, v116
    s_waitcnt lgkmcnt(6)
    v_mfma_f32_32x32x16_bf16 v[64:79], v[40:43], v[248:251], v[64:79]
    ds_read_b64_tr_b16 v[40:41], v9 offset:4096
    ds_read_b64_tr_b16 v[42:43], v9 offset:4608
    v_or_b32 v117, s53, v117
    v_or_b32 v118, s54, v118
    v_or_b32 v119, s55, v119
    buffer_store_dwordx4 v[116:119], v2, s[28:31], s47 offen offset:1024 sc1
    s_waitcnt vmcnt(8)
    v_cmp_ne_u32 vcc, s39, v24
    s_nop 0
    s_cmp_eq_u64 vcc, 0
    s_cbranch_scc1 L_pok_mb1
    s_mov_b32 s67, 0
L_poll_mb1:
    s_sleep 1
    buffer_load_dword v24, v22, s[28:31], s61 offen sc1
    s_waitcnt vmcnt(0)
    v_cmp_ne_u32 vcc, s39, v24
    s_nop 0
    s_cmp_eq_u64 vcc, 0
    s_cbranch_scc1 L_pok_mb1
    s_add_u32 s67, s67, 1
    s_cmp_gt_u32 s67, 200000
    s_cbranch_scc0 L_poll_mb1
L_pok_mb1:
    s_waitcnt lgkmcnt(6)
    v_mfma_f32_32x32x16_bf16 v[64:79], v[44:47], v[252:255], v[64:79]
    v_mfma_f32_32x32x8bf16_1k v[64:79], v[30:31], v[26:27], v[64:79]
    ds_read_b64_tr_b16 v[44:45], v9 offset:6144
    ds_read_b64_tr_b16 v[46:47], v9 offset:6656
    s_waitcnt lgkmcnt(6)
    v_mfma_f32_32x32x16_bf16 v[80:95], v[32:35], v[128:131], 0
    ds_read_b64_tr_b16 v[32:33], v25 offset:4096
    ds_read_b64_tr_b16 v[34:35], v25 offset:4352
    s_lshl_b32 s34, s8, 1
    s_waitcnt vmcnt(7)
    buffer_load_dwordx4 v[112:115], v7, s[28:31], s34 offen offset:0 sc1
    s_waitcnt lgkmcnt(6)
    v_mfma_f32_32x32x16_bf16 v[80:95], v[36:39], v[132:135], v[80:95]
    ds_read_b64_tr_b16 v[36:37], v25 offset:5120
    ds_read_b64_tr_b16 v[38:39], v25 offset:5376
    s_waitcnt vmcnt(7)
    buffer_load_dwordx4 v[116:119], v7, s[28:31], s34 offen offset:1024 sc1
    s_waitcnt lgkmcnt(6)
    v_mfma_f32_32x32x16_bf16 v[80:95], v[40:43], v[136:139], v[80:95]
    ds_read_b64_tr_b16 v[40:41], v25 offset:6144
    ds_read_b64_tr_b16 v[42:43], v25 offset:6400
    s_lshl_b32 s34, s9, 1
    s_waitcnt vmcnt(7)
    buffer_load_dwordx4 v[120:123], v7, s[28:31], s34 offen offset:0 sc1
    s_waitcnt lgkmcnt(6)
    v_mfma_f32_32x32x16_bf16 v[80:95], v[44:47], v[140:143], v[80:95]
    ds_read_b64_tr_b16 v[44:45], v25 offset:7168
    ds_read_b64_tr_b16 v[46:47], v25 offset:7424
    v_cvt_pk_bf16_f32 v64, v64, v65
    v_cvt_pk_bf16_f32 v65, v66, v67
    v_cvt_pk_bf16_f32 v66, v68, v69
    v_cvt_pk_bf16_f32 v67, v70, v71
    ds_write_b128 v3, v[64:67] offset:8192
    s_waitcnt vmcnt(7)
    buffer_load_dwordx4 v[124:127], v7, s[28:31], s34 offen offset:1024 sc1
    s_waitcnt lgkmcnt(7)
    v_mfma_f32_32x32x16_bf16 v[80:95], v[32:35], v[144:147], v[80:95]
    ds_read_b64_tr_b16 v[32:33], v25 offset:8192
    ds_read_b64_tr_b16 v[34:35], v25 offset:8448
    v_cvt_pk_bf16_f32 v68, v72, v73
    v_cvt_pk_bf16_f32 v69, v74, v75
    v_cvt_pk_bf16_f32 v70, v76, v77
    v_cvt_pk_bf16_f32 v71, v78, v79
    ds_write_b128 v3, v[68:71] offset:9216
    s_lshl_b32 s34, s10, 1
    s_waitcnt vmcnt(7)
    buffer_load_dwordx4 v[128:131], v7, s[28:31], s34 offen offset:0 sc1
    s_waitcnt lgkmcnt(8)
    v_mfma_f32_32x32x16_bf16 v[80:95], v[36:39], v[148:151], v[80:95]
    ds_read_b64_tr_b16 v[36:37], v25 offset:9216
    ds_read_b64_tr_b16 v[38:39], v25 offset:9472
    v_mov_b32 v1, 2
    ds_write_b32 v5, v1
    s_waitcnt vmcnt(7)
    buffer_load_dwordx4 v[132:135], v7, s[28:31], s34 offen offset:1024 sc1
    s_waitcnt lgkmcnt(9)
    v_mfma_f32_32x32x16_bf16 v[80:95], v[40:43], v[152:155], v[80:95]
    ds_read_b64_tr_b16 v[40:41], v25 offset:10240
    ds_read_b64_tr_b16 v[42:43], v25 offset:10496
    s_lshl_b32 s34, s11, 1
    s_waitcnt vmcnt(7)
    buffer_load_dwordx4 v[136:139], v7, s[28:31], s34 offen offset:0 sc1
    s_waitcnt lgkmcnt(9)
    v_mfma_f32_32x32x16_bf16 v[80:95], v[44:47], v[156:159], v[80:95]
    ds_read_b64_tr_b16 v[44:45], v25 offset:11264
    ds_read_b64_tr_b16 v[46:47], v25 offset:11520
    s_waitcnt vmcnt(7)
    buffer_load_dwordx4 v[140:143], v7, s[28:31], s34 offen offset:1024 sc1
    s_waitcnt lgkmcnt(8)
    v_mfma_f32_32x32x16_bf16 v[80:95], v[32:35], v[160:163], v[80:95]
    ds_read_b64_tr_b16 v[32:33], v25 offset:12288
    ds_read_b64_tr_b16 v[34:35], v25 offset:12544
    s_lshl_b32 s34, s12, 1
    s_waitcnt vmcnt(7)
    buffer_load_dwordx4 v[144:147], v7, s[28:31], s34 offen offset:0 sc1
    s_waitcnt lgkmcnt(7)
    v_mfma_f32_32x32x16_bf16 v[80:95], v[36:39], v[164:167], v[80:95]
    ds_read_b64_tr_b16 v[36:37], v25 offset:13312
    ds_read_b64_tr_b16 v[38:39], v25 offset:13568
    s_waitcnt vmcnt(7)
    buffer_load_dwordx4 v[148:151], v7, s[28:31], s34 offen offset:1024 sc1
    s_waitcnt lgkmcnt(6)
    v_mfma_f32_32x32x16_bf16 v[80:95], v[40:43], v[168:171], v[80:95]
    ds_read_b64_tr_b16 v[40:41], v25 offset:14336
    ds_read_b64_tr_b16 v[42:43], v25 offset:14592
    s_lshl_b32 s34, s13, 1
    s_waitcnt vmcnt(7)
    buffer_load_dwordx4 v[152:155], v7, s[28:31], s34 offen offset:0 sc1
    s_waitcnt lgkmcnt(6)
    v_mfma_f32_32x32x16_bf16 v[80:95], v[44:47], v[172:175], v[80:95]
    ds_read_b64_tr_b16 v[44:45], v25 offset:15360
    ds_read_b64_tr_b16 v[46:47], v25 offset:15616
    s_waitcnt vmcnt(7)
    buffer_load_dwordx4 v[156:159], v7, s[28:31], s34 offen offset:1024 sc1
    s_waitcnt lgkmcnt(6)
    v_mfma_f32_32x32x16_bf16 v[80:95], v[32:35], v[176:179], v[80:95]
    ds_read_b64_tr_b16 v[32:33], v25 offset:16384
    ds_read_b64_tr_b16 v[34:35], v25 offset:16640
    s_lshl_b32 s34, s14, 1
    s_waitcnt vmcnt(7)
    buffer_load_dwordx4 v[160:163], v7, s[28:31], s34 offen offset:0 sc1
    s_waitcnt lgkmcnt(6)
    v_mfma_f32_32x32x16_bf16 v[80:95], v[36:39], v[180:183], v[80:95]
    ds_read_b64_tr_b16 v[36:37], v25 offset:17408
    ds_read_b64_tr_b16 v[38:39], v25 offset:17664
    s_waitcnt vmcnt(7)
    buffer_load_dwordx4 v[164:167], v7, s[28:31], s34 offen offset:1024 sc1
    s_waitcnt lgkmcnt(6)
    v_mfma_f32_32x32x16_bf16 v[80:95], v[40:43], v[184:187], v[80:95]
    ds_read_b64_tr_b16 v[40:41], v25 offset:18432
    ds_read_b64_tr_b16 v[42:43], v25 offset:18688
    s_lshl_b32 s34, s15, 1
    s_waitcnt vmcnt(7)
    buffer_load_dwordx4 v[168:171], v7, s[28:31], s34 offen offset:0 sc1
    s_waitcnt lgkmcnt(6)
    v_mfma_f32_32x32x16_bf16 v[80:95], v[44:47], v[188:191], v[80:95]
    ds_read_b64_tr_b16 v[44:45], v25 offset:19456
    ds_read_b64_tr_b16 v[46:47], v25 offset:19712
    s_waitcnt vmcnt(7)
    buffer_load_dwordx4 v[172:175], v7, s[28:31], s34 offen offset:1024 sc1
    s_waitcnt lgkmcnt(6)
    v_mfma_f32_32x32x16_bf16 v[80:95], v[32:35], v[192:195], v[80:95]
    ds_read_b64_tr_b16 v[32:33], v25 offset:20480
    ds_read_b64_tr_b16 v[34:35], v25 offset:20736
    s_lshl_b32 s34, s16, 1
    s_waitcnt vmcnt(7)
    buffer_load_dwordx4 v[176:179], v7, s[28:31], s34 offen offset:0 sc1
    s_waitcnt lgkmcnt(6)
    v_mfma_f32_32x32x16_bf16 v[80:95], v[36:39], v[196:199], v[80:95]
    ds_read_b64_tr_b16 v[36:37], v25 offset:21504
    ds_read_b64_tr_b16 v[38:39], v25 offset:21760
    s_waitcnt vmcnt(7)
    buffer_load_dwordx4 v[180:183], v7, s[28:31], s34 offen offset:1024 sc1
    s_waitcnt lgkmcnt(6)
    v_mfma_f32_32x32x16_bf16 v[80:95], v[40:43], v[200:203], v[80:95]
    ds_read_b64_tr_b16 v[40:41], v25 offset:22528
    ds_read_b64_tr_b16 v[42:43], v25 offset:22784
    s_lshl_b32 s34, s17, 1
    s_waitcnt vmcnt(7)
    buffer_load_dwordx4 v[184:187], v7, s[28:31], s34 offen offset:0 sc1
    s_waitcnt lgkmcnt(6)
    v_mfma_f32_32x32x16_bf16 v[80:95], v[44:47], v[204:207], v[80:95]
    ds_read_b64_tr_b16 v[44:45], v25 offset:23552
    ds_read_b64_tr_b16 v[46:47], v25 offset:23808
    s_waitcnt vmcnt(7)
    buffer_load_dwordx4 v[188:191], v7, s[28:31], s34 offen offset:1024 sc1
    s_waitcnt lgkmcnt(6)
    v_mfma_f32_32x32x16_bf16 v[80:95], v[32:35], v[208:211], v[80:95]
    ds_read_b64_tr_b16 v[32:33], v25 offset:24576
    ds_read_b64_tr_b16 v[34:35], v25 offset:24832
    s_lshl_b32 s34, s18, 1
    s_waitcnt vmcnt(7)
    buffer_load_dwordx4 v[192:195], v7, s[28:31], s34 offen offset:0 sc1
    s_waitcnt lgkmcnt(6)
    v_mfma_f32_32x32x16_bf16 v[80:95], v[36:39], v[212:215], v[80:95]
    ds_read_b64_tr_b16 v[36:37], v25 offset:25600
    ds_read_b64_tr_b16 v[38:39], v25 offset:25856
    s_waitcnt vmcnt(7)
    buffer_load_dwordx4 v[196:199], v7, s[28:31], s34 offen offset:1024 sc1
    s_waitcnt lgkmcnt(6)
    v_mfma_f32_32x32x16_bf16 v[80:95], v[40:43], v[216:219], v[80:95]
    ds_read_b64_tr_b16 v[40:41], v25 offset:26624
    ds_read_b64_tr_b16 v[42:43], v25 offset:26880
    s_lshl_b32 s34, s19, 1
    s_waitcnt vmcnt(7)
    buffer_load_dwordx4 v[200:203], v7, s[28:31], s34 offen offset:0 sc1
    s_waitcnt lgkmcnt(6)
    v_mfma_f32_32x32x16_bf16 v[80:95], v[44:47], v[220:223], v[80:95]
    ds_read_b64_tr_b16 v[44:45], v25 offset:27648
    ds_read_b64_tr_b16 v[46:47], v25 offset:27904
    s_waitcnt vmcnt(7)
    buffer_load_dwordx4 v[204:207], v7, s[28:31], s34 offen offset:1024 sc1
    s_waitcnt lgkmcnt(6)
    v_mfma_f32_32x32x16_bf16 v[80:95], v[32:35], v[224:227], v[80:95]
    ds_read_b64_tr_b16 v[32:33], v25 offset:28672
    ds_read_b64_tr_b16 v[34:35], v25 offset:28928
    s_lshl_b32 s34, s20, 1
    s_waitcnt vmcnt(7)
    buffer_load_dwordx4 v[208:211], v7, s[28:31], s34 offen offset:0 sc1
    s_waitcnt lgkmcnt(6)
    v_mfma_f32_32x32x16_bf16 v[80:95], v[36:39], v[228:231], v[80:95]
    ds_read_b64_tr_b16 v[36:37], v25 offset:29696
    ds_read_b64_tr_b16 v[38:39], v25 offset:29952
    s_waitcnt vmcnt(7)
    buffer_load_dwordx4 v[212:215], v7, s[28:31], s34 offen offset:1024 sc1
    s_waitcnt lgkmcnt(6)
    v_mfma_f32_32x32x16_bf16 v[80:95], v[40:43], v[232:235], v[80:95]
    ds_read_b64_tr_b16 v[40:41], v25 offset:30720
    ds_read_b64_tr_b16 v[42:43], v25 offset:30976
    s_lshl_b32 s34, s21, 1
    s_waitcnt vmcnt(7)
    buffer_load_dwordx4 v[216:219], v7, s[28:31], s34 offen offset:0 sc1
    s_waitcnt lgkmcnt(6)
    v_mfma_f32_32x32x16_bf16 v[80:95], v[44:47], v[236:239], v[80:95]
    ds_read_b64_tr_b16 v[44:45], v25 offset:31744
    ds_read_b64_tr_b16 v[46:47], v25 offset:32000
    s_waitcnt vmcnt(7)
    buffer_load_dwordx4 v[220:223], v7, s[28:31], s34 offen offset:1024 sc1
    s_waitcnt lgkmcnt(6)
    v_mfma_f32_32x32x16_bf16 v[80:95], v[32:35], v[240:243], v[80:95]
    s_lshl_b32 s34, s22, 1
    s_waitcnt vmcnt(7)
    buffer_load_dwordx4 v[224:227], v7, s[28:31], s34 offen offset:0 sc1
    s_waitcnt lgkmcnt(4)
    v_mfma_f32_32x32x16_bf16 v[80:95], v[36:39], v[244:247], v[80:95]
    s_waitcnt vmcnt(7)
    buffer_load_dwordx4 v[228:231], v7, s[28:31], s34 offen offset:1024 sc1
    s_waitcnt lgkmcnt(2)
    v_mfma_f32_32x32x16_bf16 v[80:95], v[40:43], v[248:251], v[80:95]
    s_lshl_b32 s34, s23, 1
    s_waitcnt vmcnt(7)
    buffer_load_dwordx4 v[232:235], v7, s[28:31], s34 offen offset:0 sc1
    s_waitcnt lgkmcnt(0)
    v_mfma_f32_32x32x16_bf16 v[80:95], v[44:47], v[252:255], v[80:95]
    v_mfma_f32_32x32x8bf16_1k v[80:95], v[10:11], v[26:27], v[80:95]
    s_waitcnt vmcnt(7)
    buffer_load_dwordx4 v[236:239], v7, s[28:31], s34 offen offset:1024 sc1
    s_nop 9
    v_cvt_pk_bf16_f32 v80, v80, v81
    v_cvt_pk_bf16_f32 v81, v82, v83
    v_cvt_pk_bf16_f32 v82, v84, v85
    v_cvt_pk_bf16_f32 v83, v86, v87
    v_pk_max_i16 v80, v80, 0
    v_pk_max_i16 v81, v81, 0
    v_pk_max_i16 v82, v82, 0
    v_pk_max_i16 v83, v83, 0
    v_or_b32 v80, s52, v80
    v_or_b32 v81, s53, v81
    v_or_b32 v82, s54, v82
    v_or_b32 v83, s55, v83
    buffer_store_dwordx4 v[80:83], v2, s[28:31], s48 offen offset:0 sc1
    v_cvt_pk_bf16_f32 v84, v88, v89
    v_cvt_pk_bf16_f32 v85, v90, v91
    v_cvt_pk_bf16_f32 v86, v92, v93
    v_cvt_pk_bf16_f32 v87, v94, v95
    v_pk_max_i16 v84, v84, 0
    v_pk_max_i16 v85, v85, 0
    v_pk_max_i16 v86, v86, 0
    v_pk_max_i16 v87, v87, 0
    v_or_b32 v84, s52, v84
    v_or_b32 v85, s53, v85
    v_or_b32 v86, s54, v86
    v_or_b32 v87, s55, v87
    buffer_store_dwordx4 v[84:87], v2, s[28:31], s48 offen offset:1024 sc1
    v_mov_b32 v5, 160304
    v_mov_b32 v1, 1
    s_mov_b64 exec, 1
    ds_add_u32 v5, v1
    s_mov_b64 exec, -1
    s_lshl_b32 s34, s32, 1
    s_waitcnt vmcnt(7)
    buffer_load_dwordx4 v[240:243], v7, s[28:31], s34 offen offset:0 sc1
    s_waitcnt vmcnt(7)
    buffer_load_dwordx4 v[244:247], v7, s[28:31], s34 offen offset:1024 sc1
    s_lshl_b32 s34, s33, 1
    s_waitcnt vmcnt(7)
    buffer_load_dwordx4 v[248:251], v7, s[28:31], s34 offen offset:0 sc1
    s_waitcnt vmcnt(7)
    buffer_load_dwordx4 v[252:255], v7, s[28:31], s34 offen offset:1024 sc1
L_p2:
    s_lshl_b32 s72, s40, 4
    s_add_u32 s72, s72, s96
    s_mul_i32 s72, s72, 18432
    v_lshlrev_b32 v4, 4, v0
    v_add_u32 v2, s72, v4
    v_add_u32 v1, 147456, v2
    s_mov_b32 s66, 0
    buffer_load_dwordx4 v[8:11], v2, s[28:31], s8 offen sc1
    buffer_load_dwordx4 v[12:15], v1, s[28:31], s8 offen sc1
    buffer_load_dwordx4 v[16:19], v2, s[28:31], s9 offen sc1
    buffer_load_dwordx4 v[20:23], v1, s[28:31], s9 offen sc1
    buffer_load_dwordx4 v[24:27], v2, s[28:31], s10 offen sc1
    buffer_load_dwordx4 v[28:31], v1, s[28:31], s10 offen sc1
    buffer_load_dwordx4 v[32:35], v2, s[28:31], s11 offen sc1
    buffer_load_dwordx4 v[36:39], v1, s[28:31], s11 offen sc1
    buffer_load_dwordx4 v[40:43], v2, s[28:31], s12 offen sc1
    buffer_load_dwordx4 v[44:47], v1, s[28:31], s12 offen sc1
L_mw0:
    s_waitcnt vmcnt(8)
L_mv0:
    v_xor_b32 v8, s52, v8
    v_xor_b32 v9, s53, v9
    v_xor_b32 v10, s54, v10
    v_xor_b32 v11, s55, v11
    v_xor_b32 v12, s52, v12
    v_xor_b32 v13, s53, v13
    v_xor_b32 v14, s54, v14
    v_xor_b32 v15, s55, v15
    v_or3_b32 v5, v8, v9, v10
    v_or3_b32 v6, v11, v12, v13
    v_or3_b32 v5, v5, v14, v15
    v_or_b32 v5, v5, v6
    v_and_b32 v5, 0x80008000, v5
    v_cmp_ne_u32 vcc, 0, v5
    s_cbranch_vccnz L_mrt0
L_mgo0:
    v_mfma_f32_32x32x16_bf16 v[48:63], v[112:115], v[8:11], 0
    v_mfma_f32_32x32x16_bf16 v[64:79], v[112:115], v[12:15], 0
    v_mfma_f32_32x32x16_bf16 v[80:95], v[116:119], v[8:11], 0
    v_mfma_f32_32x32x16_bf16 v[96:111], v[116:119], v[12:15], 0
    buffer_load_dwordx4 v[8:11], v2, s[28:31], s13 offen sc1
    buffer_load_dwordx4 v[12:15], v1, s[28:31], s13 offen sc1
L_mw1:
    s_waitcnt vmcnt(8)
L_mv1:
    v_xor_b32 v16, s52, v16
    v_xor_b32 v17, s53, v17
    v_xor_b32 v18, s54, v18
    v_xor_b32 v19, s55, v19
    v_xor_b32 v20, s52, v20
    v_xor_b32 v21, s53, v21
    v_xor_b32 v22, s54, v22
    v_xor_b32 v23, s55, v23
    v_or3_b32 v5, v16, v17, v18
    v_or3_b32 v6, v19, v20, v21
    v_or3_b32 v5, v5, v22, v23
    v_or_b32 v5, v5, v6
    v_and_b32 v5, 0x80008000, v5
    v_cmp_ne_u32 vcc, 0, v5
    s_cbranch_vccnz L_mrt1
L_mgo1:
    v_mfma_f32_32x32x16_bf16 v[48:63], v[120:123], v[16:19], v[48:63]
    v_mfma_f32_32x32x16_bf16 v[64:79], v[120:123], v[20:23], v[64:79]
    v_mfma_f32_32x32x16_bf16 v[80:95], v[124:127], v[16:19], v[80:95]
    v_mfma_f32_32x32x16_bf16 v[96:111], v[124:127], v[20:23], v[96:111]
    buffer_load_dwordx4 v[16:19], v2, s[28:31], s14 offen sc1
    buffer_load_dwordx4 v[20:23], v1, s[28:31], s14 offen sc1
    s_lshl_b32 s72, s38, 4
    v_lshrrev_b32 v117, 3, v0
    v_add_u32 v117, s72, v117
    v_and_b32 v118, 7, v0
    v_lshlrev_b32 v119, 10, v117
    v_lshl_add_u32 v119, v118, 4, v119
    v_lshlrev_b32 v121, 4, v117
    s_lshl_b32 s64, s40, 16
    s_lshl_b32 s72, s41, 7
    s_add_u32 s64, s64, s72
    s_add_u32 s63, s64, 8192
    s_lshl_b32 s65, s40, 10
    s_add_u32 s65, s65, 18087944
    v_mov_b32 v7, 160304
    v_and_b32 v3, 31, v0
    v_lshlrev_b32 v3, 7, v3
    s_lshr_b32 s61, s40, 1
    s_lshl_b32 s61, s61, 12
    s_add_u32 s61, s61, 19202048
    s_lshl_b32 s62, s96, 2
    s_lshl_b32 s62, 15, s62
L_mw2:
    s_waitcnt vmcnt(8)
L_mv2:
    v_xor_b32 v24, s52, v24
    v_xor_b32 v25, s53, v25
    v_xor_b32 v26, s54, v26
    v_xor_b32 v27, s55, v27
    v_xor_b32 v28, s52, v28
    v_xor_b32 v29, s53, v29
    v_xor_b32 v30, s54, v30
    v_xor_b32 v31, s55, v31
    v_or3_b32 v5, v24, v25, v26
    v_or3_b32 v6, v27, v28, v29
    v_or3_b32 v5, v5, v30, v31
    v_or_b32 v5, v5, v6
    v_and_b32 v5, 0x80008000, v5
    v_cmp_ne_u32 vcc, 0, v5
    s_cbranch_vccnz L_mrt2
L_mgo2:
    v_mfma_f32_32x32x16_bf16 v[48:63], v[128:131], v[24:27], v[48:63]
    v_mfma_f32_32x32x16_bf16 v[64:79], v[128:131], v[28:31], v[64:79]
    v_mfma_f32_32x32x16_bf16 v[80:95], v[132:135], v[24:27], v[80:95]
    v_mfma_f32_32x32x16_bf16 v[96:111], v[132:135], v[28:31], v[96:111]
    buffer_load_dwordx4 v[24:27], v2, s[28:31], s15 offen sc1
    buffer_load_dwordx4 v[28:31], v1, s[28:31], s15 offen sc1
L_mw3:
    s_waitcnt vmcnt(8)
L_mv3:
    v_xor_b32 v32, s52, v32
    v_xor_b32 v33, s53, v33
    v_xor_b32 v34, s54, v34
    v_xor_b32 v35, s55, v35
    v_xor_b32 v36, s52, v36
    v_xor_b32 v37, s53, v37
    v_xor_b32 v38, s54, v38
    v_xor_b32 v39, s55, v39
    v_or3_b32 v5, v32, v33, v34
    v_or3_b32 v6, v35, v36, v37
    v_or3_b32 v5, v5, v38, v39
    v_or_b32 v5, v5, v6
    v_and_b32 v5, 0x80008000, v5
    v_cmp_ne_u32 vcc, 0, v5
    s_cbranch_vccnz L_mrt3
L_mgo3:
    v_mfma_f32_32x32x16_bf16 v[48:63], v[136:139], v[32:35], v[48:63]
    v_mfma_f32_32x32x16_bf16 v[64:79], v[136:139], v[36:39], v[64:79]
    v_mfma_f32_32x32x16_bf16 v[80:95], v[140:143], v[32:35], v[80:95]
    v_mfma_f32_32x32x16_bf16 v[96:111], v[140:143], v[36:39], v[96:111]
    buffer_load_dwordx4 v[32:35], v2, s[28:31], s16 offen sc1
    buffer_load_dwordx4 v[36:39], v1, s[28:31], s16 offen sc1
L_mw4:
    s_waitcnt vmcnt(8)
L_mv4:
    v_xor_b32 v40, s52, v40
    v_xor_b32 v41, s53, v41
    v_xor_b32 v42, s54, v42
    v_xor_b32 v43, s55, v43
    v_xor_b32 v44, s52, v44
    v_xor_b32 v45, s53, v45
    v_xor_b32 v46, s54, v46
    v_xor_b32 v47, s55, v47
    v_or3_b32 v5, v40, v41, v42
    v_or3_b32 v6, v43, v44, v45
    v_or3_b32 v5, v5, v46, v47
    v_or_b32 v5, v5, v6
    v_and_b32 v5, 0x80008000, v5
    v_cmp_ne_u32 vcc, 0, v5
    s_cbranch_vccnz L_mrt4
L_mgo4:
    v_mfma_f32_32x32x16_bf16 v[48:63], v[144:147], v[40:43], v[48:63]
    v_mfma_f32_32x32x16_bf16 v[64:79], v[144:147], v[44:47], v[64:79]
    v_mfma_f32_32x32x16_bf16 v[80:95], v[148:151], v[40:43], v[80:95]
    v_mfma_f32_32x32x16_bf16 v[96:111], v[148:151], v[44:47], v[96:111]
    buffer_load_dwordx4 v[40:43], v2, s[28:31], s17 offen sc1
    buffer_load_dwordx4 v[44:47], v1, s[28:31], s17 offen sc1
L_mw5:
    s_waitcnt vmcnt(8)
L_mv5:
    v_xor_b32 v8, s52, v8
    v_xor_b32 v9, s53, v9
    v_xor_b32 v10, s54, v10
    v_xor_b32 v11, s55, v11
    v_xor_b32 v12, s52, v12
    v_xor_b32 v13, s53, v13
    v_xor_b32 v14, s54, v14
    v_xor_b32 v15, s55, v15
    v_or3_b32 v5, v8, v9, v10
    v_or3_b32 v6, v11, v12, v13
    v_or3_b32 v5, v5, v14, v15
    v_or_b32 v5, v5, v6
    v_and_b32 v5, 0x80008000, v5
    v_cmp_ne_u32 vcc, 0, v5
    s_cbranch_vccnz L_mrt5
L_mgo5:
    v_mfma_f32_32x32x16_bf16 v[48:63], v[152:155], v[8:11], v[48:63]
    v_mfma_f32_32x32x16_bf16 v[64:79], v[152:155], v[12:15], v[64:79]
    v_mfma_f32_32x32x16_bf16 v[80:95], v[156:159], v[8:11], v[80:95]
    v_mfma_f32_32x32x16_bf16 v[96:111], v[156:159], v[12:15], v[96:111]
    buffer_load_dwordx4 v[8:11], v2, s[28:31], s18 offen sc1
    buffer_load_dwordx4 v[12:15], v1, s[28:31], s18 offen sc1
L_mw6:
    s_waitcnt vmcnt(8)
L_mv6:
    v_xor_b32 v16, s52, v16
    v_xor_b32 v17, s53, v17
    v_xor_b32 v18, s54, v18
    v_xor_b32 v19, s55, v19
    v_xor_b32 v20, s52, v20
    v_xor_b32 v21, s53, v21
    v_xor_b32 v22, s54, v22
    v_xor_b32 v23, s55, v23
    v_or3_b32 v5, v16, v17, v18
    v_or3_b32 v6, v19, v20, v21
    v_or3_b32 v5, v5, v22, v23
    v_or_b32 v5, v5, v6
    v_and_b32 v5, 0x80008000, v5
    v_cmp_ne_u32 vcc, 0, v5
    s_cbranch_vccnz L_mrt6
L_mgo6:
    v_mfma_f32_32x32x16_bf16 v[48:63], v[160:163], v[16:19], v[48:63]
    v_mfma_f32_32x32x16_bf16 v[64:79], v[160:163], v[20:23], v[64:79]
    v_mfma_f32_32x32x16_bf16 v[80:95], v[164:167], v[16:19], v[80:95]
    v_mfma_f32_32x32x16_bf16 v[96:111], v[164:167], v[20:23], v[96:111]
    buffer_load_dwordx4 v[16:19], v2, s[28:31], s19 offen sc1
    buffer_load_dwordx4 v[20:23], v1, s[28:31], s19 offen sc1
L_mw7:
    s_waitcnt vmcnt(8)
L_mv7:
    v_xor_b32 v24, s52, v24
    v_xor_b32 v25, s53, v25
    v_xor_b32 v26, s54, v26
    v_xor_b32 v27, s55, v27
    v_xor_b32 v28, s52, v28
    v_xor_b32 v29, s53, v29
    v_xor_b32 v30, s54, v30
    v_xor_b32 v31, s55, v31
    v_or3_b32 v5, v24, v25, v26
    v_or3_b32 v6, v27, v28, v29
    v_or3_b32 v5, v5, v30, v31
    v_or_b32 v5, v5, v6
    v_and_b32 v5, 0x80008000, v5
    v_cmp_ne_u32 vcc, 0, v5
    s_cbranch_vccnz L_mrt7
L_mgo7:
    v_mfma_f32_32x32x16_bf16 v[48:63], v[168:171], v[24:27], v[48:63]
    v_mfma_f32_32x32x16_bf16 v[64:79], v[168:171], v[28:31], v[64:79]
    v_mfma_f32_32x32x16_bf16 v[80:95], v[172:175], v[24:27], v[80:95]
    v_mfma_f32_32x32x16_bf16 v[96:111], v[172:175], v[28:31], v[96:111]
    buffer_load_dwordx4 v[24:27], v2, s[28:31], s20 offen sc1
    buffer_load_dwordx4 v[28:31], v1, s[28:31], s20 offen sc1
L_mw8:
    s_waitcnt vmcnt(8)
L_mv8:
    v_xor_b32 v32, s52, v32
    v_xor_b32 v33, s53, v33
    v_xor_b32 v34, s54, v34
    v_xor_b32 v35, s55, v35
    v_xor_b32 v36, s52, v36
    v_xor_b32 v37, s53, v37
    v_xor_b32 v38, s54, v38
    v_xor_b32 v39, s55, v39
    v_or3_b32 v5, v32, v33, v34
    v_or3_b32 v6, v35, v36, v37
    v_or3_b32 v5, v5, v38, v39
    v_or_b32 v5, v5, v6
    v_and_b32 v5, 0x80008000, v5
    v_cmp_ne_u32 vcc, 0, v5
    s_cbranch_vccnz L_mrt8
L_mgo8:
    v_mfma_f32_32x32x16_bf16 v[48:63], v[176:179], v[32:35], v[48:63]
    v_mfma_f32_32x32x16_bf16 v[64:79], v[176:179], v[36:39], v[64:79]
    v_mfma_f32_32x32x16_bf16 v[80:95], v[180:183], v[32:35], v[80:95]
    v_mfma_f32_32x32x16_bf16 v[96:111], v[180:183], v[36:39], v[96:111]
    buffer_load_dwordx4 v[32:35], v2, s[28:31], s21 offen sc1
    buffer_load_dwordx4 v[36:39], v1, s[28:31], s21 offen sc1
L_mw9:
    s_waitcnt vmcnt(8)
L_mv9:
    v_xor_b32 v40, s52, v40
    v_xor_b32 v41, s53, v41
    v_xor_b32 v42, s54, v42
    v_xor_b32 v43, s55, v43
    v_xor_b32 v44, s52, v44
    v_xor_b32 v45, s53, v45
    v_xor_b32 v46, s54, v46
    v_xor_b32 v47, s55, v47
    v_or3_b32 v5, v40, v41, v42
    v_or3_b32 v6, v43, v44, v45
    v_or3_b32 v5, v5, v46, v47
    v_or_b32 v5, v5, v6
    v_and_b32 v5, 0x80008000, v5
    v_cmp_ne_u32 vcc, 0, v5
    s_cbranch_vccnz L_mrt9
L_mgo9:
    v_mfma_f32_32x32x16_bf16 v[48:63], v[184:187], v[40:43], v[48:63]
    v_mfma_f32_32x32x16_bf16 v[64:79], v[184:187], v[44:47], v[64:79]
    v_mfma_f32_32x32x16_bf16 v[80:95], v[188:191], v[40:43], v[80:95]
    v_mfma_f32_32x32x16_bf16 v[96:111], v[188:191], v[44:47], v[96:111]
L_mw10:
    s_waitcnt vmcnt(6)
L_mv10:
    v_xor_b32 v8, s52, v8
    v_xor_b32 v9, s53, v9
    v_xor_b32 v10, s54, v10
    v_xor_b32 v11, s55, v11
    v_xor_b32 v12, s52, v12
    v_xor_b32 v13, s53, v13
    v_xor_b32 v14, s54, v14
    v_xor_b32 v15, s55, v15
    v_or3_b32 v5, v8, v9, v10
    v_or3_b32 v6, v11, v12, v13
    v_or3_b32 v5, v5, v14, v15
    v_or_b32 v5, v5, v6
    v_and_b32 v5, 0x80008000, v5
    v_cmp_ne_u32 vcc, 0, v5
    s_cbranch_vccnz L_mrt10
L_mgo10:
    v_mfma_f32_32x32x16_bf16 v[48:63], v[192:195], v[8:11], v[48:63]
    v_mfma_f32_32x32x16_bf16 v[64:79], v[192:195], v[12:15], v[64:79]
    v_mfma_f32_32x32x16_bf16 v[80:95], v[196:199], v[8:11], v[80:95]
    v_mfma_f32_32x32x16_bf16 v[96:111], v[196:199], v[12:15], v[96:111]
L_mw11:
    s_waitcnt vmcnt(4)
L_mv11:
    v_xor_b32 v16, s52, v16
    v_xor_b32 v17, s53, v17
    v_xor_b32 v18, s54, v18
    v_xor_b32 v19, s55, v19
    v_xor_b32 v20, s52, v20
    v_xor_b32 v21, s53, v21
    v_xor_b32 v22, s54, v22
    v_xor_b32 v23, s55, v23
    v_or3_b32 v5, v16, v17, v18
    v_or3_b32 v6, v19, v20, v21
    v_or3_b32 v5, v5, v22, v23
    v_or_b32 v5, v5, v6
    v_and_b32 v5, 0x80008000, v5
    v_cmp_ne_u32 vcc, 0, v5
    s_cbranch_vccnz L_mrt11
L_mgo11:
    v_mfma_f32_32x32x16_bf16 v[48:63], v[200:203], v[16:19], v[48:63]
    v_mfma_f32_32x32x16_bf16 v[64:79], v[200:203], v[20:23], v[64:79]
    v_mfma_f32_32x32x16_bf16 v[80:95], v[204:207], v[16:19], v[80:95]
    v_mfma_f32_32x32x16_bf16 v[96:111], v[204:207], v[20:23], v[96:111]
    s_mov_b32 exec_lo, s62
    s_mov_b32 exec_hi, 0
    buffer_load_dword v122, v3, s[28:31], s61 offen sc1
    s_mov_b64 exec, -1
L_mw12:
    s_waitcnt vmcnt(3)
L_mv12:
    v_xor_b32 v24, s52, v24
    v_xor_b32 v25, s53, v25
    v_xor_b32 v26, s54, v26
    v_xor_b32 v27, s55, v27
    v_xor_b32 v28, s52, v28
    v_xor_b32 v29, s53, v29
    v_xor_b32 v30, s54, v30
    v_xor_b32 v31, s55, v31
    v_or3_b32 v5, v24, v25, v26
    v_or3_b32 v6, v27, v28, v29
    v_or3_b32 v5, v5, v30, v31
    v_or_b32 v5, v5, v6
    v_and_b32 v5, 0x80008000, v5
    v_cmp_ne_u32 vcc, 0, v5
    s_cbranch_vccnz L_mrt12
L_mgo12:
    v_mfma_f32_32x32x16_bf16 v[48:63], v[208:211], v[24:27], v[48:63]
    v_mfma_f32_32x32x16_bf16 v[64:79], v[208:211], v[28:31], v[64:79]
    v_mfma_f32_32x32x16_bf16 v[80:95], v[212:215], v[24:27], v[80:95]
    v_mfma_f32_32x32x16_bf16 v[96:111], v[212:215], v[28:31], v[96:111]
    buffer_load_dwordx4 v[112:115], v119, s[4:7], s64 offen
    buffer_load_dword v116, v121, s[28:31], s65 offen sc1
    buffer_load_dwordx4 v[160:163], v119, s[4:7], s63 offen
    buffer_load_dword v164, v121, s[28:31], s65 offen offset:128 sc1
L_mw13:
    s_waitcnt vmcnt(5)
L_mv13:
    v_xor_b32 v32, s52, v32
    v_xor_b32 v33, s53, v33
    v_xor_b32 v34, s54, v34
    v_xor_b32 v35, s55, v35
    v_xor_b32 v36, s52, v36
    v_xor_b32 v37, s53, v37
    v_xor_b32 v38, s54, v38
    v_xor_b32 v39, s55, v39
    v_or3_b32 v5, v32, v33, v34
    v_or3_b32 v6, v35, v36, v37
    v_or3_b32 v5, v5, v38, v39
    v_or_b32 v5, v5, v6
    v_and_b32 v5, 0x80008000, v5
    v_cmp_ne_u32 vcc, 0, v5
    s_cbranch_vccnz L_mrt13
L_mgo13:
    v_mfma_f32_32x32x16_bf16 v[48:63], v[216:219], v[32:35], v[48:63]
    v_mfma_f32_32x32x16_bf16 v[64:79], v[216:219], v[36:39], v[64:79]
    v_mfma_f32_32x32x16_bf16 v[80:95], v[220:223], v[32:35], v[80:95]
    v_mfma_f32_32x32x16_bf16 v[96:111], v[220:223], v[36:39], v[96:111]
    s_waitcnt vmcnt(4)
    v_cmp_eq_u32 vcc, s39, v122
    s_nop 1
    s_and_b32 s72, vcc_lo, s62
    s_cmp_eq_u32 s72, s62
    s_cbranch_scc1 L_mook
    s_mov_b32 s67, 0
L_mopoll:
    s_sleep 4
    s_mov_b32 exec_lo, s62
    s_mov_b32 exec_hi, 0
    buffer_load_dword v122, v3, s[28:31], s61 offen sc1
    s_mov_b64 exec, -1
    s_add_u32 s67, s67, 1
    s_cmp_gt_u32 s67, 200000
    s_cbranch_scc1 L_mook
    s_waitcnt vmcnt(0)
    v_cmp_eq_u32 vcc, s39, v122
    s_nop 1
    s_and_b32 s72, vcc_lo, s62
    s_cmp_eq_u32 s72, s62
    s_cbranch_scc0 L_mopoll
L_mook:
    buffer_load_dwordx4 v[40:43], v2, s[28:31], s22 offen sc1
    buffer_load_dwordx4 v[44:47], v1, s[28:31], s22 offen sc1
    buffer_load_dwordx4 v[8:11], v2, s[28:31], s23 offen sc1
    buffer_load_dwordx4 v[12:15], v1, s[28:31], s23 offen sc1
    buffer_load_dwordx4 v[16:19], v2, s[28:31], s32 offen sc1
    buffer_load_dwordx4 v[20:23], v1, s[28:31], s32 offen sc1
    buffer_load_dwordx4 v[24:27], v2, s[28:31], s33 offen sc1
    buffer_load_dwordx4 v[28:31], v1, s[28:31], s33 offen sc1
    ds_read_b32 v3, v7
    v_and_b32 v4, 31, v0
    v_mul_u32_u24 v4, 272, v4
    v_lshrrev_b32 v120, 5, v0
    v_lshl_add_u32 v4, v120, 4, v4
    s_mul_i32 s72, s38, 17408
    v_add_u32 v4, s72, v4
    s_waitcnt vmcnt(8)
    v_lshlrev_b32 v144, 16, v112
    v_and_b32 v145, 0xffff0000, v112
    v_lshlrev_b32 v146, 16, v113
    v_and_b32 v147, 0xffff0000, v113
    v_lshlrev_b32 v148, 16, v114
    v_and_b32 v149, 0xffff0000, v114
    v_lshlrev_b32 v150, 16, v115
    v_and_b32 v151, 0xffff0000, v115
    v_lshlrev_b32 v152, 16, v160
    v_and_b32 v153, 0xffff0000, v160
    v_lshlrev_b32 v154, 16, v161
    v_and_b32 v155, 0xffff0000, v161
    v_lshlrev_b32 v156, 16, v162
    v_and_b32 v157, 0xffff0000, v162
    v_lshlrev_b32 v158, 16, v163
    v_and_b32 v159, 0xffff0000, v163
    v_mul_u32_u24 v5, 272, v117
    v_lshl_add_u32 v5, v118, 5, v5
    v_add_u32 v6, 69632, v5
    s_waitcnt lgkmcnt(0)
    v_readfirstlane_b32 s72, v3
    s_nop 0
    s_cmp_ge_u32 s72, 8
    s_cbranch_scc1 L_lx_p1m
    s_mov_b32 s67, 0
L_lw_p1m:
    ds_read_b32 v3, v7 offset:0
    s_add_u32 s67, s67, 1
    s_waitcnt lgkmcnt(0)
    v_readfirstlane_b32 s74, v3
    s_cmp_gt_u32 s67, 1600000
    s_cbranch_scc1 L_lx_p1m
    s_cmp_lt_u32 s74, 8
    s_cbranch_scc1 L_lw_p1m
L_lx_p1m:
L_mw14:
    s_waitcnt vmcnt(6)
L_mv14:
L_mgo14:
    v_mfma_f32_32x32x16_bf16 v[48:63], v[224:227], v[40:43], v[48:63]
    v_mfma_f32_32x32x16_bf16 v[64:79], v[224:227], v[44:47], v[64:79]
    v_mfma_f32_32x32x16_bf16 v[80:95], v[228:231], v[40:43], v[80:95]
    v_mfma_f32_32x32x16_bf16 v[96:111], v[228:231], v[44:47], v[96:111]
L_mw15:
    s_waitcnt vmcnt(4)
L_mv15:
L_mgo15:
    v_mfma_f32_32x32x16_bf16 v[48:63], v[232:235], v[8:11], v[48:63]
    v_mfma_f32_32x32x16_bf16 v[64:79], v[232:235], v[12:15], v[64:79]
    v_mfma_f32_32x32x16_bf16 v[80:95], v[236:239], v[8:11], v[80:95]
    v_mfma_f32_32x32x16_bf16 v[96:111], v[236:239], v[12:15], v[96:111]
    s_waitcnt vmcnt(2)
    v_mfma_f32_32x32x16_bf16 v[48:63], v[240:243], v[16:19], v[48:63]
    v_mfma_f32_32x32x16_bf16 v[64:79], v[240:243], v[20:23], v[64:79]
    s_waitcnt vmcnt(0)
    v_mfma_f32_32x32x16_bf16 v[48:63], v[248:251], v[24:27], v[48:63]
    v_mfma_f32_32x32x16_bf16 v[64:79], v[248:251], v[28:31], v[64:79]
    v_mfma_f32_32x32x16_bf16 v[80:95], v[244:247], v[16:19], v[80:95]
    v_mfma_f32_32x32x16_bf16 v[96:111], v[244:247], v[20:23], v[96:111]
    s_nop 8
    ds_write_b128 v4, v[48:51] offset:0
    ds_write_b128 v4, v[52:55] offset:32
    ds_write_b128 v4, v[56:59] offset:64
    ds_write_b128 v4, v[60:63] offset:96
    v_mfma_f32_32x32x16_bf16 v[80:95], v[252:255], v[24:27], v[80:95]
    ds_write_b128 v4, v[64:67] offset:8704
    ds_write_b128 v4, v[68:71] offset:8736
    ds_write_b128 v4, v[72:75] offset:8768
    ds_write_b128 v4, v[76:79] offset:8800
    v_mfma_f32_32x32x16_bf16 v[96:111], v[252:255], v[28:31], v[96:111]
    s_nop 6
    ds_write_b128 v4, v[80:83] offset:128
    ds_write_b128 v4, v[84:87] offset:160
    ds_write_b128 v4, v[88:91] offset:192
    ds_write_b128 v4, v[92:95] offset:224
    s_nop 0
    ds_write_b128 v4, v[96:99] offset:8832
    ds_write_b128 v4, v[100:103] offset:8864
    ds_write_b128 v4, v[104:107] offset:8896
    ds_write_b128 v4, v[108:111] offset:8928
    v_mov_b32 v3, 1
    s_waitcnt lgkmcnt(0)
    s_mov_b64 exec, 1
    ds_add_u32 v7, v3 offset:4
    s_mov_b64 exec, -1
    s_mov_b32 s67, 0
L_lw_mred:
    ds_read_b32 v3, v7 offset:4
    s_add_u32 s67, s67, 1
    s_waitcnt lgkmcnt(0)
    v_readfirstlane_b32 s74, v3
    s_cmp_gt_u32 s67, 1600000
    s_cbranch_scc1 L_lx_mred
    s_cmp_lt_u32 s74, 4
    s_cbranch_scc1 L_lw_mred
L_lx_mred:
    ds_read_b128 v[48:51], v5 offset:0
    ds_read_b128 v[52:55], v5 offset:16
    ds_read_b128 v[56:59], v5 offset:2176
    ds_read_b128 v[60:63], v5 offset:2192
    ds_read_b128 v[64:67], v5 offset:17408
    ds_read_b128 v[68:71], v5 offset:17424
    ds_read_b128 v[72:75], v5 offset:19584
    ds_read_b128 v[76:79], v5 offset:19600
    ds_read_b128 v[80:83], v5 offset:34816
    ds_read_b128 v[84:87], v5 offset:34832
    ds_read_b128 v[88:91], v5 offset:36992
    ds_read_b128 v[92:95], v5 offset:37008
    ds_read_b128 v[96:99], v5 offset:52224
    ds_read_b128 v[100:103], v5 offset:52240
    s_waitcnt lgkmcnt(12)
    ds_read_b128 v[104:107], v5 offset:54400
    ds_read_b128 v[108:111], v5 offset:54416
    s_waitcnt lgkmcnt(10)
    v_pk_add_f32 v[128:129], v[48:49], v[64:65]
    v_pk_add_f32 v[130:131], v[50:51], v[66:67]
    v_pk_add_f32 v[132:133], v[52:53], v[68:69]
    v_pk_add_f32 v[134:135], v[54:55], v[70:71]
    s_waitcnt lgkmcnt(8)
    v_pk_add_f32 v[136:137], v[56:57], v[72:73]
    v_pk_add_f32 v[138:139], v[58:59], v[74:75]
    v_pk_add_f32 v[140:141], v[60:61], v[76:77]
    v_pk_add_f32 v[142:143], v[62:63], v[78:79]
    s_waitcnt lgkmcnt(6)
    v_pk_add_f32 v[128:129], v[128:129], v[80:81]
    v_pk_add_f32 v[130:131], v[130:131], v[82:83]
    v_pk_add_f32 v[132:133], v[132:133], v[84:85]
    v_pk_add_f32 v[134:135], v[134:135], v[86:87]
    s_waitcnt lgkmcnt(4)
    v_pk_add_f32 v[136:137], v[136:137], v[88:89]
    v_pk_add_f32 v[138:139], v[138:139], v[90:91]
    v_pk_add_f32 v[140:141], v[140:141], v[92:93]
    v_pk_add_f32 v[142:143], v[142:143], v[94:95]
    s_waitcnt lgkmcnt(2)
    v_pk_add_f32 v[128:129], v[128:129], v[96:97]
    v_pk_add_f32 v[130:131], v[130:131], v[98:99]
    v_pk_add_f32 v[132:133], v[132:133], v[100:101]
    v_pk_add_f32 v[134:135], v[134:135], v[102:103]
    s_waitcnt lgkmcnt(0)
    v_pk_add_f32 v[136:137], v[136:137], v[104:105]
    v_pk_add_f32 v[138:139], v[138:139], v[106:107]
    v_pk_add_f32 v[140:141], v[140:141], v[108:109]
    v_pk_add_f32 v[142:143], v[142:143], v[110:111]
    s_barrier
    ds_read_b128 v[48:51], v6 offset:0
    ds_read_b128 v[52:55], v6 offset:16
    ds_read_b128 v[56:59], v6 offset:2176
    ds_read_b128 v[60:63], v6 offset:2192
    ds_read_b128 v[64:67], v6 offset:17408
    ds_read_b128 v[68:71], v6 offset:17424
    ds_read_b128 v[72:75], v6 offset:19584
    ds_read_b128 v[76:79], v6 offset:19600
    ds_read_b128 v[80:83], v6 offset:34816
    ds_read_b128 v[84:87], v6 offset:34832
    ds_read_b128 v[88:91], v6 offset:36992
    ds_read_b128 v[92:95], v6 offset:37008
    ds_read_b128 v[96:99], v6 offset:52224
    ds_read_b128 v[100:103], v6 offset:52240
    s_waitcnt lgkmcnt(12)
    ds_read_b128 v[104:107], v6 offset:54400
    ds_read_b128 v[108:111], v6 offset:54416
    s_waitcnt lgkmcnt(14)
    v_pk_add_f32 v[128:129], v[128:129], v[48:49]
    v_pk_add_f32 v[130:131], v[130:131], v[50:51]
    v_pk_add_f32 v[132:133], v[132:133], v[52:53]
    v_pk_add_f32 v[134:135], v[134:135], v[54:55]
    s_waitcnt lgkmcnt(12)
    v_pk_add_f32 v[136:137], v[136:137], v[56:57]
    v_pk_add_f32 v[138:139], v[138:139], v[58:59]
    v_pk_add_f32 v[140:141], v[140:141], v[60:61]
    v_pk_add_f32 v[142:143], v[142:143], v[62:63]
    s_waitcnt lgkmcnt(10)
    v_pk_add_f32 v[128:129], v[128:129], v[64:65]
    v_pk_add_f32 v[130:131], v[130:131], v[66:67]
    v_pk_add_f32 v[132:133], v[132:133], v[68:69]
    v_pk_add_f32 v[134:135], v[134:135], v[70:71]
    s_waitcnt lgkmcnt(8)
    v_pk_add_f32 v[136:137], v[136:137], v[72:73]
    v_pk_add_f32 v[138:139], v[138:139], v[74:75]
    v_pk_add_f32 v[140:141], v[140:141], v[76:77]
    v_pk_add_f32 v[142:143], v[142:143], v[78:79]
    s_waitcnt lgkmcnt(6)
    v_pk_add_f32 v[128:129], v[128:129], v[80:81]
    v_pk_add_f32 v[130:131], v[130:131], v[82:83]
    v_pk_add_f32 v[132:133], v[132:133], v[84:85]
    v_pk_add_f32 v[134:135], v[134:135], v[86:87]
    s_waitcnt lgkmcnt(4)
    v_pk_add_f32 v[136:137], v[136:137], v[88:89]
    v_pk_add_f32 v[138:139], v[138:139], v[90:91]
    v_pk_add_f32 v[140:141], v[140:141], v[92:93]
    v_pk_add_f32 v[142:143], v[142:143], v[94:95]
    s_waitcnt lgkmcnt(2)
    v_pk_add_f32 v[128:129], v[128:129], v[96:97]
    v_pk_add_f32 v[130:131], v[130:131], v[98:99]
    v_pk_add_f32 v[132:133], v[132:133], v[100:101]
    v_pk_add_f32 v[134:135], v[134:135], v[102:103]
    v_fma_f32 v128, v128, v116, v144
    v_fma_f32 v129, v129, v116, v145
    v_fma_f32 v130, v130, v116, v146
    v_fma_f32 v131, v131, v116, v147
    v_fma_f32 v132, v132, v116, v148
    v_fma_f32 v133, v133, v116, v149
    v_fma_f32 v134, v134, v116, v150
    v_fma_f32 v135, v135, v116, v151
    v_cvt_pk_bf16_f32 v144, v128, v129
    v_cvt_pk_bf16_f32 v145, v130, v131
    v_cvt_pk_bf16_f32 v146, v132, v133
    v_cvt_pk_bf16_f32 v147, v134, v135
    buffer_store_dwordx4 v[144:147], v119, s[24:27], s64 offen sc0 sc1
    s_waitcnt lgkmcnt(0)
    v_pk_add_f32 v[136:137], v[136:137], v[104:105]
    v_pk_add_f32 v[138:139], v[138:139], v[106:107]
    v_pk_add_f32 v[140:141], v[140:141], v[108:109]
    v_pk_add_f32 v[142:143], v[142:143], v[110:111]
    v_fma_f32 v136, v136, v164, v152
    v_fma_f32 v137, v137, v164, v153
    v_fma_f32 v138, v138, v164, v154
    v_fma_f32 v139, v139, v164, v155
    v_fma_f32 v140, v140, v164, v156
    v_fma_f32 v141, v141, v164, v157
    v_fma_f32 v142, v142, v164, v158
    v_fma_f32 v143, v143, v164, v159
    v_cvt_pk_bf16_f32 v152, v136, v137
    v_cvt_pk_bf16_f32 v153, v138, v139
    v_cvt_pk_bf16_f32 v154, v140, v141
    v_cvt_pk_bf16_f32 v155, v142, v143
    buffer_store_dwordx4 v[152:155], v119, s[24:27], s63 offen sc0 sc1
    s_branch L_fin
L_p2h:
    s_nop 0
    s_lshl_b32 s72, s40, 4
    s_add_u32 s72, s72, s96
    s_mul_i32 s72, s72, 18432
    v_lshlrev_b32 v4, 4, v0
    v_add_u32 v2, s72, v4
    v_add_u32 v1, 147456, v2
    s_mov_b32 s66, 0
    buffer_load_dwordx4 v[8:11], v2, s[28:31], s8 offen sc1
    buffer_load_dwordx4 v[12:15], v1, s[28:31], s8 offen sc1
    buffer_load_dwordx4 v[16:19], v2, s[28:31], s9 offen sc1
    buffer_load_dwordx4 v[20:23], v1, s[28:31], s9 offen sc1
    buffer_load_dwordx4 v[24:27], v2, s[28:31], s10 offen sc1
    buffer_load_dwordx4 v[28:31], v1, s[28:31], s10 offen sc1
    buffer_load_dwordx4 v[32:35], v2, s[28:31], s11 offen sc1
    buffer_load_dwordx4 v[36:39], v1, s[28:31], s11 offen sc1
    buffer_load_dwordx4 v[40:43], v2, s[28:31], s12 offen sc1
    buffer_load_dwordx4 v[44:47], v1, s[28:31], s12 offen sc1
L_w0:
    s_waitcnt vmcnt(8)
L_v0:
    v_xor_b32 v8, s52, v8
    v_xor_b32 v9, s53, v9
    v_xor_b32 v10, s54, v10
    v_xor_b32 v11, s55, v11
    v_xor_b32 v12, s52, v12
    v_xor_b32 v13, s53, v13
    v_xor_b32 v14, s54, v14
    v_xor_b32 v15, s55, v15
    v_or3_b32 v5, v8, v9, v10
    v_or3_b32 v6, v11, v12, v13
    v_or3_b32 v5, v5, v14, v15
    v_or_b32 v5, v5, v6
    v_and_b32 v5, 0x80008000, v5
    v_cmp_ne_u32 vcc, 0, v5
    s_cbranch_vccnz L_rt0
L_go0:
    v_mfma_f32_32x32x16_bf16 v[48:63], v[112:115], v[8:11], 0
    v_mfma_f32_32x32x16_bf16 v[64:79], v[112:115], v[12:15], 0
    v_mfma_f32_32x32x16_bf16 v[80:95], v[116:119], v[8:11], 0
    v_mfma_f32_32x32x16_bf16 v[96:111], v[116:119], v[12:15], 0
    buffer_load_dwordx4 v[8:11], v2, s[28:31], s13 offen sc1
    buffer_load_dwordx4 v[12:15], v1, s[28:31], s13 offen sc1
L_w1:
    s_waitcnt vmcnt(8)
L_v1:
    v_xor_b32 v16, s52, v16
    v_xor_b32 v17, s53, v17
    v_xor_b32 v18, s54, v18
    v_xor_b32 v19, s55, v19
    v_xor_b32 v20, s52, v20
    v_xor_b32 v21, s53, v21
    v_xor_b32 v22, s54, v22
    v_xor_b32 v23, s55, v23
    v_or3_b32 v5, v16, v17, v18
    v_or3_b32 v6, v19, v20, v21
    v_or3_b32 v5, v5, v22, v23
    v_or_b32 v5, v5, v6
    v_and_b32 v5, 0x80008000, v5
    v_cmp_ne_u32 vcc, 0, v5
    s_cbranch_vccnz L_rt1
L_go1:
    v_mfma_f32_32x32x16_bf16 v[48:63], v[120:123], v[16:19], v[48:63]
    v_mfma_f32_32x32x16_bf16 v[64:79], v[120:123], v[20:23], v[64:79]
    v_mfma_f32_32x32x16_bf16 v[80:95], v[124:127], v[16:19], v[80:95]
    v_mfma_f32_32x32x16_bf16 v[96:111], v[124:127], v[20:23], v[96:111]
    buffer_load_dwordx4 v[16:19], v2, s[28:31], s14 offen sc1
    buffer_load_dwordx4 v[20:23], v1, s[28:31], s14 offen sc1
    s_lshl_b32 s72, s38, 3
    v_lshrrev_b32 v117, 3, v0
    v_add_u32 v117, s72, v117
    v_and_b32 v118, 7, v0
    v_lshlrev_b32 v119, 10, v117
    v_lshl_add_u32 v119, v118, 4, v119
    v_lshlrev_b32 v121, 4, v117
    s_lshl_b32 s64, s40, 16
    s_lshl_b32 s72, s41, 7
    s_add_u32 s64, s64, s72
    s_lshl_b32 s65, s40, 10
    s_add_u32 s65, s65, 18087944
    v_mov_b32 v7, 160304
    v_and_b32 v3, 31, v0
    v_lshlrev_b32 v3, 7, v3
    s_lshr_b32 s61, s40, 1
    s_lshl_b32 s61, s61, 12
    s_add_u32 s61, s61, 19202048
    s_lshl_b32 s62, s96, 2
    s_lshl_b32 s62, 15, s62
L_w2:
    s_waitcnt vmcnt(8)
L_v2:
    v_xor_b32 v24, s52, v24
    v_xor_b32 v25, s53, v25
    v_xor_b32 v26, s54, v26
    v_xor_b32 v27, s55, v27
    v_xor_b32 v28, s52, v28
    v_xor_b32 v29, s53, v29
    v_xor_b32 v30, s54, v30
    v_xor_b32 v31, s55, v31
    v_or3_b32 v5, v24, v25, v26
    v_or3_b32 v6, v27, v28, v29
    v_or3_b32 v5, v5, v30, v31
    v_or_b32 v5, v5, v6
    v_and_b32 v5, 0x80008000, v5
    v_cmp_ne_u32 vcc, 0, v5
    s_cbranch_vccnz L_rt2
L_go2:
    v_mfma_f32_32x32x16_bf16 v[48:63], v[128:131], v[24:27], v[48:63]
    v_mfma_f32_32x32x16_bf16 v[64:79], v[128:131], v[28:31], v[64:79]
    v_mfma_f32_32x32x16_bf16 v[80:95], v[132:135], v[24:27], v[80:95]
    v_mfma_f32_32x32x16_bf16 v[96:111], v[132:135], v[28:31], v[96:111]
    buffer_load_dwordx4 v[24:27], v2, s[28:31], s15 offen sc1
    buffer_load_dwordx4 v[28:31], v1, s[28:31], s15 offen sc1
L_w3:
    s_waitcnt vmcnt(8)
L_v3:
    v_xor_b32 v32, s52, v32
    v_xor_b32 v33, s53, v33
    v_xor_b32 v34, s54, v34
    v_xor_b32 v35, s55, v35
    v_xor_b32 v36, s52, v36
    v_xor_b32 v37, s53, v37
    v_xor_b32 v38, s54, v38
    v_xor_b32 v39, s55, v39
    v_or3_b32 v5, v32, v33, v34
    v_or3_b32 v6, v35, v36, v37
    v_or3_b32 v5, v5, v38, v39
    v_or_b32 v5, v5, v6
    v_and_b32 v5, 0x80008000, v5
    v_cmp_ne_u32 vcc, 0, v5
    s_cbranch_vccnz L_rt3
L_go3:
    v_mfma_f32_32x32x16_bf16 v[48:63], v[136:139], v[32:35], v[48:63]
    v_mfma_f32_32x32x16_bf16 v[64:79], v[136:139], v[36:39], v[64:79]
    v_mfma_f32_32x32x16_bf16 v[80:95], v[140:143], v[32:35], v[80:95]
    v_mfma_f32_32x32x16_bf16 v[96:111], v[140:143], v[36:39], v[96:111]
    buffer_load_dwordx4 v[32:35], v2, s[28:31], s16 offen sc1
    buffer_load_dwordx4 v[36:39], v1, s[28:31], s16 offen sc1
L_w4:
    s_waitcnt vmcnt(8)
L_v4:
    v_xor_b32 v40, s52, v40
    v_xor_b32 v41, s53, v41
    v_xor_b32 v42, s54, v42
    v_xor_b32 v43, s55, v43
    v_xor_b32 v44, s52, v44
    v_xor_b32 v45, s53, v45
    v_xor_b32 v46, s54, v46
    v_xor_b32 v47, s55, v47
    v_or3_b32 v5, v40, v41, v42
    v_or3_b32 v6, v43, v44, v45
    v_or3_b32 v5, v5, v46, v47
    v_or_b32 v5, v5, v6
    v_and_b32 v5, 0x80008000, v5
    v_cmp_ne_u32 vcc, 0, v5
    s_cbranch_vccnz L_rt4
L_go4:
    v_mfma_f32_32x32x16_bf16 v[48:63], v[144:147], v[40:43], v[48:63]
    v_mfma_f32_32x32x16_bf16 v[64:79], v[144:147], v[44:47], v[64:79]
    v_mfma_f32_32x32x16_bf16 v[80:95], v[148:151], v[40:43], v[80:95]
    v_mfma_f32_32x32x16_bf16 v[96:111], v[148:151], v[44:47], v[96:111]
    buffer_load_dwordx4 v[40:43], v2, s[28:31], s17 offen sc1
    buffer_load_dwordx4 v[44:47], v1, s[28:31], s17 offen sc1
L_w5:
    s_waitcnt vmcnt(8)
L_v5:
    v_xor_b32 v8, s52, v8
    v_xor_b32 v9, s53, v9
    v_xor_b32 v10, s54, v10
    v_xor_b32 v11, s55, v11
    v_xor_b32 v12, s52, v12
    v_xor_b32 v13, s53, v13
    v_xor_b32 v14, s54, v14
    v_xor_b32 v15, s55, v15
    v_or3_b32 v5, v8, v9, v10
    v_or3_b32 v6, v11, v12, v13
    v_or3_b32 v5, v5, v14, v15
    v_or_b32 v5, v5, v6
    v_and_b32 v5, 0x80008000, v5
    v_cmp_ne_u32 vcc, 0, v5
    s_cbranch_vccnz L_rt5
L_go5:
    v_mfma_f32_32x32x16_bf16 v[48:63], v[152:155], v[8:11], v[48:63]
    v_mfma_f32_32x32x16_bf16 v[64:79], v[152:155], v[12:15], v[64:79]
    v_mfma_f32_32x32x16_bf16 v[80:95], v[156:159], v[8:11], v[80:95]
    v_mfma_f32_32x32x16_bf16 v[96:111], v[156:159], v[12:15], v[96:111]
    buffer_load_dwordx4 v[8:11], v2, s[28:31], s18 offen sc1
    buffer_load_dwordx4 v[12:15], v1, s[28:31], s18 offen sc1
L_w6:
    s_waitcnt vmcnt(8)
L_v6:
    v_xor_b32 v16, s52, v16
    v_xor_b32 v17, s53, v17
    v_xor_b32 v18, s54, v18
    v_xor_b32 v19, s55, v19
    v_xor_b32 v20, s52, v20
    v_xor_b32 v21, s53, v21
    v_xor_b32 v22, s54, v22
    v_xor_b32 v23, s55, v23
    v_or3_b32 v5, v16, v17, v18
    v_or3_b32 v6, v19, v20, v21
    v_or3_b32 v5, v5, v22, v23
    v_or_b32 v5, v5, v6
    v_and_b32 v5, 0x80008000, v5
    v_cmp_ne_u32 vcc, 0, v5
    s_cbranch_vccnz L_rt6
L_go6:
    v_mfma_f32_32x32x16_bf16 v[48:63], v[160:163], v[16:19], v[48:63]
    v_mfma_f32_32x32x16_bf16 v[64:79], v[160:163], v[20:23], v[64:79]
    v_mfma_f32_32x32x16_bf16 v[80:95], v[164:167], v[16:19], v[80:95]
    v_mfma_f32_32x32x16_bf16 v[96:111], v[164:167], v[20:23], v[96:111]
    buffer_load_dwordx4 v[16:19], v2, s[28:31], s19 offen sc1
    buffer_load_dwordx4 v[20:23], v1, s[28:31], s19 offen sc1
L_w7:
    s_waitcnt vmcnt(8)
L_v7:
    v_xor_b32 v24, s52, v24
    v_xor_b32 v25, s53, v25
    v_xor_b32 v26, s54, v26
    v_xor_b32 v27, s55, v27
    v_xor_b32 v28, s52, v28
    v_xor_b32 v29, s53, v29
    v_xor_b32 v30, s54, v30
    v_xor_b32 v31, s55, v31
    v_or3_b32 v5, v24, v25, v26
    v_or3_b32 v6, v27, v28, v29
    v_or3_b32 v5, v5, v30, v31
    v_or_b32 v5, v5, v6
    v_and_b32 v5, 0x80008000, v5
    v_cmp_ne_u32 vcc, 0, v5
    s_cbranch_vccnz L_rt7
L_go7:
    v_mfma_f32_32x32x16_bf16 v[48:63], v[168:171], v[24:27], v[48:63]
    v_mfma_f32_32x32x16_bf16 v[64:79], v[168:171], v[28:31], v[64:79]
    v_mfma_f32_32x32x16_bf16 v[80:95], v[172:175], v[24:27], v[80:95]
    v_mfma_f32_32x32x16_bf16 v[96:111], v[172:175], v[28:31], v[96:111]
    buffer_load_dwordx4 v[24:27], v2, s[28:31], s20 offen sc1
    buffer_load_dwordx4 v[28:31], v1, s[28:31], s20 offen sc1
L_w8:
    s_waitcnt vmcnt(8)
L_v8:
    v_xor_b32 v32, s52, v32
    v_xor_b32 v33, s53, v33
    v_xor_b32 v34, s54, v34
    v_xor_b32 v35, s55, v35
    v_xor_b32 v36, s52, v36
    v_xor_b32 v37, s53, v37
    v_xor_b32 v38, s54, v38
    v_xor_b32 v39, s55, v39
    v_or3_b32 v5, v32, v33, v34
    v_or3_b32 v6, v35, v36, v37
    v_or3_b32 v5, v5, v38, v39
    v_or_b32 v5, v5, v6
    v_and_b32 v5, 0x80008000, v5
    v_cmp_ne_u32 vcc, 0, v5
    s_cbranch_vccnz L_rt8
L_go8:
    v_mfma_f32_32x32x16_bf16 v[48:63], v[176:179], v[32:35], v[48:63]
    v_mfma_f32_32x32x16_bf16 v[64:79], v[176:179], v[36:39], v[64:79]
    v_mfma_f32_32x32x16_bf16 v[80:95], v[180:183], v[32:35], v[80:95]
    v_mfma_f32_32x32x16_bf16 v[96:111], v[180:183], v[36:39], v[96:111]
    buffer_load_dwordx4 v[32:35], v2, s[28:31], s21 offen sc1
    buffer_load_dwordx4 v[36:39], v1, s[28:31], s21 offen sc1
L_w9:
    s_waitcnt vmcnt(8)
L_v9:
    v_xor_b32 v40, s52, v40
    v_xor_b32 v41, s53, v41
    v_xor_b32 v42, s54, v42
    v_xor_b32 v43, s55, v43
    v_xor_b32 v44, s52, v44
    v_xor_b32 v45, s53, v45
    v_xor_b32 v46, s54, v46
    v_xor_b32 v47, s55, v47
    v_or3_b32 v5, v40, v41, v42
    v_or3_b32 v6, v43, v44, v45
    v_or3_b32 v5, v5, v46, v47
    v_or_b32 v5, v5, v6
    v_and_b32 v5, 0x80008000, v5
    v_cmp_ne_u32 vcc, 0, v5
    s_cbranch_vccnz L_rt9
L_go9:
    v_mfma_f32_32x32x16_bf16 v[48:63], v[184:187], v[40:43], v[48:63]
    v_mfma_f32_32x32x16_bf16 v[64:79], v[184:187], v[44:47], v[64:79]
    v_mfma_f32_32x32x16_bf16 v[80:95], v[188:191], v[40:43], v[80:95]
    v_mfma_f32_32x32x16_bf16 v[96:111], v[188:191], v[44:47], v[96:111]
L_w10:
    s_waitcnt vmcnt(6)
L_v10:
    v_xor_b32 v8, s52, v8
    v_xor_b32 v9, s53, v9
    v_xor_b32 v10, s54, v10
    v_xor_b32 v11, s55, v11
    v_xor_b32 v12, s52, v12
    v_xor_b32 v13, s53, v13
    v_xor_b32 v14, s54, v14
    v_xor_b32 v15, s55, v15
    v_or3_b32 v5, v8, v9, v10
    v_or3_b32 v6, v11, v12, v13
    v_or3_b32 v5, v5, v14, v15
    v_or_b32 v5, v5, v6
    v_and_b32 v5, 0x80008000, v5
    v_cmp_ne_u32 vcc, 0, v5
    s_cbranch_vccnz L_rt10
L_go10:
    v_mfma_f32_32x32x16_bf16 v[48:63], v[192:195], v[8:11], v[48:63]
    v_mfma_f32_32x32x16_bf16 v[64:79], v[192:195], v[12:15], v[64:79]
    v_mfma_f32_32x32x16_bf16 v[80:95], v[196:199], v[8:11], v[80:95]
    v_mfma_f32_32x32x16_bf16 v[96:111], v[196:199], v[12:15], v[96:111]
L_w11:
    s_waitcnt vmcnt(4)
L_v11:
    v_xor_b32 v16, s52, v16
    v_xor_b32 v17, s53, v17
    v_xor_b32 v18, s54, v18
    v_xor_b32 v19, s55, v19
    v_xor_b32 v20, s52, v20
    v_xor_b32 v21, s53, v21
    v_xor_b32 v22, s54, v22
    v_xor_b32 v23, s55, v23
    v_or3_b32 v5, v16, v17, v18
    v_or3_b32 v6, v19, v20, v21
    v_or3_b32 v5, v5, v22, v23
    v_or_b32 v5, v5, v6
    v_and_b32 v5, 0x80008000, v5
    v_cmp_ne_u32 vcc, 0, v5
    s_cbranch_vccnz L_rt11
L_go11:
    v_mfma_f32_32x32x16_bf16 v[48:63], v[200:203], v[16:19], v[48:63]
    v_mfma_f32_32x32x16_bf16 v[64:79], v[200:203], v[20:23], v[64:79]
    v_mfma_f32_32x32x16_bf16 v[80:95], v[204:207], v[16:19], v[80:95]
    v_mfma_f32_32x32x16_bf16 v[96:111], v[204:207], v[20:23], v[96:111]
    s_mov_b32 exec_lo, s62
    s_mov_b32 exec_hi, 0
    buffer_load_dword v122, v3, s[28:31], s61 offen sc1
    s_mov_b64 exec, -1
L_w12:
    s_waitcnt vmcnt(3)
L_v12:
    v_xor_b32 v24, s52, v24
    v_xor_b32 v25, s53, v25
    v_xor_b32 v26, s54, v26
    v_xor_b32 v27, s55, v27
    v_xor_b32 v28, s52, v28
    v_xor_b32 v29, s53, v29
    v_xor_b32 v30, s54, v30
    v_xor_b32 v31, s55, v31
    v_or3_b32 v5, v24, v25, v26
    v_or3_b32 v6, v27, v28, v29
    v_or3_b32 v5, v5, v30, v31
    v_or_b32 v5, v5, v6
    v_and_b32 v5, 0x80008000, v5
    v_cmp_ne_u32 vcc, 0, v5
    s_cbranch_vccnz L_rt12
L_go12:
    v_mfma_f32_32x32x16_bf16 v[48:63], v[208:211], v[24:27], v[48:63]
    v_mfma_f32_32x32x16_bf16 v[64:79], v[208:211], v[28:31], v[64:79]
    v_mfma_f32_32x32x16_bf16 v[80:95], v[212:215], v[24:27], v[80:95]
    v_mfma_f32_32x32x16_bf16 v[96:111], v[212:215], v[28:31], v[96:111]
L_w13:
    s_waitcnt vmcnt(1)
L_v13:
    v_xor_b32 v32, s52, v32
    v_xor_b32 v33, s53, v33
    v_xor_b32 v34, s54, v34
    v_xor_b32 v35, s55, v35
    v_xor_b32 v36, s52, v36
    v_xor_b32 v37, s53, v37
    v_xor_b32 v38, s54, v38
    v_xor_b32 v39, s55, v39
    v_or3_b32 v5, v32, v33, v34
    v_or3_b32 v6, v35, v36, v37
    v_or3_b32 v5, v5, v38, v39
    v_or_b32 v5, v5, v6
    v_and_b32 v5, 0x80008000, v5
    v_cmp_ne_u32 vcc, 0, v5
    s_cbranch_vccnz L_rt13
L_go13:
    v_mfma_f32_32x32x16_bf16 v[48:63], v[216:219], v[32:35], v[48:63]
    v_mfma_f32_32x32x16_bf16 v[64:79], v[216:219], v[36:39], v[64:79]
    v_mfma_f32_32x32x16_bf16 v[80:95], v[220:223], v[32:35], v[80:95]
    v_mfma_f32_32x32x16_bf16 v[96:111], v[220:223], v[36:39], v[96:111]
    s_waitcnt vmcnt(0)
    v_cmp_eq_u32 vcc, s39, v122
    s_nop 1
    s_and_b32 s72, vcc_lo, s62
    s_cmp_eq_u32 s72, s62
    s_cbranch_scc1 L_ook
    s_mov_b32 s67, 0
L_opoll:
    s_sleep 4
    s_mov_b32 exec_lo, s62
    s_mov_b32 exec_hi, 0
    buffer_load_dword v122, v3, s[28:31], s61 offen sc1
    s_mov_b64 exec, -1
    s_add_u32 s67, s67, 1
    s_cmp_gt_u32 s67, 200000
    s_cbranch_scc1 L_ook
    s_waitcnt vmcnt(0)
    v_cmp_eq_u32 vcc, s39, v122
    s_nop 1
    s_and_b32 s72, vcc_lo, s62
    s_cmp_eq_u32 s72, s62
    s_cbranch_scc0 L_opoll
L_ook:
    buffer_load_dwordx4 v[40:43], v2, s[28:31], s22 offen sc1
    buffer_load_dwordx4 v[44:47], v1, s[28:31], s22 offen sc1
    buffer_load_dwordx4 v[8:11], v2, s[28:31], s23 offen sc1
    buffer_load_dwordx4 v[12:15], v1, s[28:31], s23 offen sc1
    buffer_load_dwordx4 v[16:19], v2, s[28:31], s32 offen sc1
    buffer_load_dwordx4 v[20:23], v1, s[28:31], s32 offen sc1
    buffer_load_dwordx4 v[24:27], v2, s[28:31], s33 offen sc1
    buffer_load_dwordx4 v[28:31], v1, s[28:31], s33 offen sc1
    ds_read_b32 v3, v7
    v_and_b32 v4, 31, v0
    v_mul_u32_u24 v4, 272, v4
    v_lshrrev_b32 v120, 5, v0
    v_lshl_add_u32 v4, v120, 4, v4
    s_mul_i32 s72, s38, 17408
    v_add_u32 v4, s72, v4
    s_waitcnt lgkmcnt(0)
    v_readfirstlane_b32 s72, v3
    s_nop 0
    s_cmp_ge_u32 s72, 8
    s_cbranch_scc1 L_lx_p1
    s_mov_b32 s67, 0
L_lw_p1:
    ds_read_b32 v3, v7 offset:0
    s_add_u32 s67, s67, 1
    s_waitcnt lgkmcnt(0)
    v_readfirstlane_b32 s74, v3
    s_cmp_gt_u32 s67, 1600000
    s_cbranch_scc1 L_lx_p1
    s_cmp_lt_u32 s74, 8
    s_cbranch_scc1 L_lw_p1
L_lx_p1:
L_w14:
    s_waitcnt vmcnt(6)
L_v14:
L_go14:
    v_mfma_f32_32x32x16_bf16 v[48:63], v[224:227], v[40:43], v[48:63]
    v_mfma_f32_32x32x16_bf16 v[64:79], v[224:227], v[44:47], v[64:79]
    v_mfma_f32_32x32x16_bf16 v[80:95], v[228:231], v[40:43], v[80:95]
    v_mfma_f32_32x32x16_bf16 v[96:111], v[228:231], v[44:47], v[96:111]
L_w15:
    s_waitcnt vmcnt(4)
L_v15:
L_go15:
    v_mfma_f32_32x32x16_bf16 v[48:63], v[232:235], v[8:11], v[48:63]
    v_mfma_f32_32x32x16_bf16 v[64:79], v[232:235], v[12:15], v[64:79]
    v_mfma_f32_32x32x16_bf16 v[80:95], v[236:239], v[8:11], v[80:95]
    v_mfma_f32_32x32x16_bf16 v[96:111], v[236:239], v[12:15], v[96:111]
    s_waitcnt vmcnt(2)
    v_mfma_f32_32x32x16_bf16 v[48:63], v[240:243], v[16:19], v[48:63]
    v_mfma_f32_32x32x16_bf16 v[64:79], v[240:243], v[20:23], v[64:79]
    s_waitcnt vmcnt(0)
    v_mfma_f32_32x32x16_bf16 v[48:63], v[248:251], v[24:27], v[48:63]
    v_mfma_f32_32x32x16_bf16 v[64:79], v[248:251], v[28:31], v[64:79]
    v_mfma_f32_32x32x16_bf16 v[80:95], v[244:247], v[16:19], v[80:95]
    v_mfma_f32_32x32x16_bf16 v[96:111], v[244:247], v[20:23], v[96:111]
    s_nop 8
    ds_write_b128 v4, v[48:51] offset:0
    ds_write_b128 v4, v[52:55] offset:32
    ds_write_b128 v4, v[56:59] offset:64
    ds_write_b128 v4, v[60:63] offset:96
    v_mfma_f32_32x32x16_bf16 v[80:95], v[252:255], v[24:27], v[80:95]
    ds_write_b128 v4, v[64:67] offset:8704
    ds_write_b128 v4, v[68:71] offset:8736
    ds_write_b128 v4, v[72:75] offset:8768
    ds_write_b128 v4, v[76:79] offset:8800
    v_mfma_f32_32x32x16_bf16 v[96:111], v[252:255], v[28:31], v[96:111]
    s_nop 6
    ds_write_b128 v4, v[80:83] offset:128
    ds_write_b128 v4, v[84:87] offset:160
    ds_write_b128 v4, v[88:91] offset:192
    ds_write_b128 v4, v[92:95] offset:224
    s_nop 0
    ds_write_b128 v4, v[96:99] offset:8832
    ds_write_b128 v4, v[100:103] offset:8864
    ds_write_b128 v4, v[104:107] offset:8896
    ds_write_b128 v4, v[108:111] offset:8928
    s_waitcnt lgkmcnt(0)
    s_barrier
L_fin:
    s_or_b32 s60, s2, s38
    s_cmp_lg_u32 s60, 0
    s_cbranch_scc1 L_end
    s_add_u32 s60, s99, 1
    v_mov_b32 v5, s60
    v_mov_b32 v6, 19070976
    s_mov_b64 exec, 1
    buffer_store_dword v5, v6, s[28:31], 0 offen sc1
    s_endpgm
L_qrt0:
    s_add_u32 s66, s66, 1
    s_cmp_gt_u32 s66, 200000
    s_cbranch_scc1 L_qgo0
    s_sleep 2
    buffer_load_dwordx4 v[8:11], v2, s[28:31], s8 offen sc1
    buffer_load_dwordx4 v[12:15], v1, s[28:31], s8 offen sc1
    buffer_load_dwordx4 v[16:19], v2, s[28:31], s9 offen sc1
    buffer_load_dwordx4 v[20:23], v1, s[28:31], s9 offen sc1
    buffer_load_dwordx4 v[24:27], v2, s[28:31], s10 offen sc1
    buffer_load_dwordx4 v[28:31], v1, s[28:31], s10 offen sc1
    buffer_load_dwordx4 v[32:35], v2, s[28:31], s11 offen sc1
    buffer_load_dwordx4 v[36:39], v1, s[28:31], s11 offen sc1
    buffer_load_dwordx4 v[40:43], v2, s[28:31], s12 offen sc1
    buffer_load_dwordx4 v[44:47], v1, s[28:31], s12 offen sc1
    s_waitcnt vmcnt(8)
    s_branch L_qv0
L_qrt1:
    s_add_u32 s66, s66, 1
    s_cmp_gt_u32 s66, 200000
    s_cbranch_scc1 L_qgo1
    s_sleep 2
    buffer_load_dwordx4 v[16:19], v2, s[28:31], s9 offen sc1
    buffer_load_dwordx4 v[20:23], v1, s[28:31], s9 offen sc1
    buffer_load_dwordx4 v[24:27], v2, s[28:31], s10 offen sc1
    buffer_load_dwordx4 v[28:31], v1, s[28:31], s10 offen sc1
    buffer_load_dwordx4 v[32:35], v2, s[28:31], s11 offen sc1
    buffer_load_dwordx4 v[36:39], v1, s[28:31], s11 offen sc1
    buffer_load_dwordx4 v[40:43], v2, s[28:31], s12 offen sc1
    buffer_load_dwordx4 v[44:47], v1, s[28:31], s12 offen sc1
    buffer_load_dwordx4 v[8:11], v2, s[28:31], s13 offen sc1
    buffer_load_dwordx4 v[12:15], v1, s[28:31], s13 offen sc1
    s_waitcnt vmcnt(8)
    s_branch L_qv1
L_qrt2:
    s_add_u32 s66, s66, 1
    s_cmp_gt_u32 s66, 200000
    s_cbranch_scc1 L_qgo2
    s_sleep 2
    buffer_load_dwordx4 v[24:27], v2, s[28:31], s10 offen sc1
    buffer_load_dwordx4 v[28:31], v1, s[28:31], s10 offen sc1
    buffer_load_dwordx4 v[32:35], v2, s[28:31], s11 offen sc1
    buffer_load_dwordx4 v[36:39], v1, s[28:31], s11 offen sc1
    buffer_load_dwordx4 v[40:43], v2, s[28:31], s12 offen sc1
    buffer_load_dwordx4 v[44:47], v1, s[28:31], s12 offen sc1
    buffer_load_dwordx4 v[8:11], v2, s[28:31], s13 offen sc1
    buffer_load_dwordx4 v[12:15], v1, s[28:31], s13 offen sc1
    buffer_load_dwordx4 v[16:19], v2, s[28:31], s14 offen sc1
    buffer_load_dwordx4 v[20:23], v1, s[28:31], s14 offen sc1
    s_waitcnt vmcnt(0)
    s_branch L_qv2
L_qrt3:
    s_add_u32 s66, s66, 1
    s_cmp_gt_u32 s66, 200000
    s_cbranch_scc1 L_qgo3
    s_sleep 2
    buffer_load_dwordx4 v[32:35], v2, s[28:31], s11 offen sc1
    buffer_load_dwordx4 v[36:39], v1, s[28:31], s11 offen sc1
    buffer_load_dwordx4 v[40:43], v2, s[28:31], s12 offen sc1
    buffer_load_dwordx4 v[44:47], v1, s[28:31], s12 offen sc1
    buffer_load_dwordx4 v[8:11], v2, s[28:31], s13 offen sc1
    buffer_load_dwordx4 v[12:15], v1, s[28:31], s13 offen sc1
    buffer_load_dwordx4 v[16:19], v2, s[28:31], s14 offen sc1
    buffer_load_dwordx4 v[20:23], v1, s[28:31], s14 offen sc1
    buffer_load_dwordx4 v[24:27], v2, s[28:31], s15 offen sc1
    buffer_load_dwordx4 v[28:31], v1, s[28:31], s15 offen sc1
    s_waitcnt vmcnt(0)
    s_branch L_qv3
L_qrt4:
    s_add_u32 s66, s66, 1
    s_cmp_gt_u32 s66, 200000
    s_cbranch_scc1 L_qgo4
    s_sleep 2
    buffer_load_dwordx4 v[40:43], v2, s[28:31], s12 offen sc1
    buffer_load_dwordx4 v[44:47], v1, s[28:31], s12 offen sc1
    buffer_load_dwordx4 v[8:11], v2, s[28:31], s13 offen sc1
    buffer_load_dwordx4 v[12:15], v1, s[28:31], s13 offen sc1
    buffer_load_dwordx4 v[16:19], v2, s[28:31], s14 offen sc1
    buffer_load_dwordx4 v[20:23], v1, s[28:31], s14 offen sc1
    buffer_load_dwordx4 v[24:27], v2, s[28:31], s15 offen sc1
    buffer_load_dwordx4 v[28:31], v1, s[28:31], s15 offen sc1
    buffer_load_dwordx4 v[32:35], v2, s[28:31], s16 offen sc1
    buffer_load_dwordx4 v[36:39], v1, s[28:31], s16 offen sc1
    s_waitcnt vmcnt(0)
    s_branch L_qv4
L_qrt5:
    s_add_u32 s66, s66, 1
    s_cmp_gt_u32 s66, 200000
    s_cbranch_scc1 L_qgo5
    s_sleep 2
    buffer_load_dwordx4 v[8:11], v2, s[28:31], s13 offen sc1
    buffer_load_dwordx4 v[12:15], v1, s[28:31], s13 offen sc1
    buffer_load_dwordx4 v[16:19], v2, s[28:31], s14 offen sc1
    buffer_load_dwordx4 v[20:23], v1, s[28:31], s14 offen sc1
    buffer_load_dwordx4 v[24:27], v2, s[28:31], s15 offen sc1
    buffer_load_dwordx4 v[28:31], v1, s[28:31], s15 offen sc1
    buffer_load_dwordx4 v[32:35], v2, s[28:31], s16 offen sc1
    buffer_load_dwordx4 v[36:39], v1, s[28:31], s16 offen sc1
    buffer_load_dwordx4 v[40:43], v2, s[28:31], s17 offen sc1
    buffer_load_dwordx4 v[44:47], v1, s[28:31], s17 offen sc1
    s_waitcnt vmcnt(0)
    s_branch L_qv5
L_qrt6:
    s_add_u32 s66, s66, 1
    s_cmp_gt_u32 s66, 200000
    s_cbranch_scc1 L_qgo6
    s_sleep 2
    buffer_load_dwordx4 v[16:19], v2, s[28:31], s14 offen sc1
    buffer_load_dwordx4 v[20:23], v1, s[28:31], s14 offen sc1
    buffer_load_dwordx4 v[24:27], v2, s[28:31], s15 offen sc1
    buffer_load_dwordx4 v[28:31], v1, s[28:31], s15 offen sc1
    buffer_load_dwordx4 v[32:35], v2, s[28:31], s16 offen sc1
    buffer_load_dwordx4 v[36:39], v1, s[28:31], s16 offen sc1
    buffer_load_dwordx4 v[40:43], v2, s[28:31], s17 offen sc1
    buffer_load_dwordx4 v[44:47], v1, s[28:31], s17 offen sc1
    buffer_load_dwordx4 v[8:11], v2, s[28:31], s18 offen sc1
    buffer_load_dwordx4 v[12:15], v1, s[28:31], s18 offen sc1
    s_waitcnt vmcnt(0)
    s_branch L_qv6
L_qrt7:
    s_add_u32 s66, s66, 1
    s_cmp_gt_u32 s66, 200000
    s_cbranch_scc1 L_qgo7
    s_sleep 2
    buffer_load_dwordx4 v[24:27], v2, s[28:31], s15 offen sc1
    buffer_load_dwordx4 v[28:31], v1, s[28:31], s15 offen sc1
    buffer_load_dwordx4 v[32:35], v2, s[28:31], s16 offen sc1
    buffer_load_dwordx4 v[36:39], v1, s[28:31], s16 offen sc1
    buffer_load_dwordx4 v[40:43], v2, s[28:31], s17 offen sc1
    buffer_load_dwordx4 v[44:47], v1, s[28:31], s17 offen sc1
    buffer_load_dwordx4 v[8:11], v2, s[28:31], s18 offen sc1
    buffer_load_dwordx4 v[12:15], v1, s[28:31], s18 offen sc1
    buffer_load_dwordx4 v[16:19], v2, s[28:31], s19 offen sc1
    buffer_load_dwordx4 v[20:23], v1, s[28:31], s19 offen sc1
    s_waitcnt vmcnt(0)
    s_branch L_qv7
L_qrt8:
    s_add_u32 s66, s66, 1
    s_cmp_gt_u32 s66, 200000
    s_cbranch_scc1 L_qgo8
    s_sleep 2
    buffer_load_dwordx4 v[32:35], v2, s[28:31], s16 offen sc1
    buffer_load_dwordx4 v[36:39], v1, s[28:31], s16 offen sc1
    buffer_load_dwordx4 v[40:43], v2, s[28:31], s17 offen sc1
    buffer_load_dwordx4 v[44:47], v1, s[28:31], s17 offen sc1
    buffer_load_dwordx4 v[8:11], v2, s[28:31], s18 offen sc1
    buffer_load_dwordx4 v[12:15], v1, s[28:31], s18 offen sc1
    buffer_load_dwordx4 v[16:19], v2, s[28:31], s19 offen sc1
    buffer_load_dwordx4 v[20:23], v1, s[28:31], s19 offen sc1
    buffer_load_dwordx4 v[24:27], v2, s[28:31], s20 offen sc1
    buffer_load_dwordx4 v[28:31], v1, s[28:31], s20 offen sc1
    s_waitcnt vmcnt(0)
    s_branch L_qv8
L_qrt9:
    s_add_u32 s66, s66, 1
    s_cmp_gt_u32 s66, 200000
    s_cbranch_scc1 L_qgo9
    s_sleep 2
    buffer_load_dwordx4 v[40:43], v2, s[28:31], s17 offen sc1
    buffer_load_dwordx4 v[44:47], v1, s[28:31], s17 offen sc1
    buffer_load_dwordx4 v[8:11], v2, s[28:31], s18 offen sc1
    buffer_load_dwordx4 v[12:15], v1, s[28:31], s18 offen sc1
    buffer_load_dwordx4 v[16:19], v2, s[28:31], s19 offen sc1
    buffer_load_dwordx4 v[20:23], v1, s[28:31], s19 offen sc1
    buffer_load_dwordx4 v[24:27], v2, s[28:31], s20 offen sc1
    buffer_load_dwordx4 v[28:31], v1, s[28:31], s20 offen sc1
    buffer_load_dwordx4 v[32:35], v2, s[28:31], s21 offen sc1
    buffer_load_dwordx4 v[36:39], v1, s[28:31], s21 offen sc1
    s_waitcnt vmcnt(0)
    s_branch L_qv9
L_mrt0:
    s_add_u32 s66, s66, 1
    s_cmp_gt_u32 s66, 200000
    s_cbranch_scc1 L_mgo0
    s_sleep 2
    buffer_load_dwordx4 v[8:11], v2, s[28:31], s8 offen sc1
    buffer_load_dwordx4 v[12:15], v1, s[28:31], s8 offen sc1
    buffer_load_dwordx4 v[16:19], v2, s[28:31], s9 offen sc1
    buffer_load_dwordx4 v[20:23], v1, s[28:31], s9 offen sc1
    buffer_load_dwordx4 v[24:27], v2, s[28:31], s10 offen sc1
    buffer_load_dwordx4 v[28:31], v1, s[28:31], s10 offen sc1
    buffer_load_dwordx4 v[32:35], v2, s[28:31], s11 offen sc1
    buffer_load_dwordx4 v[36:39], v1, s[28:31], s11 offen sc1
    buffer_load_dwordx4 v[40:43], v2, s[28:31], s12 offen sc1
    buffer_load_dwordx4 v[44:47], v1, s[28:31], s12 offen sc1
    s_waitcnt vmcnt(8)
    s_branch L_mv0
L_mrt1:
    s_add_u32 s66, s66, 1
    s_cmp_gt_u32 s66, 200000
    s_cbranch_scc1 L_mgo1
    s_sleep 2
    buffer_load_dwordx4 v[16:19], v2, s[28:31], s9 offen sc1
    buffer_load_dwordx4 v[20:23], v1, s[28:31], s9 offen sc1
    buffer_load_dwordx4 v[24:27], v2, s[28:31], s10 offen sc1
    buffer_load_dwordx4 v[28:31], v1, s[28:31], s10 offen sc1
    buffer_load_dwordx4 v[32:35], v2, s[28:31], s11 offen sc1
    buffer_load_dwordx4 v[36:39], v1, s[28:31], s11 offen sc1
    buffer_load_dwordx4 v[40:43], v2, s[28:31], s12 offen sc1
    buffer_load_dwordx4 v[44:47], v1, s[28:31], s12 offen sc1
    buffer_load_dwordx4 v[8:11], v2, s[28:31], s13 offen sc1
    buffer_load_dwordx4 v[12:15], v1, s[28:31], s13 offen sc1
    s_waitcnt vmcnt(8)
    s_branch L_mv1
L_mrt2:
    s_add_u32 s66, s66, 1
    s_cmp_gt_u32 s66, 200000
    s_cbranch_scc1 L_mgo2
    s_sleep 2
    buffer_load_dwordx4 v[24:27], v2, s[28:31], s10 offen sc1
    buffer_load_dwordx4 v[28:31], v1, s[28:31], s10 offen sc1
    buffer_load_dwordx4 v[32:35], v2, s[28:31], s11 offen sc1
    buffer_load_dwordx4 v[36:39], v1, s[28:31], s11 offen sc1
    buffer_load_dwordx4 v[40:43], v2, s[28:31], s12 offen sc1
    buffer_load_dwordx4 v[44:47], v1, s[28:31], s12 offen sc1
    buffer_load_dwordx4 v[8:11], v2, s[28:31], s13 offen sc1
    buffer_load_dwordx4 v[12:15], v1, s[28:31], s13 offen sc1
    buffer_load_dwordx4 v[16:19], v2, s[28:31], s14 offen sc1
    buffer_load_dwordx4 v[20:23], v1, s[28:31], s14 offen sc1
    s_waitcnt vmcnt(8)
    s_branch L_mv2
L_mrt3:
    s_add_u32 s66, s66, 1
    s_cmp_gt_u32 s66, 200000
    s_cbranch_scc1 L_mgo3
    s_sleep 2
    buffer_load_dwordx4 v[32:35], v2, s[28:31], s11 offen sc1
    buffer_load_dwordx4 v[36:39], v1, s[28:31], s11 offen sc1
    buffer_load_dwordx4 v[40:43], v2, s[28:31], s12 offen sc1
    buffer_load_dwordx4 v[44:47], v1, s[28:31], s12 offen sc1
    buffer_load_dwordx4 v[8:11], v2, s[28:31], s13 offen sc1
    buffer_load_dwordx4 v[12:15], v1, s[28:31], s13 offen sc1
    buffer_load_dwordx4 v[16:19], v2, s[28:31], s14 offen sc1
    buffer_load_dwordx4 v[20:23], v1, s[28:31], s14 offen sc1
    buffer_load_dwordx4 v[24:27], v2, s[28:31], s15 offen sc1
    buffer_load_dwordx4 v[28:31], v1, s[28:31], s15 offen sc1
    s_waitcnt vmcnt(8)
    s_branch L_mv3
L_mrt4:
    s_add_u32 s66, s66, 1
    s_cmp_gt_u32 s66, 200000
    s_cbranch_scc1 L_mgo4
    s_sleep 2
    buffer_load_dwordx4 v[40:43], v2, s[28:31], s12 offen sc1
    buffer_load_dwordx4 v[44:47], v1, s[28:31], s12 offen sc1
    buffer_load_dwordx4 v[8:11], v2, s[28:31], s13 offen sc1
    buffer_load_dwordx4 v[12:15], v1, s[28:31], s13 offen sc1
    buffer_load_dwordx4 v[16:19], v2, s[28:31], s14 offen sc1
    buffer_load_dwordx4 v[20:23], v1, s[28:31], s14 offen sc1
    buffer_load_dwordx4 v[24:27], v2, s[28:31], s15 offen sc1
    buffer_load_dwordx4 v[28:31], v1, s[28:31], s15 offen sc1
    buffer_load_dwordx4 v[32:35], v2, s[28:31], s16 offen sc1
    buffer_load_dwordx4 v[36:39], v1, s[28:31], s16 offen sc1
    s_waitcnt vmcnt(8)
    s_branch L_mv4
L_mrt5:
    s_add_u32 s66, s66, 1
    s_cmp_gt_u32 s66, 200000
    s_cbranch_scc1 L_mgo5
    s_sleep 2
    buffer_load_dwordx4 v[8:11], v2, s[28:31], s13 offen sc1
    buffer_load_dwordx4 v[12:15], v1, s[28:31], s13 offen sc1
    buffer_load_dwordx4 v[16:19], v2, s[28:31], s14 offen sc1
    buffer_load_dwordx4 v[20:23], v1, s[28:31], s14 offen sc1
    buffer_load_dwordx4 v[24:27], v2, s[28:31], s15 offen sc1
    buffer_load_dwordx4 v[28:31], v1, s[28:31], s15 offen sc1
    buffer_load_dwordx4 v[32:35], v2, s[28:31], s16 offen sc1
    buffer_load_dwordx4 v[36:39], v1, s[28:31], s16 offen sc1
    buffer_load_dwordx4 v[40:43], v2, s[28:31], s17 offen sc1
    buffer_load_dwordx4 v[44:47], v1, s[28:31], s17 offen sc1
    s_waitcnt vmcnt(8)
    s_branch L_mv5
L_mrt6:
    s_add_u32 s66, s66, 1
    s_cmp_gt_u32 s66, 200000
    s_cbranch_scc1 L_mgo6
    s_sleep 2
    buffer_load_dwordx4 v[16:19], v2, s[28:31], s14 offen sc1
    buffer_load_dwordx4 v[20:23], v1, s[28:31], s14 offen sc1
    buffer_load_dwordx4 v[24:27], v2, s[28:31], s15 offen sc1
    buffer_load_dwordx4 v[28:31], v1, s[28:31], s15 offen sc1
    buffer_load_dwordx4 v[32:35], v2, s[28:31], s16 offen sc1
    buffer_load_dwordx4 v[36:39], v1, s[28:31], s16 offen sc1
    buffer_load_dwordx4 v[40:43], v2, s[28:31], s17 offen sc1
    buffer_load_dwordx4 v[44:47], v1, s[28:31], s17 offen sc1
    buffer_load_dwordx4 v[8:11], v2, s[28:31], s18 offen sc1
    buffer_load_dwordx4 v[12:15], v1, s[28:31], s18 offen sc1
    s_waitcnt vmcnt(8)
    s_branch L_mv6
L_mrt7:
    s_add_u32 s66, s66, 1
    s_cmp_gt_u32 s66, 200000
    s_cbranch_scc1 L_mgo7
    s_sleep 2
    buffer_load_dwordx4 v[24:27], v2, s[28:31], s15 offen sc1
    buffer_load_dwordx4 v[28:31], v1, s[28:31], s15 offen sc1
    buffer_load_dwordx4 v[32:35], v2, s[28:31], s16 offen sc1
    buffer_load_dwordx4 v[36:39], v1, s[28:31], s16 offen sc1
    buffer_load_dwordx4 v[40:43], v2, s[28:31], s17 offen sc1
    buffer_load_dwordx4 v[44:47], v1, s[28:31], s17 offen sc1
    buffer_load_dwordx4 v[8:11], v2, s[28:31], s18 offen sc1
    buffer_load_dwordx4 v[12:15], v1, s[28:31], s18 offen sc1
    buffer_load_dwordx4 v[16:19], v2, s[28:31], s19 offen sc1
    buffer_load_dwordx4 v[20:23], v1, s[28:31], s19 offen sc1
    s_waitcnt vmcnt(8)
    s_branch L_mv7
L_mrt8:
    s_add_u32 s66, s66, 1
    s_cmp_gt_u32 s66, 200000
    s_cbranch_scc1 L_mgo8
    s_sleep 2
    buffer_load_dwordx4 v[32:35], v2, s[28:31], s16 offen sc1
    buffer_load_dwordx4 v[36:39], v1, s[28:31], s16 offen sc1
    buffer_load_dwordx4 v[40:43], v2, s[28:31], s17 offen sc1
    buffer_load_dwordx4 v[44:47], v1, s[28:31], s17 offen sc1
    buffer_load_dwordx4 v[8:11], v2, s[28:31], s18 offen sc1
    buffer_load_dwordx4 v[12:15], v1, s[28:31], s18 offen sc1
    buffer_load_dwordx4 v[16:19], v2, s[28:31], s19 offen sc1
    buffer_load_dwordx4 v[20:23], v1, s[28:31], s19 offen sc1
    buffer_load_dwordx4 v[24:27], v2, s[28:31], s20 offen sc1
    buffer_load_dwordx4 v[28:31], v1, s[28:31], s20 offen sc1
    s_waitcnt vmcnt(8)
    s_branch L_mv8
L_mrt9:
    s_add_u32 s66, s66, 1
    s_cmp_gt_u32 s66, 200000
    s_cbranch_scc1 L_mgo9
    s_sleep 2
    buffer_load_dwordx4 v[40:43], v2, s[28:31], s17 offen sc1
    buffer_load_dwordx4 v[44:47], v1, s[28:31], s17 offen sc1
    buffer_load_dwordx4 v[8:11], v2, s[28:31], s18 offen sc1
    buffer_load_dwordx4 v[12:15], v1, s[28:31], s18 offen sc1
    buffer_load_dwordx4 v[16:19], v2, s[28:31], s19 offen sc1
    buffer_load_dwordx4 v[20:23], v1, s[28:31], s19 offen sc1
    buffer_load_dwordx4 v[24:27], v2, s[28:31], s20 offen sc1
    buffer_load_dwordx4 v[28:31], v1, s[28:31], s20 offen sc1
    buffer_load_dwordx4 v[32:35], v2, s[28:31], s21 offen sc1
    buffer_load_dwordx4 v[36:39], v1, s[28:31], s21 offen sc1
    s_waitcnt vmcnt(8)
    s_branch L_mv9
L_mrt10:
    s_add_u32 s66, s66, 1
    s_cmp_gt_u32 s66, 200000
    s_cbranch_scc1 L_mgo10
    s_sleep 2
    buffer_load_dwordx4 v[8:11], v2, s[28:31], s18 offen sc1
    buffer_load_dwordx4 v[12:15], v1, s[28:31], s18 offen sc1
    buffer_load_dwordx4 v[16:19], v2, s[28:31], s19 offen sc1
    buffer_load_dwordx4 v[20:23], v1, s[28:31], s19 offen sc1
    buffer_load_dwordx4 v[24:27], v2, s[28:31], s20 offen sc1
    buffer_load_dwordx4 v[28:31], v1, s[28:31], s20 offen sc1
    buffer_load_dwordx4 v[32:35], v2, s[28:31], s21 offen sc1
    buffer_load_dwordx4 v[36:39], v1, s[28:31], s21 offen sc1
    s_waitcnt vmcnt(6)
    s_branch L_mv10
L_mrt11:
    s_add_u32 s66, s66, 1
    s_cmp_gt_u32 s66, 200000
    s_cbranch_scc1 L_mgo11
    s_sleep 2
    buffer_load_dwordx4 v[16:19], v2, s[28:31], s19 offen sc1
    buffer_load_dwordx4 v[20:23], v1, s[28:31], s19 offen sc1
    buffer_load_dwordx4 v[24:27], v2, s[28:31], s20 offen sc1
    buffer_load_dwordx4 v[28:31], v1, s[28:31], s20 offen sc1
    buffer_load_dwordx4 v[32:35], v2, s[28:31], s21 offen sc1
    buffer_load_dwordx4 v[36:39], v1, s[28:31], s21 offen sc1
    s_waitcnt vmcnt(4)
    s_branch L_mv11
L_mrt12:
    s_add_u32 s66, s66, 1
    s_cmp_gt_u32 s66, 200000
    s_cbranch_scc1 L_mgo12
    s_sleep 2
    buffer_load_dwordx4 v[24:27], v2, s[28:31], s20 offen sc1
    buffer_load_dwordx4 v[28:31], v1, s[28:31], s20 offen sc1
    buffer_load_dwordx4 v[32:35], v2, s[28:31], s21 offen sc1
    buffer_load_dwordx4 v[36:39], v1, s[28:31], s21 offen sc1
    s_waitcnt vmcnt(0)
    s_branch L_mv12
L_mrt13:
    s_add_u32 s66, s66, 1
    s_cmp_gt_u32 s66, 200000
    s_cbranch_scc1 L_mgo13
    s_sleep 2
    buffer_load_dwordx4 v[32:35], v2, s[28:31], s21 offen sc1
    buffer_load_dwordx4 v[36:39], v1, s[28:31], s21 offen sc1
    s_waitcnt vmcnt(0)
    s_branch L_mv13
L_rt0:
    s_add_u32 s66, s66, 1
    s_cmp_gt_u32 s66, 200000
    s_cbranch_scc1 L_go0
    s_sleep 2
    buffer_load_dwordx4 v[8:11], v2, s[28:31], s8 offen sc1
    buffer_load_dwordx4 v[12:15], v1, s[28:31], s8 offen sc1
    buffer_load_dwordx4 v[16:19], v2, s[28:31], s9 offen sc1
    buffer_load_dwordx4 v[20:23], v1, s[28:31], s9 offen sc1
    buffer_load_dwordx4 v[24:27], v2, s[28:31], s10 offen sc1
    buffer_load_dwordx4 v[28:31], v1, s[28:31], s10 offen sc1
    buffer_load_dwordx4 v[32:35], v2, s[28:31], s11 offen sc1
    buffer_load_dwordx4 v[36:39], v1, s[28:31], s11 offen sc1
    buffer_load_dwordx4 v[40:43], v2, s[28:31], s12 offen sc1
    buffer_load_dwordx4 v[44:47], v1, s[28:31], s12 offen sc1
    s_waitcnt vmcnt(8)
    s_branch L_v0
L_rt1:
    s_add_u32 s66, s66, 1
    s_cmp_gt_u32 s66, 200000
    s_cbranch_scc1 L_go1
    s_sleep 2
    buffer_load_dwordx4 v[16:19], v2, s[28:31], s9 offen sc1
    buffer_load_dwordx4 v[20:23], v1, s[28:31], s9 offen sc1
    buffer_load_dwordx4 v[24:27], v2, s[28:31], s10 offen sc1
    buffer_load_dwordx4 v[28:31], v1, s[28:31], s10 offen sc1
    buffer_load_dwordx4 v[32:35], v2, s[28:31], s11 offen sc1
    buffer_load_dwordx4 v[36:39], v1, s[28:31], s11 offen sc1
    buffer_load_dwordx4 v[40:43], v2, s[28:31], s12 offen sc1
    buffer_load_dwordx4 v[44:47], v1, s[28:31], s12 offen sc1
    buffer_load_dwordx4 v[8:11], v2, s[28:31], s13 offen sc1
    buffer_load_dwordx4 v[12:15], v1, s[28:31], s13 offen sc1
    s_waitcnt vmcnt(8)
    s_branch L_v1
L_rt2:
    s_add_u32 s66, s66, 1
    s_cmp_gt_u32 s66, 200000
    s_cbranch_scc1 L_go2
    s_sleep 2
    buffer_load_dwordx4 v[24:27], v2, s[28:31], s10 offen sc1
    buffer_load_dwordx4 v[28:31], v1, s[28:31], s10 offen sc1
    buffer_load_dwordx4 v[32:35], v2, s[28:31], s11 offen sc1
    buffer_load_dwordx4 v[36:39], v1, s[28:31], s11 offen sc1
    buffer_load_dwordx4 v[40:43], v2, s[28:31], s12 offen sc1
    buffer_load_dwordx4 v[44:47], v1, s[28:31], s12 offen sc1
    buffer_load_dwordx4 v[8:11], v2, s[28:31], s13 offen sc1
    buffer_load_dwordx4 v[12:15], v1, s[28:31], s13 offen sc1
    buffer_load_dwordx4 v[16:19], v2, s[28:31], s14 offen sc1
    buffer_load_dwordx4 v[20:23], v1, s[28:31], s14 offen sc1
    s_waitcnt vmcnt(8)
    s_branch L_v2
L_rt3:
    s_add_u32 s66, s66, 1
    s_cmp_gt_u32 s66, 200000
    s_cbranch_scc1 L_go3
    s_sleep 2
    buffer_load_dwordx4 v[32:35], v2, s[28:31], s11 offen sc1
    buffer_load_dwordx4 v[36:39], v1, s[28:31], s11 offen sc1
    buffer_load_dwordx4 v[40:43], v2, s[28:31], s12 offen sc1
    buffer_load_dwordx4 v[44:47], v1, s[28:31], s12 offen sc1
    buffer_load_dwordx4 v[8:11], v2, s[28:31], s13 offen sc1
    buffer_load_dwordx4 v[12:15], v1, s[28:31], s13 offen sc1
    buffer_load_dwordx4 v[16:19], v2, s[28:31], s14 offen sc1
    buffer_load_dwordx4 v[20:23], v1, s[28:31], s14 offen sc1
    buffer_load_dwordx4 v[24:27], v2, s[28:31], s15 offen sc1
    buffer_load_dwordx4 v[28:31], v1, s[28:31], s15 offen sc1
    s_waitcnt vmcnt(8)
    s_branch L_v3
L_rt4:
    s_add_u32 s66, s66, 1
    s_cmp_gt_u32 s66, 200000
    s_cbranch_scc1 L_go4
    s_sleep 2
    buffer_load_dwordx4 v[40:43], v2, s[28:31], s12 offen sc1
    buffer_load_dwordx4 v[44:47], v1, s[28:31], s12 offen sc1
    buffer_load_dwordx4 v[8:11], v2, s[28:31], s13 offen sc1
    buffer_load_dwordx4 v[12:15], v1, s[28:31], s13 offen sc1
    buffer_load_dwordx4 v[16:19], v2, s[28:31], s14 offen sc1
    buffer_load_dwordx4 v[20:23], v1, s[28:31], s14 offen sc1
    buffer_load_dwordx4 v[24:27], v2, s[28:31], s15 offen sc1
    buffer_load_dwordx4 v[28:31], v1, s[28:31], s15 offen sc1
    buffer_load_dwordx4 v[32:35], v2, s[28:31], s16 offen sc1
    buffer_load_dwordx4 v[36:39], v1, s[28:31], s16 offen sc1
    s_waitcnt vmcnt(8)
    s_branch L_v4
L_rt5:
    s_add_u32 s66, s66, 1
    s_cmp_gt_u32 s66, 200000
    s_cbranch_scc1 L_go5
    s_sleep 2
    buffer_load_dwordx4 v[8:11], v2, s[28:31], s13 offen sc1
    buffer_load_dwordx4 v[12:15], v1, s[28:31], s13 offen sc1
    buffer_load_dwordx4 v[16:19], v2, s[28:31], s14 offen sc1
    buffer_load_dwordx4 v[20:23], v1, s[28:31], s14 offen sc1
    buffer_load_dwordx4 v[24:27], v2, s[28:31], s15 offen sc1
    buffer_load_dwordx4 v[28:31], v1, s[28:31], s15 offen sc1
    buffer_load_dwordx4 v[32:35], v2, s[28:31], s16 offen sc1
    buffer_load_dwordx4 v[36:39], v1, s[28:31], s16 offen sc1
    buffer_load_dwordx4 v[40:43], v2, s[28:31], s17 offen sc1
    buffer_load_dwordx4 v[44:47], v1, s[28:31], s17 offen sc1
    s_waitcnt vmcnt(8)
    s_branch L_v5
L_rt6:
    s_add_u32 s66, s66, 1
    s_cmp_gt_u32 s66, 200000
    s_cbranch_scc1 L_go6
    s_sleep 2
    buffer_load_dwordx4 v[16:19], v2, s[28:31], s14 offen sc1
    buffer_load_dwordx4 v[20:23], v1, s[28:31], s14 offen sc1
    buffer_load_dwordx4 v[24:27], v2, s[28:31], s15 offen sc1
    buffer_load_dwordx4 v[28:31], v1, s[28:31], s15 offen sc1
    buffer_load_dwordx4 v[32:35], v2, s[28:31], s16 offen sc1
    buffer_load_dwordx4 v[36:39], v1, s[28:31], s16 offen sc1
    buffer_load_dwordx4 v[40:43], v2, s[28:31], s17 offen sc1
    buffer_load_dwordx4 v[44:47], v1, s[28:31], s17 offen sc1
    buffer_load_dwordx4 v[8:11], v2, s[28:31], s18 offen sc1
    buffer_load_dwordx4 v[12:15], v1, s[28:31], s18 offen sc1
    s_waitcnt vmcnt(8)
    s_branch L_v6
L_rt7:
    s_add_u32 s66, s66, 1
    s_cmp_gt_u32 s66, 200000
    s_cbranch_scc1 L_go7
    s_sleep 2
    buffer_load_dwordx4 v[24:27], v2, s[28:31], s15 offen sc1
    buffer_load_dwordx4 v[28:31], v1, s[28:31], s15 offen sc1
    buffer_load_dwordx4 v[32:35], v2, s[28:31], s16 offen sc1
    buffer_load_dwordx4 v[36:39], v1, s[28:31], s16 offen sc1
    buffer_load_dwordx4 v[40:43], v2, s[28:31], s17 offen sc1
    buffer_load_dwordx4 v[44:47], v1, s[28:31], s17 offen sc1
    buffer_load_dwordx4 v[8:11], v2, s[28:31], s18 offen sc1
    buffer_load_dwordx4 v[12:15], v1, s[28:31], s18 offen sc1
    buffer_load_dwordx4 v[16:19], v2, s[28:31], s19 offen sc1
    buffer_load_dwordx4 v[20:23], v1, s[28:31], s19 offen sc1
    s_waitcnt vmcnt(8)
    s_branch L_v7
L_rt8:
    s_add_u32 s66, s66, 1
    s_cmp_gt_u32 s66, 200000
    s_cbranch_scc1 L_go8
    s_sleep 2
    buffer_load_dwordx4 v[32:35], v2, s[28:31], s16 offen sc1
    buffer_load_dwordx4 v[36:39], v1, s[28:31], s16 offen sc1
    buffer_load_dwordx4 v[40:43], v2, s[28:31], s17 offen sc1
    buffer_load_dwordx4 v[44:47], v1, s[28:31], s17 offen sc1
    buffer_load_dwordx4 v[8:11], v2, s[28:31], s18 offen sc1
    buffer_load_dwordx4 v[12:15], v1, s[28:31], s18 offen sc1
    buffer_load_dwordx4 v[16:19], v2, s[28:31], s19 offen sc1
    buffer_load_dwordx4 v[20:23], v1, s[28:31], s19 offen sc1
    buffer_load_dwordx4 v[24:27], v2, s[28:31], s20 offen sc1
    buffer_load_dwordx4 v[28:31], v1, s[28:31], s20 offen sc1
    s_waitcnt vmcnt(8)
    s_branch L_v8
L_rt9:
    s_add_u32 s66, s66, 1
    s_cmp_gt_u32 s66, 200000
    s_cbranch_scc1 L_go9
    s_sleep 2
    buffer_load_dwordx4 v[40:43], v2, s[28:31], s17 offen sc1
    buffer_load_dwordx4 v[44:47], v1, s[28:31], s17 offen sc1
    buffer_load_dwordx4 v[8:11], v2, s[28:31], s18 offen sc1
    buffer_load_dwordx4 v[12:15], v1, s[28:31], s18 offen sc1
    buffer_load_dwordx4 v[16:19], v2, s[28:31], s19 offen sc1
    buffer_load_dwordx4 v[20:23], v1, s[28:31], s19 offen sc1
    buffer_load_dwordx4 v[24:27], v2, s[28:31], s20 offen sc1
    buffer_load_dwordx4 v[28:31], v1, s[28:31], s20 offen sc1
    buffer_load_dwordx4 v[32:35], v2, s[28:31], s21 offen sc1
    buffer_load_dwordx4 v[36:39], v1, s[28:31], s21 offen sc1
    s_waitcnt vmcnt(8)
    s_branch L_v9
L_rt10:
    s_add_u32 s66, s66, 1
    s_cmp_gt_u32 s66, 200000
    s_cbranch_scc1 L_go10
    s_sleep 2
    buffer_load_dwordx4 v[8:11], v2, s[28:31], s18 offen sc1
    buffer_load_dwordx4 v[12:15], v1, s[28:31], s18 offen sc1
    buffer_load_dwordx4 v[16:19], v2, s[28:31], s19 offen sc1
    buffer_load_dwordx4 v[20:23], v1, s[28:31], s19 offen sc1
    buffer_load_dwordx4 v[24:27], v2, s[28:31], s20 offen sc1
    buffer_load_dwordx4 v[28:31], v1, s[28:31], s20 offen sc1
    buffer_load_dwordx4 v[32:35], v2, s[28:31], s21 offen sc1
    buffer_load_dwordx4 v[36:39], v1, s[28:31], s21 offen sc1
    s_waitcnt vmcnt(6)
    s_branch L_v10
L_rt11:
    s_add_u32 s66, s66, 1
    s_cmp_gt_u32 s66, 200000
    s_cbranch_scc1 L_go11
    s_sleep 2
    buffer_load_dwordx4 v[16:19], v2, s[28:31], s19 offen sc1
    buffer_load_dwordx4 v[20:23], v1, s[28:31], s19 offen sc1
    buffer_load_dwordx4 v[24:27], v2, s[28:31], s20 offen sc1
    buffer_load_dwordx4 v[28:31], v1, s[28:31], s20 offen sc1
    buffer_load_dwordx4 v[32:35], v2, s[28:31], s21 offen sc1
    buffer_load_dwordx4 v[36:39], v1, s[28:31], s21 offen sc1
    s_waitcnt vmcnt(4)
    s_branch L_v11
L_rt12:
    s_add_u32 s66, s66, 1
    s_cmp_gt_u32 s66, 200000
    s_cbranch_scc1 L_go12
    s_sleep 2
    buffer_load_dwordx4 v[24:27], v2, s[28:31], s20 offen sc1
    buffer_load_dwordx4 v[28:31], v1, s[28:31], s20 offen sc1
    buffer_load_dwordx4 v[32:35], v2, s[28:31], s21 offen sc1
    buffer_load_dwordx4 v[36:39], v1, s[28:31], s21 offen sc1
    s_waitcnt vmcnt(0)
    s_branch L_v12
L_rt13:
    s_add_u32 s66, s66, 1
    s_cmp_gt_u32 s66, 200000
    s_cbranch_scc1 L_go13
    s_sleep 2
    buffer_load_dwordx4 v[32:35], v2, s[28:31], s21 offen sc1
    buffer_load_dwordx4 v[36:39], v1, s[28:31], s21 offen sc1
    s_waitcnt vmcnt(0)
    s_branch L_v13
L_end:
    s_endpgm
.section .rodata,"a"
.p2align 6
.amdhsa_kernel parallel_sum__linear_kernel_hedgehog__dense_activation_relu__prompt_kernel
  .amdhsa_next_free_vgpr 256
  .amdhsa_next_free_sgpr 102
  .amdhsa_accum_offset 256
  .amdhsa_group_segment_fixed_size 0
  .amdhsa_kernarg_size 80
  .amdhsa_user_sgpr_count 2
  .amdhsa_user_sgpr_kernarg_segment_ptr 1
  .amdhsa_system_sgpr_workgroup_id_x 1
.end_amdhsa_kernel
```
